```python
import torch

def _softmax(x, axis=-1):
    return torch.softmax(x, dim=axis)
def _gelu(x):
    return torch.nn.functional.gelu(x, approximate="tanh")
def _silu(x):
    return torch.nn.functional.silu(x)
def _sigmoid(x):
    return torch.sigmoid(x)
def _layernorm(x, axis=-1, eps=1e-5):
    m = x.mean(dim=axis, keepdim=True)
    v = x.var(dim=axis, keepdim=True, unbiased=False)
    return (x - m) / torch.sqrt(v + eps)
def _scatter_add(tgt, idx, src, axis=0):
    return tgt.clone().index_add_(axis, idx, src)
def _segment_sum(src, seg, n):
    out = torch.zeros((n,) + src.shape[1:], dtype=src.dtype)
    return out.index_add_(0, seg, src)
def _pad(x, pw):
    flat = tuple(v for pair in reversed(pw) for v in pair)
    return torch.nn.functional.pad(x, flat)

kernel_name = 'recurrent_scan__linear_attn_block__glu_gated_geglu__prompt'

def setup_inputs():

    _w = (lambda a: (lambda t: t.to(torch.bfloat16) if t.is_floating_point() else t)(torch.as_tensor(a)))
    def _A_setup():
        B, S, D = 1, 2048, 640
        return {
            "x": _w((lambda *s: torch.randn(*s, dtype=torch.bfloat16) * 0.05)(B, S, D)),
            "wqkv": _w((lambda *s: torch.randn(*s, dtype=torch.bfloat16) * 0.8)(D, 3 * D)),
            "wo": _w((lambda *s: torch.randn(*s, dtype=torch.bfloat16) * 0.8)(D, D)),
        }
    _A_in = _A_setup()

    def _B_setup():
        B, S, Dm, Df = 1, 2048, 640, 1536
        return {
            "x": _w((lambda *s: torch.randn(*s, dtype=torch.bfloat16) * 0.05)(B, S, Dm)),
            "w_gate": _w((lambda *s: torch.randn(*s, dtype=torch.bfloat16) * 0.2)(Dm, Df) * (Dm ** -0.5)),
            "w_up": _w((lambda *s: torch.randn(*s, dtype=torch.bfloat16) * 0.2)(Dm, Df) * (Dm ** -0.5)),
            "w_down": _w((lambda *s: torch.randn(*s, dtype=torch.bfloat16) * 0.2)(Df, Dm) * (Df ** -0.5)),
        }
    _B_in = _B_setup()

    return {
        "A_x": _A_in["x"],
        "A_wqkv": _A_in["wqkv"],
        "A_wo": _A_in["wo"],
        "B_x": _B_in["x"],
        "B_w_gate": _B_in["w_gate"],
        "B_w_up": _B_in["w_up"],
        "B_w_down": _B_in["w_down"],
    }

def reference(A_x, A_wqkv, A_wo, B_x, B_w_gate, B_w_up, B_w_down):
    def _A_ref(x, wqkv, wo):
        B, S, D = x.shape
        H = 32; Dh = D // H
        qkv = (lambda x, *d: x.permute(*d))((x @ wqkv).reshape(B, S, 3, H, Dh), 2, 0, 3, 1, 4)
        q, k, v = qkv[0], qkv[1], qkv[2]
        phi = lambda t: torch.where(t > 0, t + 1, torch.exp(t)) + 1e-6
        pq, pk = phi(q), phi(k)
        kv = torch.einsum("bhsd,bhse->bhde", pk, v)
        z = torch.einsum("bhsd->bhd", pk)
        num = torch.einsum("bhqd,bhde->bhqe", pq, kv)
        den = torch.einsum("bhqd,bhd->bhq", pq, z)[..., None] + 1e-6
        o = num / den
        return (lambda x, *d: x.permute(*d))(o, 0, 2, 1, 3).reshape(B, S, D) @ wo

    def _B_ref(x, w_gate, w_up, w_down):
        g = torch.einsum("bsd,df->bsf", x, w_gate)
        u = torch.einsum("bsd,df->bsf", x, w_up)
        h = _gelu(g) * u
        return torch.einsum("bsf,fd->bsd", h, w_down)

    x = A_x
    xn = _layernorm(x, axis=-1)
    s = _A_ref(xn, A_wqkv, A_wo)
    g = _silu(_B_ref(xn, B_w_gate, B_w_up, B_w_down))
    return x + s * g
```

```asm
; @launch grid=(256,1,1) block=(512,1,1) lds=163840
.amdgcn_target "amdgcn-amd-amdhsa--gfx950"
.text
.globl recurrent_scan__linear_attn_block__glu_gated_geglu__prompt_kernel
.p2align 8
.type recurrent_scan__linear_attn_block__glu_gated_geglu__prompt_kernel,@function
recurrent_scan__linear_attn_block__glu_gated_geglu__prompt_kernel:
    s_cmp_ge_u32 s2, 256
    s_cbranch_scc1 K_END
    s_load_dwordx16 s[4:19], s[0:1], 0
    s_load_dwordx4 s[20:23], s[0:1], 64
    s_mov_b32 s3, 0
    s_getpc_b64 s[24:25]
K_PC:
    s_mov_b32 s26, K_CODE_END - K_PC
    s_mov_b32 s27, 0x20000
    s_lshr_b32 s28, s2, 3
    s_lshl_b32 s28, s28, 12
    v_lshlrev_b32 v1, 6, v0
    v_cmp_gt_u32 vcc, 64, v0
    s_nop 1
    s_and_saveexec_b64 s[30:31], vcc
    s_cbranch_execz K_NOPF
    buffer_load_dword v254, v1, s[24:27], s28 offen
K_NOPF:
    s_mov_b64 exec, -1
    s_and_b32 s56, s2, 7
    s_lshr_b32 s57, s2, 3
    s_and_b32 s48, s56, 1
    s_lshl_b32 s48, s48, 3
    s_and_b32 s58, s57, 7
    s_add_u32 s48, s48, s58
    s_lshr_b32 s49, s56, 1
    s_lshl_b32 s49, s49, 2
    s_lshr_b32 s58, s57, 3
    s_add_u32 s49, s49, s58
    s_mov_b32 s58, 0xe8716540
    s_mov_b32 s59, 0xfdc3ba92
    s_lshl_b32 s49, s49, 2
    s_lshr_b64 s[58:59], s[58:59], s49
    s_and_b32 s49, s58, 15
    s_sub_u32 s53, s49, 4
    v_lshrrev_b32 v30, 6, v0
    v_and_b32 v1, 63, v0
    v_readfirstlane_b32 s50, v30
    v_and_b32 v2, 15, v0
    v_bfe_u32 v3, v0, 4, 2
    s_lshr_b32 s51, s50, 2
    s_and_b32 s52, s50, 3
    s_lshl_b32 s54, s50, 10
    s_lshl_b32 s55, s50, 11
    s_add_u32 s56, s48, s49
    s_cmp_ge_u32 s56, 20
    s_cselect_b32 s57, 20, 0
    s_sub_u32 s56, s56, s57
    s_cmp_ge_u32 s56, 10
    s_cselect_b32 s57, 10, 0
    s_sub_u32 s56, s56, s57
    s_cmp_le_u32 s56, 0
    s_cselect_b32 s80, 64, 0
    s_movk_i32 s81, 64
    s_cmp_le_u32 s56, 1
    s_cselect_b32 s81, 128, s81
    s_movk_i32 s82, 128
    s_cmp_le_u32 s56, 2
    s_cselect_b32 s82, 192, s82
    s_lshl_b32 s83, s56, 6
    s_movk_i32 s84, 192
    s_cmp_le_u32 s56, 3
    s_cselect_b32 s84, 256, s84
    s_movk_i32 s85, 256
    s_cmp_le_u32 s56, 4
    s_cselect_b32 s85, 320, s85
    s_movk_i32 s86, 320
    s_cmp_le_u32 s56, 5
    s_cselect_b32 s86, 384, s86
    s_movk_i32 s87, 384
    s_cmp_le_u32 s56, 6
    s_cselect_b32 s87, 448, s87
    s_movk_i32 s88, 448
    s_cmp_le_u32 s56, 7
    s_cselect_b32 s88, 512, s88
    s_movk_i32 s89, 512
    s_cmp_le_u32 s56, 8
    s_cselect_b32 s89, 576, s89
    v_lshrrev_b32 v32, 3, v1
    s_lshl_b32 s56, s48, 7
    s_lshl_b32 s57, s50, 4
    s_add_u32 s56, s56, s57
    v_add_u32 v30, s56, v32
    v_mul_u32_u24 v30, 1280, v30
    v_and_b32 v31, 7, v1
    v_xor_b32 v31, v31, v3
    v_lshl_add_u32 v4, v31, 4, v30
    v_xor_b32 v31, 4, v31
    v_lshl_add_u32 v5, v31, 4, v30
    v_add_u32 v5, 10240, v5
    s_cmp_lt_u32 s49, 4
    s_cbranch_scc1 P1_KV
    s_lshr_b32 s56, s50, 1
    s_and_b32 s56, s56, 1
    s_lshl_b32 s56, s56, 2
    v_or_b32 v30, s56, v3
    v_lshlrev_b32 v30, 1, v30
    v_xor_b32 v30, v30, v2
    s_lshl_b32 s56, s50, 2
    v_add_u32 v31, s56, v3
    v_mul_u32_u24 v31, 3072, v31
    v_lshl_add_u32 v30, v30, 4, v31
    s_lshl_b32 s56, s53, 8
    v_add_u32 v6, s56, v30
    s_and_b32 s56, s50, 1
    s_lshl_b32 s56, s56, 1
    v_and_b32 v30, 1, v3
    v_or_b32 v30, s56, v30
    v_lshlrev_b32 v30, 1, v30
    v_and_b32 v31, 7, v1
    v_xor_b32 v30, v30, v31
    s_lshl_b32 s56, s50, 3
    v_add_u32 v31, s56, v32
    v_mul_u32_u24 v31, 3840, v31
    v_lshl_add_u32 v30, v30, 4, v31
    s_lshl_b32 s56, s53, 7
    v_add_u32 v8, s56, v30
    s_waitcnt lgkmcnt(0)
    s_mov_b32 s24, s4
    s_mov_b32 s25, s5
    s_mov_b32 s26, 2621440
    s_mov_b32 s27, 0x20000
    s_mov_b32 s36, s6
    s_mov_b32 s37, s7
    s_mov_b32 s38, 2457600
    s_mov_b32 s39, 0x20000
    s_mov_b32 s40, s22
    s_mov_b32 s41, s23
    s_mov_b32 s42, 33554432
    s_mov_b32 s43, 0x20000
    s_mov_b32 s44, s20
    s_mov_b32 s45, s21
    s_mov_b32 s46, 256
    s_mov_b32 s47, 0x20000
    s_mov_b32 s28, s12
    s_mov_b32 s29, s13
    s_mov_b32 s30, 1966080
    s_mov_b32 s31, 0x20000
    s_mov_b32 s32, s14
    s_mov_b32 s33, s15
    s_mov_b32 s34, 1966080
    s_mov_b32 s35, 0x20000
    s_cmp_ge_u32 s53, 10
    s_cbranch_scc1 P1_GU
    s_lshl_b32 s59, s80, 1
    s_add_u32 m0, s55, 81920
    s_nop 0
    buffer_load_dwordx4 v4, s[24:27], s59 offen lds
    s_add_u32 m0, s55, 82944
    s_nop 0
    buffer_load_dwordx4 v5, s[24:27], s59 offen lds
    s_mul_i32 s60, s80, 3840
    s_add_u32 m0, s54, 131072
    s_nop 0
    buffer_load_dwordx4 v8, s[36:39], s60 offen lds
    s_mul_i32 s58, s80, 3072
    s_add_u32 m0, s54, 0
    s_nop 0
    buffer_load_dwordx4 v6, s[28:31], s58 offen lds
    s_add_u32 m0, s54, 8192
    s_nop 0
    buffer_load_dwordx4 v6, s[32:35], s58 offen lds
    v_lshrrev_b32 v30, 2, v2
    v_and_b32 v31, 3, v2
    v_lshl_add_u32 v32, v3, 3, v30
    v_and_b32 v33, 1, v3
    v_lshl_or_b32 v34, v33, 2, v30
    s_lshl_b32 s56, s52, 1
    v_xor_b32 v34, s56, v34
    v_lshlrev_b32 v35, 8, v32
    v_lshl_add_u32 v35, v31, 3, v35
    v_lshl_add_u32 v9, v34, 5, v35
    v_xor_b32 v34, 1, v34
    v_lshl_add_u32 v11, v34, 5, v35
    v_add_u32 v10, 0x10000, v9
    v_add_u32 v12, 0x10000, v11
    v_lshrrev_b32 v34, 1, v30
    v_lshl_or_b32 v34, v33, 1, v34
    v_xor_b32 v34, s52, v34
    v_lshlrev_b32 v35, 7, v32
    v_lshl_add_u32 v35, v31, 3, v35
    v_lshl_add_u32 v35, v34, 5, v35
    v_add_u32 v17, 131072, v35
    v_lshrrev_b32 v30, 1, v2
    v_xor_b32 v30, v30, v3
    v_lshlrev_b32 v30, 4, v30
    v_lshl_add_u32 v30, v2, 7, v30
    v_xor_b32 v31, 64, v30
    s_lshl_b32 s57, s51, 13
    s_add_u32 s57, s57, 81920
    s_xor_b32 s56, s52, 0
    s_lshl_b32 s56, s56, 11
    s_add_u32 s56, s56, s57
    v_add_u32 v19, s56, v30
    v_add_u32 v20, s56, v31
    s_xor_b32 s56, s52, 1
    s_lshl_b32 s56, s56, 11
    s_add_u32 s56, s56, s57
    v_add_u32 v21, s56, v30
    v_add_u32 v22, s56, v31
    s_xor_b32 s56, s52, 2
    s_lshl_b32 s56, s56, 11
    s_add_u32 s56, s56, s57
    v_add_u32 v23, s56, v30
    v_add_u32 v24, s56, v31
    s_xor_b32 s56, s52, 3
    s_lshl_b32 s56, s56, 11
    s_add_u32 s56, s56, s57
    v_add_u32 v25, s56, v30
    v_add_u32 v26, s56, v31
    s_barrier
    s_mul_i32 s58, s80, 3072
    s_add_u32 s58, s58, 98304
    s_add_u32 m0, s54, 16384
    s_nop 0
    buffer_load_dwordx4 v6, s[28:31], s58 offen lds
    s_add_u32 m0, s54, 24576
    s_nop 0
    buffer_load_dwordx4 v6, s[32:35], s58 offen lds
    s_mov_b32 s92, s16
    s_mov_b32 s93, s17
    s_mov_b32 s94, 1966080
    s_mov_b32 s95, 0x20000
    s_mul_i32 s56, s48, 12
    s_add_u32 s56, s56, s53
    s_lshr_b32 s60, s56, 2
    s_and_b32 s61, s56, 3
    s_mul_i32 s62, s60, 40960
    s_mul_i32 s63, s61, 320
    s_add_u32 s62, s62, s63
    s_mov_b32 s59, 3277
    v_mov_b32 v34, 0x40000000
    v_add_u32 v30, 0, v0
    v_mul_u32_u24 v31, s59, v30
    v_lshrrev_b32 v31, 16, v31
    v_mul_u32_u24 v33, 20, v31
    v_sub_u32 v33, v30, v33
    v_mul_u32_u24 v31, 1280, v31
    v_lshl_add_u32 v31, v33, 4, v31
    s_add_u32 m0, s54, 65536
    s_nop 0
    buffer_load_dwordx4 v31, s[92:95], s62 offen lds
    v_add_u32 v30, 512, v0
    v_mul_u32_u24 v31, s59, v30
    v_lshrrev_b32 v31, 16, v31
    v_mul_u32_u24 v33, 20, v31
    v_sub_u32 v33, v30, v33
    v_mul_u32_u24 v31, 1280, v31
    v_lshl_add_u32 v31, v33, 4, v31
    v_cmp_gt_u32 vcc, 640, v30
    s_nop 1
    v_cndmask_b32 v31, v34, v31, vcc
    s_add_u32 m0, s54, 73728
    s_nop 0
    buffer_load_dwordx4 v31, s[92:95], s62 offen lds
    s_mul_i32 s90, s61, 96
    s_add_u32 s90, s90, s60
    s_mul_i32 s90, s90, 5
    s_add_u32 s90, s90, s50
    s_lshl_b32 s90, s90, 10
    s_add_u32 s90, s90, 8912896
    s_lshl_b32 s100, s61, 9
    s_lshl_b32 s62, s60, 3
    s_add_u32 s100, s100, s62
    s_add_u32 s100, s100, 13090816
    s_cmp_ge_u32 s50, 5
    s_cselect_b32 s90, 0x40000000, s90
    s_min_u32 s56, s50, 4
    s_lshl_b32 s56, s56, 5
    v_lshrrev_b32 v30, 2, v2
    v_and_b32 v31, 3, v2
    v_lshl_add_u32 v31, v31, 3, s56
    v_lshl_add_u32 v32, v3, 2, v30
    v_mul_u32_u24 v33, 320, v32
    v_add_u32 v33, v33, v31
    v_add_u32 v220, 65536, v33
    v_lshlrev_b32 v223, 4, v1
    v_mov_b32 v27, 0x3f803f80
    v_mov_b32 v244, 0x3f803f80
    v_mov_b32 v245, 0x3f803f80
    v_mov_b32 v246, 0x3f803f80
    v_mov_b32 v247, 0x3f803f80
    v_mov_b32 v112, 0
    v_mov_b32 v113, 0
    v_mov_b32 v114, 0
    v_mov_b32 v115, 0
    v_mov_b32 v116, 0
    v_mov_b32 v117, 0
    v_mov_b32 v118, 0
    v_mov_b32 v119, 0
    v_mov_b32 v120, 0
    v_mov_b32 v121, 0
    v_mov_b32 v122, 0
    v_mov_b32 v123, 0
    v_mov_b32 v124, 0
    v_mov_b32 v125, 0
    v_mov_b32 v126, 0
    v_mov_b32 v127, 0
    v_mov_b32 v128, 0
    v_mov_b32 v129, 0
    v_mov_b32 v130, 0
    v_mov_b32 v131, 0
    v_mov_b32 v132, 0
    v_mov_b32 v133, 0
    v_mov_b32 v134, 0
    v_mov_b32 v135, 0
    v_mov_b32 v136, 0
    v_mov_b32 v137, 0
    v_mov_b32 v138, 0
    v_mov_b32 v139, 0
    v_mov_b32 v140, 0
    v_mov_b32 v141, 0
    v_mov_b32 v142, 0
    v_mov_b32 v143, 0
    v_mov_b32 v144, 0
    v_mov_b32 v145, 0
    v_mov_b32 v146, 0
    v_mov_b32 v147, 0
    v_mov_b32 v148, 0
    v_mov_b32 v149, 0
    v_mov_b32 v150, 0
    v_mov_b32 v151, 0
    v_mov_b32 v152, 0
    v_mov_b32 v153, 0
    v_mov_b32 v154, 0
    v_mov_b32 v155, 0
    v_mov_b32 v156, 0
    v_mov_b32 v157, 0
    v_mov_b32 v158, 0
    v_mov_b32 v159, 0
    v_mov_b32 v160, 0
    v_mov_b32 v161, 0
    v_mov_b32 v162, 0
    v_mov_b32 v163, 0
    v_mov_b32 v164, 0
    v_mov_b32 v165, 0
    v_mov_b32 v166, 0
    v_mov_b32 v167, 0
    v_mov_b32 v168, 0
    v_mov_b32 v169, 0
    v_mov_b32 v170, 0
    v_mov_b32 v171, 0
    v_mov_b32 v172, 0
    v_mov_b32 v173, 0
    v_mov_b32 v174, 0
    v_mov_b32 v175, 0
    v_mov_b32 v176, 0
    v_mov_b32 v177, 0
    v_mov_b32 v178, 0
    v_mov_b32 v179, 0
    v_mov_b32 v180, 0
    v_mov_b32 v181, 0
    v_mov_b32 v182, 0
    v_mov_b32 v183, 0
    v_mov_b32 v184, 0
    v_mov_b32 v185, 0
    v_mov_b32 v186, 0
    v_mov_b32 v187, 0
    v_mov_b32 v188, 0
    v_mov_b32 v189, 0
    v_mov_b32 v190, 0
    v_mov_b32 v191, 0
    s_cmp_lg_u32 s51, 0
    s_cselect_b64 vcc, -1, 0
    s_waitcnt vmcnt(4)
    s_barrier
    ds_read_b128 v[40:43], v19 offset:0
    ds_read_b64_tr_b16 v[56:57], v9 offset:0
    ds_read_b64_tr_b16 v[58:59], v9 offset:1024
    ds_read_b128 v[44:47], v21 offset:0
    ds_read_b64_tr_b16 v[60:61], v11 offset:0
    ds_read_b64_tr_b16 v[62:63], v11 offset:1024
    ds_read_b128 v[48:51], v23 offset:0
    ds_read_b64_tr_b16 v[64:65], v9 offset:8192
    ds_read_b64_tr_b16 v[66:67], v9 offset:9216
    ds_read_b128 v[52:55], v25 offset:0
    ds_read_b64_tr_b16 v[68:69], v11 offset:8192
    ds_read_b64_tr_b16 v[70:71], v11 offset:9216
    ds_read_b64_tr_b16 v[72:73], v17 offset:0
    ds_read_b64_tr_b16 v[74:75], v17 offset:512
    s_lshl_b32 s59, s81, 1
    s_add_u32 m0, s55, 98304
    s_nop 0
    buffer_load_dwordx4 v4, s[24:27], s59 offen lds
    s_add_u32 m0, s55, 99328
    s_nop 0
    buffer_load_dwordx4 v5, s[24:27], s59 offen lds
    s_mul_i32 s60, s81, 3840
    s_add_u32 m0, s54, 139264
    s_nop 0
    buffer_load_dwordx4 v8, s[36:39], s60 offen lds
    s_mul_i32 s58, s81, 3072
    s_add_u32 m0, s54, 32768
    s_nop 0
    buffer_load_dwordx4 v6, s[28:31], s58 offen lds
    s_add_u32 m0, s54, 40960
    s_nop 0
    buffer_load_dwordx4 v6, s[32:35], s58 offen lds
    s_mul_i32 s58, s81, 3072
    s_add_u32 s58, s58, 98304
    s_add_u32 m0, s54, 49152
    s_nop 0
    buffer_load_dwordx4 v6, s[28:31], s58 offen lds
    s_add_u32 m0, s54, 57344
    s_nop 0
    buffer_load_dwordx4 v6, s[32:35], s58 offen lds
    s_waitcnt vmcnt(7) lgkmcnt(0)
    s_barrier
    v_mfma_f32_16x16x32_bf16 v[112:115], v[56:59], v[40:43], v[112:115]
    ds_read_b128 v[76:79], v20 offset:0
    ds_read_b64_tr_b16 v[92:93], v9 offset:16384
    v_mfma_f32_16x16x32_bf16 v[116:119], v[56:59], v[44:47], v[116:119]
    ds_read_b64_tr_b16 v[94:95], v9 offset:17408
    v_mfma_f32_16x16x32_bf16 v[120:123], v[56:59], v[48:51], v[120:123]
    ds_read_b128 v[80:83], v22 offset:0
    v_mfma_f32_16x16x32_bf16 v[124:127], v[56:59], v[52:55], v[124:127]
    ds_read_b64_tr_b16 v[96:97], v11 offset:16384
    v_mfma_f32_16x16x32_bf16 v[128:131], v[60:63], v[40:43], v[128:131]
    ds_read_b64_tr_b16 v[98:99], v11 offset:17408
    v_mfma_f32_16x16x32_bf16 v[132:135], v[60:63], v[44:47], v[132:135]
    ds_read_b128 v[84:87], v24 offset:0
    v_mfma_f32_16x16x32_bf16 v[136:139], v[60:63], v[48:51], v[136:139]
    ds_read_b64_tr_b16 v[100:101], v9 offset:24576
    ds_read_b64_tr_b16 v[102:103], v9 offset:25600
    v_mfma_f32_16x16x32_bf16 v[140:143], v[60:63], v[52:55], v[140:143]
    ds_read_b128 v[88:91], v26 offset:0
    v_mfma_f32_16x16x32_bf16 v[144:147], v[64:67], v[40:43], v[144:147]
    ds_read_b64_tr_b16 v[104:105], v11 offset:24576
    v_mfma_f32_16x16x32_bf16 v[148:151], v[64:67], v[44:47], v[148:151]
    ds_read_b64_tr_b16 v[106:107], v11 offset:25600
    v_mfma_f32_16x16x32_bf16 v[152:155], v[64:67], v[48:51], v[152:155]
    ds_read_b64_tr_b16 v[108:109], v17 offset:4096
    v_mfma_f32_16x16x32_bf16 v[156:159], v[64:67], v[52:55], v[156:159]
    ds_read_b64_tr_b16 v[110:111], v17 offset:4608
    v_mfma_f32_16x16x32_bf16 v[160:163], v[68:71], v[40:43], v[160:163]
    ds_read_b64_tr_b16 v[192:193], v220 offset:0
    v_mfma_f32_16x16x32_bf16 v[164:167], v[68:71], v[44:47], v[164:167]
    ds_read_b64_tr_b16 v[194:195], v220 offset:5120
    ds_read_b64_tr_b16 v[196:197], v220 offset:160
    v_mfma_f32_16x16x32_bf16 v[168:171], v[68:71], v[48:51], v[168:171]
    ds_read_b64_tr_b16 v[198:199], v220 offset:5280
    v_mfma_f32_16x16x32_bf16 v[172:175], v[68:71], v[52:55], v[172:175]
    s_lshl_b32 s59, s82, 1
    s_add_u32 m0, s55, 114688
    s_nop 0
    buffer_load_dwordx4 v4, s[24:27], s59 offen lds
    v_mfma_f32_16x16x32_bf16 v[176:179], v[72:75], v[40:43], v[176:179]
    s_add_u32 m0, s55, 115712
    s_nop 0
    buffer_load_dwordx4 v5, s[24:27], s59 offen lds
    v_mfma_f32_16x16x32_bf16 v[180:183], v[72:75], v[44:47], v[180:183]
    s_mul_i32 s60, s82, 3840
    s_add_u32 m0, s54, 147456
    s_nop 0
    buffer_load_dwordx4 v8, s[36:39], s60 offen lds
    v_mfma_f32_16x16x32_bf16 v[184:187], v[72:75], v[48:51], v[184:187]
    s_mul_i32 s58, s82, 3072
    s_add_u32 s58, s58, 98304
    s_add_u32 m0, s54, 0
    s_nop 0
    buffer_load_dwordx4 v6, s[28:31], s58 offen lds
    v_mfma_f32_16x16x32_bf16 v[188:191], v[72:75], v[52:55], v[188:191]
    s_add_u32 m0, s54, 8192
    s_nop 0
    buffer_load_dwordx4 v6, s[32:35], s58 offen lds
    s_waitcnt vmcnt(7) lgkmcnt(0)
    s_barrier
    v_mfma_f32_16x16x32_bf16 v[112:115], v[92:95], v[76:79], v[112:115]
    ds_read_b128 v[40:43], v19 offset:16384
    ds_read_b64_tr_b16 v[56:57], v9 offset:32768
    v_mfma_f32_16x16x32_bf16 v[116:119], v[92:95], v[80:83], v[116:119]
    ds_read_b64_tr_b16 v[58:59], v9 offset:33792
    v_mfma_f32_16x16x32_bf16 v[120:123], v[92:95], v[84:87], v[120:123]
    ds_read_b128 v[44:47], v21 offset:16384
    v_mfma_f32_16x16x32_bf16 v[124:127], v[92:95], v[88:91], v[124:127]
    ds_read_b64_tr_b16 v[60:61], v11 offset:32768
    v_mfma_f32_16x16x32_bf16 v[128:131], v[96:99], v[76:79], v[128:131]
    ds_read_b64_tr_b16 v[62:63], v11 offset:33792
    v_mfma_f32_16x16x32_bf16 v[132:135], v[96:99], v[80:83], v[132:135]
    ds_read_b128 v[48:51], v23 offset:16384
    v_mfma_f32_16x16x32_bf16 v[136:139], v[96:99], v[84:87], v[136:139]
    ds_read_b64_tr_b16 v[64:65], v9 offset:40960
    v_mfma_f32_16x16x32_bf16 v[140:143], v[96:99], v[88:91], v[140:143]
    ds_read_b64_tr_b16 v[66:67], v9 offset:41984
    v_mfma_f32_16x16x32_bf16 v[144:147], v[100:103], v[76:79], v[144:147]
    ds_read_b128 v[52:55], v25 offset:16384
    v_mfma_f32_16x16x32_bf16 v[148:151], v[100:103], v[80:83], v[148:151]
    ds_read_b64_tr_b16 v[68:69], v11 offset:40960
    v_mfma_f32_16x16x32_bf16 v[152:155], v[100:103], v[84:87], v[152:155]
    ds_read_b64_tr_b16 v[70:71], v11 offset:41984
    v_mfma_f32_16x16x32_bf16 v[156:159], v[100:103], v[88:91], v[156:159]
    ds_read_b64_tr_b16 v[72:73], v17 offset:8192
    v_mfma_f32_16x16x32_bf16 v[160:163], v[104:107], v[76:79], v[160:163]
    ds_read_b64_tr_b16 v[74:75], v17 offset:8704
    v_mfma_f32_16x16x32_bf16 v[164:167], v[104:107], v[80:83], v[164:167]
    buffer_store_dwordx4 v[192:195], v223, s[40:43], s90 offen sc0 sc1
    s_add_u32 s90, s90, 245760
    v_mfma_f32_16x16x32_bf16 v[168:171], v[104:107], v[84:87], v[168:171]
    s_mul_i32 s58, s82, 3072
    s_add_u32 m0, s54, 65536
    s_nop 0
    buffer_load_dwordx4 v6, s[28:31], s58 offen lds
    v_mfma_f32_16x16x32_bf16 v[172:175], v[104:107], v[88:91], v[172:175]
    s_add_u32 m0, s54, 73728
    s_nop 0
    buffer_load_dwordx4 v6, s[32:35], s58 offen lds
    v_mfma_f32_16x16x32_bf16 v[176:179], v[108:111], v[76:79], v[176:179]
    s_mul_i32 s58, s83, 3072
    s_add_u32 m0, s54, 16384
    s_nop 0
    buffer_load_dwordx4 v6, s[28:31], s58 offen lds
    v_mfma_f32_16x16x32_bf16 v[180:183], v[108:111], v[80:83], v[180:183]
    s_add_u32 m0, s54, 24576
    s_nop 0
    buffer_load_dwordx4 v6, s[32:35], s58 offen lds
    v_mfma_f32_16x16x32_bf16 v[184:187], v[108:111], v[84:87], v[184:187]
    s_lshl_b32 s59, s83, 1
    s_add_u32 m0, s55, 81920
    s_nop 0
    buffer_load_dwordx4 v4, s[24:27], s59 offen lds
    v_mfma_f32_16x16x32_bf16 v[188:191], v[108:111], v[88:91], v[188:191]
    s_add_u32 m0, s55, 82944
    s_nop 0
    buffer_load_dwordx4 v5, s[24:27], s59 offen lds
    s_waitcnt vmcnt(12) lgkmcnt(0)
    s_barrier
    v_mfma_f32_16x16x32_bf16 v[112:115], v[56:59], v[40:43], v[112:115]
    ds_read_b128 v[76:79], v20 offset:16384
    v_mfma_f32_16x16x32_bf16 v[116:119], v[56:59], v[44:47], v[116:119]
    ds_read_b64_tr_b16 v[92:93], v9 offset:49152
    v_mfma_f32_16x16x32_bf16 v[120:123], v[56:59], v[48:51], v[120:123]
    ds_read_b64_tr_b16 v[94:95], v9 offset:50176
    v_mfma_f32_16x16x32_bf16 v[124:127], v[56:59], v[52:55], v[124:127]
    ds_read_b128 v[80:83], v22 offset:16384
    v_mfma_f32_16x16x32_bf16 v[128:131], v[60:63], v[40:43], v[128:131]
    ds_read_b64_tr_b16 v[96:97], v11 offset:49152
    v_mfma_f32_16x16x32_bf16 v[132:135], v[60:63], v[44:47], v[132:135]
    ds_read_b64_tr_b16 v[98:99], v11 offset:50176
    v_mfma_f32_16x16x32_bf16 v[136:139], v[60:63], v[48:51], v[136:139]
    ds_read_b128 v[84:87], v24 offset:16384
    v_mfma_f32_16x16x32_bf16 v[140:143], v[60:63], v[52:55], v[140:143]
    ds_read_b64_tr_b16 v[100:101], v9 offset:57344
    v_mfma_f32_16x16x32_bf16 v[144:147], v[64:67], v[40:43], v[144:147]
    ds_read_b64_tr_b16 v[102:103], v9 offset:58368
    v_mfma_f32_16x16x32_bf16 v[148:151], v[64:67], v[44:47], v[148:151]
    ds_read_b128 v[88:91], v26 offset:16384
    v_mfma_f32_16x16x32_bf16 v[152:155], v[64:67], v[48:51], v[152:155]
    ds_read_b64_tr_b16 v[104:105], v11 offset:57344
    v_mfma_f32_16x16x32_bf16 v[156:159], v[64:67], v[52:55], v[156:159]
    ds_read_b64_tr_b16 v[106:107], v11 offset:58368
    v_mfma_f32_16x16x32_bf16 v[160:163], v[68:71], v[40:43], v[160:163]
    ds_read_b64_tr_b16 v[108:109], v17 offset:12288
    v_mfma_f32_16x16x32_bf16 v[164:167], v[68:71], v[44:47], v[164:167]
    ds_read_b64_tr_b16 v[110:111], v17 offset:12800
    v_mfma_f32_16x16x32_bf16 v[168:171], v[68:71], v[48:51], v[168:171]
    buffer_store_dwordx4 v[196:199], v223, s[40:43], s90 offen sc0 sc1
    v_mfma_f32_16x16x32_bf16 v[172:175], v[68:71], v[52:55], v[172:175]
    s_cmp_lg_u32 s50, 7
    s_cbranch_scc1 P1_GUQ_NL
    v_mov_b32 v30, 0
    buffer_load_dwordx2 v[238:239], v30, s[44:47], 0 offen offset:16 sc0 sc1
P1_GUQ_NL:
    v_mfma_f32_16x16x32_bf16 v[176:179], v[72:75], v[40:43], v[176:179]
    s_mul_i32 s58, s83, 3072
    s_add_u32 s58, s58, 98304
    s_add_u32 m0, s54, 32768
    s_nop 0
    buffer_load_dwordx4 v6, s[28:31], s58 offen lds
    v_mfma_f32_16x16x32_bf16 v[180:183], v[72:75], v[44:47], v[180:183]
    s_add_u32 m0, s54, 40960
    s_nop 0
    buffer_load_dwordx4 v6, s[32:35], s58 offen lds
    v_mfma_f32_16x16x32_bf16 v[184:187], v[72:75], v[48:51], v[184:187]
    s_mul_i32 s60, s83, 3840
    s_add_u32 m0, s54, 131072
    s_nop 0
    buffer_load_dwordx4 v8, s[36:39], s60 offen lds
    v_mfma_f32_16x16x32_bf16 v[188:191], v[72:75], v[52:55], v[188:191]
    s_waitcnt vmcnt(8) lgkmcnt(0)
    s_barrier
    v_mfma_f32_16x16x32_bf16 v[112:115], v[92:95], v[76:79], v[112:115]
    ds_read_b128 v[40:43], v19 offset:32768
    v_mfma_f32_16x16x32_bf16 v[116:119], v[92:95], v[80:83], v[116:119]
    ds_read_b64_tr_b16 v[56:57], v10 offset:0
    v_mfma_f32_16x16x32_bf16 v[120:123], v[92:95], v[84:87], v[120:123]
    ds_read_b64_tr_b16 v[58:59], v10 offset:1024
    v_mfma_f32_16x16x32_bf16 v[124:127], v[92:95], v[88:91], v[124:127]
    ds_read_b128 v[44:47], v21 offset:32768
    v_mfma_f32_16x16x32_bf16 v[128:131], v[96:99], v[76:79], v[128:131]
    ds_read_b64_tr_b16 v[60:61], v12 offset:0
    v_mfma_f32_16x16x32_bf16 v[132:135], v[96:99], v[80:83], v[132:135]
    ds_read_b64_tr_b16 v[62:63], v12 offset:1024
    v_mfma_f32_16x16x32_bf16 v[136:139], v[96:99], v[84:87], v[136:139]
    ds_read_b128 v[48:51], v23 offset:32768
    v_mfma_f32_16x16x32_bf16 v[140:143], v[96:99], v[88:91], v[140:143]
    ds_read_b64_tr_b16 v[64:65], v10 offset:8192
    v_mfma_f32_16x16x32_bf16 v[144:147], v[100:103], v[76:79], v[144:147]
    ds_read_b64_tr_b16 v[66:67], v10 offset:9216
    v_mfma_f32_16x16x32_bf16 v[148:151], v[100:103], v[80:83], v[148:151]
    v_mfma_f32_16x16x32_bf16 v[152:155], v[100:103], v[84:87], v[152:155]
    ds_read_b128 v[52:55], v25 offset:32768
    v_mfma_f32_16x16x32_bf16 v[156:159], v[100:103], v[88:91], v[156:159]
    ds_read_b64_tr_b16 v[68:69], v12 offset:8192
    v_mfma_f32_16x16x32_bf16 v[160:163], v[104:107], v[76:79], v[160:163]
    ds_read_b64_tr_b16 v[70:71], v12 offset:9216
    v_mfma_f32_16x16x32_bf16 v[164:167], v[104:107], v[80:83], v[164:167]
    ds_read_b64_tr_b16 v[72:73], v17 offset:16384
    v_mfma_f32_16x16x32_bf16 v[168:171], v[104:107], v[84:87], v[168:171]
    ds_read_b64_tr_b16 v[74:75], v17 offset:16896
    v_mfma_f32_16x16x32_bf16 v[172:175], v[104:107], v[88:91], v[172:175]
    s_mul_i32 s58, s84, 3072
    s_add_u32 m0, s54, 49152
    s_nop 0
    buffer_load_dwordx4 v6, s[28:31], s58 offen lds
    v_mfma_f32_16x16x32_bf16 v[176:179], v[108:111], v[76:79], v[176:179]
    s_add_u32 m0, s54, 57344
    s_nop 0
    buffer_load_dwordx4 v6, s[32:35], s58 offen lds
    v_mfma_f32_16x16x32_bf16 v[180:183], v[108:111], v[80:83], v[180:183]
    s_lshl_b32 s59, s84, 1
    s_add_u32 m0, s55, 98304
    s_nop 0
    buffer_load_dwordx4 v4, s[24:27], s59 offen lds
    v_mfma_f32_16x16x32_bf16 v[184:187], v[108:111], v[84:87], v[184:187]
    s_add_u32 m0, s55, 99328
    s_nop 0
    buffer_load_dwordx4 v5, s[24:27], s59 offen lds
    v_mfma_f32_16x16x32_bf16 v[188:191], v[108:111], v[88:91], v[188:191]
    s_waitcnt vmcnt(15) lgkmcnt(0)
    s_barrier
    v_mfma_f32_16x16x32_bf16 v[112:115], v[56:59], v[40:43], v[112:115]
    ds_read_b128 v[76:79], v20 offset:32768
    v_mfma_f32_16x16x32_bf16 v[116:119], v[56:59], v[44:47], v[116:119]
    ds_read_b64_tr_b16 v[92:93], v9 offset:0
    v_mfma_f32_16x16x32_bf16 v[120:123], v[56:59], v[48:51], v[120:123]
    ds_read_b64_tr_b16 v[94:95], v9 offset:1024
    v_mfma_f32_16x16x32_bf16 v[124:127], v[56:59], v[52:55], v[124:127]
    ds_read_b128 v[80:83], v22 offset:32768
    v_mfma_f32_16x16x32_bf16 v[128:131], v[60:63], v[40:43], v[128:131]
    ds_read_b64_tr_b16 v[96:97], v11 offset:0
    v_mfma_f32_16x16x32_bf16 v[132:135], v[60:63], v[44:47], v[132:135]
    ds_read_b64_tr_b16 v[98:99], v11 offset:1024
    v_mfma_f32_16x16x32_bf16 v[136:139], v[60:63], v[48:51], v[136:139]
    v_mfma_f32_16x16x32_bf16 v[140:143], v[60:63], v[52:55], v[140:143]
    ds_read_b128 v[84:87], v24 offset:32768
    v_mfma_f32_16x16x32_bf16 v[144:147], v[64:67], v[40:43], v[144:147]
    ds_read_b64_tr_b16 v[100:101], v9 offset:8192
    v_mfma_f32_16x16x32_bf16 v[148:151], v[64:67], v[44:47], v[148:151]
    ds_read_b64_tr_b16 v[102:103], v9 offset:9216
    v_mfma_f32_16x16x32_bf16 v[152:155], v[64:67], v[48:51], v[152:155]
    ds_read_b128 v[88:91], v26 offset:32768
    v_mfma_f32_16x16x32_bf16 v[156:159], v[64:67], v[52:55], v[156:159]
    ds_read_b64_tr_b16 v[104:105], v11 offset:8192
    v_mfma_f32_16x16x32_bf16 v[160:163], v[68:71], v[40:43], v[160:163]
    ds_read_b64_tr_b16 v[106:107], v11 offset:9216
    v_mfma_f32_16x16x32_bf16 v[164:167], v[68:71], v[44:47], v[164:167]
    v_mfma_f32_16x16x32_bf16 v[168:171], v[68:71], v[48:51], v[168:171]
    ds_read_b64_tr_b16 v[108:109], v17 offset:20480
    v_mfma_f32_16x16x32_bf16 v[172:175], v[68:71], v[52:55], v[172:175]
    ds_read_b64_tr_b16 v[110:111], v17 offset:20992
    v_mfma_f32_16x16x32_bf16 v[176:179], v[72:75], v[40:43], v[176:179]
    s_mul_i32 s58, s84, 3072
    s_add_u32 s58, s58, 98304
    s_add_u32 m0, s54, 65536
    s_nop 0
    buffer_load_dwordx4 v6, s[28:31], s58 offen lds
    v_mfma_f32_16x16x32_bf16 v[180:183], v[72:75], v[44:47], v[180:183]
    s_add_u32 m0, s54, 73728
    s_nop 0
    buffer_load_dwordx4 v6, s[32:35], s58 offen lds
    v_mfma_f32_16x16x32_bf16 v[184:187], v[72:75], v[48:51], v[184:187]
    s_mul_i32 s60, s84, 3840
    s_add_u32 m0, s54, 139264
    s_nop 0
    buffer_load_dwordx4 v8, s[36:39], s60 offen lds
    v_mfma_f32_16x16x32_bf16 v[188:191], v[72:75], v[52:55], v[188:191]
    s_waitcnt vmcnt(7) lgkmcnt(0)
    s_barrier
    v_mfma_f32_16x16x32_bf16 v[112:115], v[92:95], v[76:79], v[112:115]
    ds_read_b128 v[40:43], v19 offset:0
    v_mfma_f32_16x16x32_bf16 v[116:119], v[92:95], v[80:83], v[116:119]
    ds_read_b64_tr_b16 v[56:57], v9 offset:16384
    v_mfma_f32_16x16x32_bf16 v[120:123], v[92:95], v[84:87], v[120:123]
    ds_read_b64_tr_b16 v[58:59], v9 offset:17408
    v_mfma_f32_16x16x32_bf16 v[124:127], v[92:95], v[88:91], v[124:127]
    ds_read_b128 v[44:47], v21 offset:0
    v_mfma_f32_16x16x32_bf16 v[128:131], v[96:99], v[76:79], v[128:131]
    ds_read_b64_tr_b16 v[60:61], v11 offset:16384
    v_mfma_f32_16x16x32_bf16 v[132:135], v[96:99], v[80:83], v[132:135]
    ds_read_b64_tr_b16 v[62:63], v11 offset:17408
    v_mfma_f32_16x16x32_bf16 v[136:139], v[96:99], v[84:87], v[136:139]
    ds_read_b128 v[48:51], v23 offset:0
    v_mfma_f32_16x16x32_bf16 v[140:143], v[96:99], v[88:91], v[140:143]
    ds_read_b64_tr_b16 v[64:65], v9 offset:24576
    v_mfma_f32_16x16x32_bf16 v[144:147], v[100:103], v[76:79], v[144:147]
    ds_read_b64_tr_b16 v[66:67], v9 offset:25600
    v_mfma_f32_16x16x32_bf16 v[148:151], v[100:103], v[80:83], v[148:151]
    v_mfma_f32_16x16x32_bf16 v[152:155], v[100:103], v[84:87], v[152:155]
    ds_read_b128 v[52:55], v25 offset:0
    v_mfma_f32_16x16x32_bf16 v[156:159], v[100:103], v[88:91], v[156:159]
    ds_read_b64_tr_b16 v[68:69], v11 offset:24576
    v_mfma_f32_16x16x32_bf16 v[160:163], v[104:107], v[76:79], v[160:163]
    ds_read_b64_tr_b16 v[70:71], v11 offset:25600
    v_mfma_f32_16x16x32_bf16 v[164:167], v[104:107], v[80:83], v[164:167]
    ds_read_b64_tr_b16 v[72:73], v17 offset:0
    v_mfma_f32_16x16x32_bf16 v[168:171], v[104:107], v[84:87], v[168:171]
    ds_read_b64_tr_b16 v[74:75], v17 offset:512
    v_mfma_f32_16x16x32_bf16 v[172:175], v[104:107], v[88:91], v[172:175]
    s_mul_i32 s58, s85, 3072
    s_add_u32 m0, s54, 0
    s_nop 0
    buffer_load_dwordx4 v6, s[28:31], s58 offen lds
    v_mfma_f32_16x16x32_bf16 v[176:179], v[108:111], v[76:79], v[176:179]
    s_add_u32 m0, s54, 8192
    s_nop 0
    buffer_load_dwordx4 v6, s[32:35], s58 offen lds
    v_mfma_f32_16x16x32_bf16 v[180:183], v[108:111], v[80:83], v[180:183]
    s_lshl_b32 s59, s85, 1
    s_add_u32 m0, s55, 114688
    s_nop 0
    buffer_load_dwordx4 v4, s[24:27], s59 offen lds
    v_mfma_f32_16x16x32_bf16 v[184:187], v[108:111], v[84:87], v[184:187]
    s_add_u32 m0, s55, 115712
    s_nop 0
    buffer_load_dwordx4 v5, s[24:27], s59 offen lds
    v_mfma_f32_16x16x32_bf16 v[188:191], v[108:111], v[88:91], v[188:191]
    s_waitcnt vmcnt(11) lgkmcnt(0)
    s_barrier
    s_cmp_lg_u32 s50, 7
    s_cbranch_scc1 P1_GUQ_NC_DONE
P1_GUQ_NC:
    v_readfirstlane_b32 s61, v238
    s_nop 1
    s_cmp_lg_u32 s61, 0
    s_cbranch_scc1 P1_GUQ_NC_OK
    s_add_u32 s3, s3, 1
    s_cmp_gt_u32 s3, 0x200000
    s_cbranch_scc1 K_END
    s_sleep 2
    v_mov_b32 v30, 0
    buffer_load_dwordx2 v[238:239], v30, s[44:47], 0 offen offset:16 sc0 sc1
    s_waitcnt vmcnt(0)
    s_branch P1_GUQ_NC
P1_GUQ_NC_OK:
    v_mov_b32 v30, 162048
    v_mov_b32 v31, 0
    ds_write_b64 v30, v[238:239]
    s_mov_b64 exec, 1
    buffer_store_dwordx2 v[238:239], v31, s[40:43], s100 offen sc0 sc1
    s_mov_b64 exec, -1
P1_GUQ_NC_DONE:
    v_mfma_f32_16x16x32_bf16 v[112:115], v[56:59], v[40:43], v[112:115]
    ds_read_b128 v[76:79], v20 offset:0
    v_mfma_f32_16x16x32_bf16 v[116:119], v[56:59], v[44:47], v[116:119]
    ds_read_b64_tr_b16 v[92:93], v9 offset:32768
    v_mfma_f32_16x16x32_bf16 v[120:123], v[56:59], v[48:51], v[120:123]
    ds_read_b64_tr_b16 v[94:95], v9 offset:33792
    v_mfma_f32_16x16x32_bf16 v[124:127], v[56:59], v[52:55], v[124:127]
    ds_read_b128 v[80:83], v22 offset:0
    v_mfma_f32_16x16x32_bf16 v[128:131], v[60:63], v[40:43], v[128:131]
    ds_read_b64_tr_b16 v[96:97], v11 offset:32768
    v_mfma_f32_16x16x32_bf16 v[132:135], v[60:63], v[44:47], v[132:135]
    ds_read_b64_tr_b16 v[98:99], v11 offset:33792
    v_mfma_f32_16x16x32_bf16 v[136:139], v[60:63], v[48:51], v[136:139]
    ds_read_b128 v[84:87], v24 offset:0
    v_mfma_f32_16x16x32_bf16 v[140:143], v[60:63], v[52:55], v[140:143]
    ds_read_b64_tr_b16 v[100:101], v9 offset:40960
    v_mfma_f32_16x16x32_bf16 v[144:147], v[64:67], v[40:43], v[144:147]
    ds_read_b64_tr_b16 v[102:103], v9 offset:41984
    v_mfma_f32_16x16x32_bf16 v[148:151], v[64:67], v[44:47], v[148:151]
    ds_read_b128 v[88:91], v26 offset:0
    v_mfma_f32_16x16x32_bf16 v[152:155], v[64:67], v[48:51], v[152:155]
    ds_read_b64_tr_b16 v[104:105], v11 offset:40960
    v_mfma_f32_16x16x32_bf16 v[156:159], v[64:67], v[52:55], v[156:159]
    ds_read_b64_tr_b16 v[106:107], v11 offset:41984
    v_mfma_f32_16x16x32_bf16 v[160:163], v[68:71], v[40:43], v[160:163]
    ds_read_b64_tr_b16 v[108:109], v17 offset:4096
    v_mfma_f32_16x16x32_bf16 v[164:167], v[68:71], v[44:47], v[164:167]
    ds_read_b64_tr_b16 v[110:111], v17 offset:4608
    v_mfma_f32_16x16x32_bf16 v[168:171], v[68:71], v[48:51], v[168:171]
    s_mul_i32 s58, s85, 3072
    s_add_u32 s58, s58, 98304
    s_add_u32 m0, s54, 16384
    s_nop 0
    buffer_load_dwordx4 v6, s[28:31], s58 offen lds
    v_mfma_f32_16x16x32_bf16 v[172:175], v[68:71], v[52:55], v[172:175]
    s_add_u32 m0, s54, 24576
    s_nop 0
    buffer_load_dwordx4 v6, s[32:35], s58 offen lds
    v_mfma_f32_16x16x32_bf16 v[176:179], v[72:75], v[40:43], v[176:179]
    s_mul_i32 s60, s85, 3840
    s_add_u32 m0, s54, 147456
    s_nop 0
    buffer_load_dwordx4 v8, s[36:39], s60 offen lds
    v_mfma_f32_16x16x32_bf16 v[180:183], v[72:75], v[44:47], v[180:183]
    v_mfma_f32_16x16x32_bf16 v[192:195], v[244:247], v[40:43], 0
    v_mfma_f32_16x16x32_bf16 v[184:187], v[72:75], v[48:51], v[184:187]
    v_mfma_f32_16x16x32_bf16 v[196:199], v[40:43], v[40:43], 0
    v_mfma_f32_16x16x32_bf16 v[188:191], v[72:75], v[52:55], v[188:191]
    s_cbranch_vccnz P1_GUQ_cs6
    v_mfma_f32_16x16x32_bf16 v[200:203], v[244:247], v[56:59], 0
    v_mfma_f32_16x16x32_bf16 v[204:207], v[244:247], v[60:63], 0
    v_mfma_f32_16x16x32_bf16 v[208:211], v[244:247], v[64:67], 0
    v_mfma_f32_16x16x32_bf16 v[212:215], v[244:247], v[68:71], 0
    v_mfma_f32_16x16x32_bf16 v[216:219], v[244:247], v[72:75], 0
P1_GUQ_cs6:
    s_waitcnt vmcnt(7) lgkmcnt(0)
    s_barrier
    v_mfma_f32_16x16x32_bf16 v[112:115], v[92:95], v[76:79], v[112:115]
    ds_read_b128 v[40:43], v19 offset:16384
    ds_read_b64_tr_b16 v[56:57], v9 offset:49152
    v_mfma_f32_16x16x32_bf16 v[116:119], v[92:95], v[80:83], v[116:119]
    ds_read_b64_tr_b16 v[58:59], v9 offset:50176
    v_mfma_f32_16x16x32_bf16 v[120:123], v[92:95], v[84:87], v[120:123]
    ds_read_b128 v[44:47], v21 offset:16384
    v_mfma_f32_16x16x32_bf16 v[124:127], v[92:95], v[88:91], v[124:127]
    ds_read_b64_tr_b16 v[60:61], v11 offset:49152
    v_mfma_f32_16x16x32_bf16 v[128:131], v[96:99], v[76:79], v[128:131]
    ds_read_b64_tr_b16 v[62:63], v11 offset:50176
    v_mfma_f32_16x16x32_bf16 v[132:135], v[96:99], v[80:83], v[132:135]
    ds_read_b128 v[48:51], v23 offset:16384
    v_mfma_f32_16x16x32_bf16 v[136:139], v[96:99], v[84:87], v[136:139]
    ds_read_b64_tr_b16 v[64:65], v9 offset:57344
    v_mfma_f32_16x16x32_bf16 v[140:143], v[96:99], v[88:91], v[140:143]
    ds_read_b64_tr_b16 v[66:67], v9 offset:58368
    v_mfma_f32_16x16x32_bf16 v[144:147], v[100:103], v[76:79], v[144:147]
    ds_read_b128 v[52:55], v25 offset:16384
    v_mfma_f32_16x16x32_bf16 v[148:151], v[100:103], v[80:83], v[148:151]
    ds_read_b64_tr_b16 v[68:69], v11 offset:57344
    v_mfma_f32_16x16x32_bf16 v[152:155], v[100:103], v[84:87], v[152:155]
    ds_read_b64_tr_b16 v[70:71], v11 offset:58368
    v_mfma_f32_16x16x32_bf16 v[156:159], v[100:103], v[88:91], v[156:159]
    ds_read_b64_tr_b16 v[72:73], v17 offset:8192
    v_mfma_f32_16x16x32_bf16 v[160:163], v[104:107], v[76:79], v[160:163]
    ds_read_b64_tr_b16 v[74:75], v17 offset:8704
    v_mfma_f32_16x16x32_bf16 v[164:167], v[104:107], v[80:83], v[164:167]
    v_mov_b32 v35, 162048
    ds_read_b64 v[238:239], v35
    v_mfma_f32_16x16x32_bf16 v[168:171], v[104:107], v[84:87], v[168:171]
    s_mul_i32 s58, s86, 3072
    s_add_u32 m0, s54, 32768
    s_nop 0
    buffer_load_dwordx4 v6, s[28:31], s58 offen lds
    v_mfma_f32_16x16x32_bf16 v[172:175], v[104:107], v[88:91], v[172:175]
    s_add_u32 m0, s54, 40960
    s_nop 0
    buffer_load_dwordx4 v6, s[32:35], s58 offen lds
    v_mfma_f32_16x16x32_bf16 v[176:179], v[108:111], v[76:79], v[176:179]
    s_lshl_b32 s59, s86, 1
    s_add_u32 m0, s55, 81920
    s_nop 0
    buffer_load_dwordx4 v4, s[24:27], s59 offen lds
    v_mfma_f32_16x16x32_bf16 v[180:183], v[108:111], v[80:83], v[180:183]
    s_add_u32 m0, s55, 82944
    s_nop 0
    buffer_load_dwordx4 v5, s[24:27], s59 offen lds
    v_mfma_f32_16x16x32_bf16 v[184:187], v[108:111], v[84:87], v[184:187]
    v_mfma_f32_16x16x32_bf16 v[192:195], v[244:247], v[76:79], v[192:195]
    v_mfma_f32_16x16x32_bf16 v[188:191], v[108:111], v[88:91], v[188:191]
    v_mfma_f32_16x16x32_bf16 v[196:199], v[76:79], v[76:79], v[196:199]
    s_cbranch_vccz P1_GUQ_cs7
    v_mfma_f32_16x16x32_bf16 v[200:203], v[244:247], v[92:95], 0
    v_mfma_f32_16x16x32_bf16 v[204:207], v[244:247], v[96:99], 0
    v_mfma_f32_16x16x32_bf16 v[208:211], v[244:247], v[100:103], 0
    v_mfma_f32_16x16x32_bf16 v[212:215], v[244:247], v[104:107], 0
    v_mfma_f32_16x16x32_bf16 v[216:219], v[244:247], v[108:111], 0
P1_GUQ_cs7:
    s_waitcnt vmcnt(11) lgkmcnt(0)
    s_barrier
    v_mfma_f32_16x16x32_bf16 v[112:115], v[56:59], v[40:43], v[112:115]
    ds_read_b128 v[76:79], v20 offset:16384
    ds_read_b64_tr_b16 v[92:93], v10 offset:0
    v_mfma_f32_16x16x32_bf16 v[116:119], v[56:59], v[44:47], v[116:119]
    ds_read_b64_tr_b16 v[94:95], v10 offset:1024
    v_mfma_f32_16x16x32_bf16 v[120:123], v[56:59], v[48:51], v[120:123]
    ds_read_b128 v[80:83], v22 offset:16384
    v_mfma_f32_16x16x32_bf16 v[124:127], v[56:59], v[52:55], v[124:127]
    ds_read_b64_tr_b16 v[96:97], v12 offset:0
    v_mfma_f32_16x16x32_bf16 v[128:131], v[60:63], v[40:43], v[128:131]
    ds_read_b64_tr_b16 v[98:99], v12 offset:1024
    v_mfma_f32_16x16x32_bf16 v[132:135], v[60:63], v[44:47], v[132:135]
    ds_read_b128 v[84:87], v24 offset:16384
    v_mfma_f32_16x16x32_bf16 v[136:139], v[60:63], v[48:51], v[136:139]
    ds_read_b64_tr_b16 v[100:101], v10 offset:8192
    v_mfma_f32_16x16x32_bf16 v[140:143], v[60:63], v[52:55], v[140:143]
    ds_read_b64_tr_b16 v[102:103], v10 offset:9216
    v_mfma_f32_16x16x32_bf16 v[144:147], v[64:67], v[40:43], v[144:147]
    ds_read_b128 v[88:91], v26 offset:16384
    v_mfma_f32_16x16x32_bf16 v[148:151], v[64:67], v[44:47], v[148:151]
    ds_read_b64_tr_b16 v[104:105], v12 offset:8192
    v_mfma_f32_16x16x32_bf16 v[152:155], v[64:67], v[48:51], v[152:155]
    ds_read_b64_tr_b16 v[106:107], v12 offset:9216
    ds_read_b64_tr_b16 v[108:109], v17 offset:12288
    v_mfma_f32_16x16x32_bf16 v[156:159], v[64:67], v[52:55], v[156:159]
    ds_read_b64_tr_b16 v[110:111], v17 offset:12800
    v_mfma_f32_16x16x32_bf16 v[160:163], v[68:71], v[40:43], v[160:163]
    v_and_b32 v32, 3, v2
    v_cmp_eq_u32 s[62:63], 1, v32
    v_cmp_eq_u32 s[64:65], 2, v32
    v_cmp_eq_u32 s[66:67], 3, v32
    v_lshrrev_b32 v32, 2, v2
    v_cndmask_b32 v193, v196, v197, s[62:63]
    v_cndmask_b32 v193, v193, v198, s[64:65]
    v_cndmask_b32 v193, v193, v199, s[66:67]
    v_cmp_eq_u32 s[62:63], v32, v3
    v_mfma_f32_16x16x32_bf16 v[164:167], v[68:71], v[44:47], v[164:167]
    s_lshl_b32 s61, s48, 4
    s_add_u32 s61, s61, s49
    s_lshl_b32 s61, s61, 10
    s_lshl_b32 s64, s50, 7
    s_add_u32 s61, s61, s64
    s_add_u32 s61, s61, 11763712
    v_lshlrev_b32 v30, 3, v2
    s_mov_b64 exec, s[62:63]
    buffer_store_dwordx2 v[192:193], v30, s[40:43], s61 offen sc0 sc1
    s_mov_b64 exec, -1
    v_mfma_f32_16x16x32_bf16 v[168:171], v[68:71], v[48:51], v[168:171]
    v_cmp_eq_u32 s[62:63], 1, v3
    v_cmp_eq_u32 s[64:65], 2, v3
    v_cmp_eq_u32 s[66:67], 3, v3
    s_lshl_b32 s61, s49, 2
    s_add_u32 s61, s61, s52
    s_lshl_b32 s61, s61, 4
    s_add_u32 s61, s61, s48
    s_lshl_b32 s61, s61, 1
    s_add_u32 s61, s61, s51
    s_lshl_b32 s61, s61, 9
    s_add_u32 s61, s61, 12025856
    v_cndmask_b32 v31, v200, v204, s[62:63]
    v_cndmask_b32 v31, v31, v208, s[64:65]
    v_cndmask_b32 v31, v31, v212, s[66:67]
    v_lshlrev_b32 v30, 2, v1
    buffer_store_dword v31, v30, s[40:43], s61 offen sc0 sc1
    v_mfma_f32_16x16x32_bf16 v[172:175], v[68:71], v[52:55], v[172:175]
    s_mov_b32 exec_hi, 0
    buffer_store_dword v216, v30, s[40:43], s61 offen offset:256 sc0 sc1
    s_mov_b64 exec, -1
    v_mfma_f32_16x16x32_bf16 v[176:179], v[72:75], v[40:43], v[176:179]
    v_readfirstlane_b32 s92, v238
    v_readfirstlane_b32 s93, v239
    v_mfma_f32_16x16x32_bf16 v[180:183], v[72:75], v[44:47], v[180:183]
    s_mul_i32 s58, s86, 3072
    s_add_u32 s58, s58, 98304
    s_add_u32 m0, s54, 49152
    s_nop 0
    buffer_load_dwordx4 v6, s[28:31], s58 offen lds
    v_mfma_f32_16x16x32_bf16 v[184:187], v[72:75], v[48:51], v[184:187]
    s_add_u32 m0, s54, 57344
    s_nop 0
    buffer_load_dwordx4 v6, s[32:35], s58 offen lds
    v_mfma_f32_16x16x32_bf16 v[188:191], v[72:75], v[52:55], v[188:191]
    s_mul_i32 s60, s86, 3840
    s_add_u32 m0, s54, 131072
    s_nop 0
    buffer_load_dwordx4 v8, s[36:39], s60 offen lds
    s_waitcnt vmcnt(10) lgkmcnt(0)
    s_barrier
    v_mfma_f32_16x16x32_bf16 v[112:115], v[92:95], v[76:79], v[112:115]
    ds_read_b128 v[40:43], v19 offset:32768
    v_mfma_f32_16x16x32_bf16 v[116:119], v[92:95], v[80:83], v[116:119]
    ds_read_b64_tr_b16 v[56:57], v9 offset:0
    v_mfma_f32_16x16x32_bf16 v[120:123], v[92:95], v[84:87], v[120:123]
    ds_read_b64_tr_b16 v[58:59], v9 offset:1024
    v_mfma_f32_16x16x32_bf16 v[124:127], v[92:95], v[88:91], v[124:127]
    ds_read_b128 v[44:47], v21 offset:32768
    v_mfma_f32_16x16x32_bf16 v[128:131], v[96:99], v[76:79], v[128:131]
    ds_read_b64_tr_b16 v[60:61], v11 offset:0
    v_mfma_f32_16x16x32_bf16 v[132:135], v[96:99], v[80:83], v[132:135]
    ds_read_b64_tr_b16 v[62:63], v11 offset:1024
    v_mfma_f32_16x16x32_bf16 v[136:139], v[96:99], v[84:87], v[136:139]
    ds_read_b128 v[48:51], v23 offset:32768
    v_mfma_f32_16x16x32_bf16 v[140:143], v[96:99], v[88:91], v[140:143]
    ds_read_b64_tr_b16 v[64:65], v9 offset:8192
    v_mfma_f32_16x16x32_bf16 v[144:147], v[100:103], v[76:79], v[144:147]
    ds_read_b64_tr_b16 v[66:67], v9 offset:9216
    v_mfma_f32_16x16x32_bf16 v[148:151], v[100:103], v[80:83], v[148:151]
    v_mfma_f32_16x16x32_bf16 v[152:155], v[100:103], v[84:87], v[152:155]
    ds_read_b128 v[52:55], v25 offset:32768
    v_mfma_f32_16x16x32_bf16 v[156:159], v[100:103], v[88:91], v[156:159]
    ds_read_b64_tr_b16 v[68:69], v11 offset:8192
    v_mfma_f32_16x16x32_bf16 v[160:163], v[104:107], v[76:79], v[160:163]
    ds_read_b64_tr_b16 v[70:71], v11 offset:9216
    v_mfma_f32_16x16x32_bf16 v[164:167], v[104:107], v[80:83], v[164:167]
    ds_read_b64_tr_b16 v[72:73], v17 offset:16384
    v_mfma_f32_16x16x32_bf16 v[168:171], v[104:107], v[84:87], v[168:171]
    ds_read_b64_tr_b16 v[74:75], v17 offset:16896
    v_mfma_f32_16x16x32_bf16 v[172:175], v[104:107], v[88:91], v[172:175]
    s_mul_i32 s58, s87, 3072
    s_add_u32 m0, s54, 65536
    s_nop 0
    buffer_load_dwordx4 v6, s[28:31], s58 offen lds
    v_mfma_f32_16x16x32_bf16 v[176:179], v[108:111], v[76:79], v[176:179]
    s_add_u32 m0, s54, 73728
    s_nop 0
    buffer_load_dwordx4 v6, s[32:35], s58 offen lds
    v_mfma_f32_16x16x32_bf16 v[180:183], v[108:111], v[80:83], v[180:183]
    s_lshl_b32 s59, s87, 1
    s_add_u32 m0, s55, 98304
    s_nop 0
    buffer_load_dwordx4 v4, s[24:27], s59 offen lds
    v_mfma_f32_16x16x32_bf16 v[184:187], v[108:111], v[84:87], v[184:187]
    s_add_u32 m0, s55, 99328
    s_nop 0
    buffer_load_dwordx4 v5, s[24:27], s59 offen lds
    v_mfma_f32_16x16x32_bf16 v[188:191], v[108:111], v[88:91], v[188:191]
    s_waitcnt vmcnt(7) lgkmcnt(0)
    s_barrier
    s_cmp_lg_u32 s50, 7
    s_cbranch_scc1 P1_GUQ_SIG
    s_lshl_b32 s61, s48, 7
    s_lshl_b32 s62, s49, 3
    s_add_u32 s61, s61, s62
    s_add_u32 s61, s61, 13097984
    v_mov_b32 v31, 0
    v_mov_b32 v32, s92
    v_mov_b32 v33, s93
    s_mov_b64 exec, 1
    buffer_store_dwordx2 v[32:33], v31, s[40:43], s61 offen sc0 sc1
    s_lshl_b32 s61, s49, 7
    s_lshl_b32 s62, s48, 3
    s_add_u32 s61, s61, s62
    s_add_u32 s61, s61, 13100032
    buffer_store_dwordx2 v[32:33], v31, s[40:43], s61 offen sc0 sc1
    s_mov_b64 exec, -1
P1_GUQ_SIG:
    v_mfma_f32_16x16x32_bf16 v[112:115], v[56:59], v[40:43], v[112:115]
    ds_read_b128 v[76:79], v20 offset:32768
    v_mfma_f32_16x16x32_bf16 v[116:119], v[56:59], v[44:47], v[116:119]
    ds_read_b64_tr_b16 v[92:93], v9 offset:16384
    v_mfma_f32_16x16x32_bf16 v[120:123], v[56:59], v[48:51], v[120:123]
    ds_read_b64_tr_b16 v[94:95], v9 offset:17408
    v_mfma_f32_16x16x32_bf16 v[124:127], v[56:59], v[52:55], v[124:127]
    ds_read_b128 v[80:83], v22 offset:32768
    v_mfma_f32_16x16x32_bf16 v[128:131], v[60:63], v[40:43], v[128:131]
    ds_read_b64_tr_b16 v[96:97], v11 offset:16384
    v_mfma_f32_16x16x32_bf16 v[132:135], v[60:63], v[44:47], v[132:135]
    ds_read_b64_tr_b16 v[98:99], v11 offset:17408
    v_mfma_f32_16x16x32_bf16 v[136:139], v[60:63], v[48:51], v[136:139]
    v_mfma_f32_16x16x32_bf16 v[140:143], v[60:63], v[52:55], v[140:143]
    ds_read_b128 v[84:87], v24 offset:32768
    v_mfma_f32_16x16x32_bf16 v[144:147], v[64:67], v[40:43], v[144:147]
    ds_read_b64_tr_b16 v[100:101], v9 offset:24576
    v_mfma_f32_16x16x32_bf16 v[148:151], v[64:67], v[44:47], v[148:151]
    ds_read_b64_tr_b16 v[102:103], v9 offset:25600
    v_mfma_f32_16x16x32_bf16 v[152:155], v[64:67], v[48:51], v[152:155]
    ds_read_b128 v[88:91], v26 offset:32768
    v_mfma_f32_16x16x32_bf16 v[156:159], v[64:67], v[52:55], v[156:159]
    ds_read_b64_tr_b16 v[104:105], v11 offset:24576
    v_mfma_f32_16x16x32_bf16 v[160:163], v[68:71], v[40:43], v[160:163]
    ds_read_b64_tr_b16 v[106:107], v11 offset:25600
    v_mfma_f32_16x16x32_bf16 v[164:167], v[68:71], v[44:47], v[164:167]
    v_mfma_f32_16x16x32_bf16 v[168:171], v[68:71], v[48:51], v[168:171]
    ds_read_b64_tr_b16 v[108:109], v17 offset:20480
    v_mfma_f32_16x16x32_bf16 v[172:175], v[68:71], v[52:55], v[172:175]
    ds_read_b64_tr_b16 v[110:111], v17 offset:20992
    v_mfma_f32_16x16x32_bf16 v[176:179], v[72:75], v[40:43], v[176:179]
    s_mul_i32 s58, s87, 3072
    s_add_u32 s58, s58, 98304
    s_add_u32 m0, s54, 0
    s_nop 0
    buffer_load_dwordx4 v6, s[28:31], s58 offen lds
    v_mfma_f32_16x16x32_bf16 v[180:183], v[72:75], v[44:47], v[180:183]
    s_add_u32 m0, s54, 8192
    s_nop 0
    buffer_load_dwordx4 v6, s[32:35], s58 offen lds
    v_mfma_f32_16x16x32_bf16 v[184:187], v[72:75], v[48:51], v[184:187]
    s_mul_i32 s60, s87, 3840
    s_add_u32 m0, s54, 139264
    s_nop 0
    buffer_load_dwordx4 v8, s[36:39], s60 offen lds
    v_mfma_f32_16x16x32_bf16 v[188:191], v[72:75], v[52:55], v[188:191]
    s_waitcnt vmcnt(7) lgkmcnt(0)
    s_barrier
    v_mfma_f32_16x16x32_bf16 v[112:115], v[92:95], v[76:79], v[112:115]
    ds_read_b128 v[40:43], v19 offset:0
    v_mfma_f32_16x16x32_bf16 v[116:119], v[92:95], v[80:83], v[116:119]
    ds_read_b64_tr_b16 v[56:57], v9 offset:32768
    v_mfma_f32_16x16x32_bf16 v[120:123], v[92:95], v[84:87], v[120:123]
    ds_read_b64_tr_b16 v[58:59], v9 offset:33792
    v_mfma_f32_16x16x32_bf16 v[124:127], v[92:95], v[88:91], v[124:127]
    ds_read_b128 v[44:47], v21 offset:0
    v_mfma_f32_16x16x32_bf16 v[128:131], v[96:99], v[76:79], v[128:131]
    ds_read_b64_tr_b16 v[60:61], v11 offset:32768
    v_mfma_f32_16x16x32_bf16 v[132:135], v[96:99], v[80:83], v[132:135]
    ds_read_b64_tr_b16 v[62:63], v11 offset:33792
    v_mfma_f32_16x16x32_bf16 v[136:139], v[96:99], v[84:87], v[136:139]
    ds_read_b128 v[48:51], v23 offset:0
    v_mfma_f32_16x16x32_bf16 v[140:143], v[96:99], v[88:91], v[140:143]
    ds_read_b64_tr_b16 v[64:65], v9 offset:40960
    v_mfma_f32_16x16x32_bf16 v[144:147], v[100:103], v[76:79], v[144:147]
    ds_read_b64_tr_b16 v[66:67], v9 offset:41984
    v_mfma_f32_16x16x32_bf16 v[148:151], v[100:103], v[80:83], v[148:151]
    ds_read_b128 v[52:55], v25 offset:0
    v_mfma_f32_16x16x32_bf16 v[152:155], v[100:103], v[84:87], v[152:155]
    ds_read_b64_tr_b16 v[68:69], v11 offset:40960
    v_mfma_f32_16x16x32_bf16 v[156:159], v[100:103], v[88:91], v[156:159]
    ds_read_b64_tr_b16 v[70:71], v11 offset:41984
    v_mfma_f32_16x16x32_bf16 v[160:163], v[104:107], v[76:79], v[160:163]
    ds_read_b64_tr_b16 v[72:73], v17 offset:0
    v_mfma_f32_16x16x32_bf16 v[164:167], v[104:107], v[80:83], v[164:167]
    ds_read_b64_tr_b16 v[74:75], v17 offset:512
    v_mfma_f32_16x16x32_bf16 v[168:171], v[104:107], v[84:87], v[168:171]
    s_and_b32 s61, s2, 1
    s_lshl_b32 s61, s61, 2
    s_lshr_b32 s62, s2, 6
    s_add_u32 s61, s61, s62
    s_lshr_b32 s94, s61, 1
    s_lshl_b32 s94, s94, 9
    s_mul_i32 s62, s52, 96
    s_add_u32 s94, s94, s62
    s_add_u32 s94, s94, 13090816
    s_lshl_b32 s61, s61, 7
    s_lshl_b32 s62, s52, 3
    s_add_u32 s61, s61, s62
    s_add_u32 s61, s61, 13092864
    s_cmp_lg_u32 s51, 0
    s_cselect_b32 s94, s61, s94
    s_cselect_b32 s96, 1, 0xfff
    s_mov_b32 s97, 0
    v_lshlrev_b32 v240, 3, v1
    s_mov_b64 exec, s[96:97]
    buffer_load_dwordx2 v[238:239], v240, s[40:43], s94 offen sc0 sc1
    s_mov_b64 exec, -1
    v_mfma_f32_16x16x32_bf16 v[172:175], v[104:107], v[88:91], v[172:175]
    s_mul_i32 s58, s88, 3072
    s_add_u32 m0, s54, 16384
    s_nop 0
    buffer_load_dwordx4 v6, s[28:31], s58 offen lds
    v_mfma_f32_16x16x32_bf16 v[176:179], v[108:111], v[76:79], v[176:179]
    s_add_u32 m0, s54, 24576
    s_nop 0
    buffer_load_dwordx4 v6, s[32:35], s58 offen lds
    v_mfma_f32_16x16x32_bf16 v[180:183], v[108:111], v[80:83], v[180:183]
    s_lshl_b32 s59, s88, 1
    s_add_u32 m0, s55, 114688
    s_nop 0
    buffer_load_dwordx4 v4, s[24:27], s59 offen lds
    v_mfma_f32_16x16x32_bf16 v[184:187], v[108:111], v[84:87], v[184:187]
    s_add_u32 m0, s55, 115712
    s_nop 0
    buffer_load_dwordx4 v5, s[24:27], s59 offen lds
    v_mfma_f32_16x16x32_bf16 v[188:191], v[108:111], v[88:91], v[188:191]
    s_waitcnt vmcnt(12) lgkmcnt(0)
    s_barrier
    v_mfma_f32_16x16x32_bf16 v[112:115], v[56:59], v[40:43], v[112:115]
    ds_read_b128 v[76:79], v20 offset:0
    v_mfma_f32_16x16x32_bf16 v[116:119], v[56:59], v[44:47], v[116:119]
    ds_read_b64_tr_b16 v[92:93], v9 offset:49152
    v_mfma_f32_16x16x32_bf16 v[120:123], v[56:59], v[48:51], v[120:123]
    ds_read_b64_tr_b16 v[94:95], v9 offset:50176
    v_mfma_f32_16x16x32_bf16 v[124:127], v[56:59], v[52:55], v[124:127]
    ds_read_b128 v[80:83], v22 offset:0
    v_mfma_f32_16x16x32_bf16 v[128:131], v[60:63], v[40:43], v[128:131]
    ds_read_b64_tr_b16 v[96:97], v11 offset:49152
    v_mfma_f32_16x16x32_bf16 v[132:135], v[60:63], v[44:47], v[132:135]
    ds_read_b64_tr_b16 v[98:99], v11 offset:50176
    v_mfma_f32_16x16x32_bf16 v[136:139], v[60:63], v[48:51], v[136:139]
    ds_read_b128 v[84:87], v24 offset:0
    v_mfma_f32_16x16x32_bf16 v[140:143], v[60:63], v[52:55], v[140:143]
    ds_read_b64_tr_b16 v[100:101], v9 offset:57344
    v_mfma_f32_16x16x32_bf16 v[144:147], v[64:67], v[40:43], v[144:147]
    ds_read_b64_tr_b16 v[102:103], v9 offset:58368
    v_mfma_f32_16x16x32_bf16 v[148:151], v[64:67], v[44:47], v[148:151]
    v_mfma_f32_16x16x32_bf16 v[152:155], v[64:67], v[48:51], v[152:155]
    ds_read_b128 v[88:91], v26 offset:0
    v_mfma_f32_16x16x32_bf16 v[156:159], v[64:67], v[52:55], v[156:159]
    ds_read_b64_tr_b16 v[104:105], v11 offset:57344
    v_mfma_f32_16x16x32_bf16 v[160:163], v[68:71], v[40:43], v[160:163]
    ds_read_b64_tr_b16 v[106:107], v11 offset:58368
    v_mfma_f32_16x16x32_bf16 v[164:167], v[68:71], v[44:47], v[164:167]
    ds_read_b64_tr_b16 v[108:109], v17 offset:4096
    v_mfma_f32_16x16x32_bf16 v[168:171], v[68:71], v[48:51], v[168:171]
    ds_read_b64_tr_b16 v[110:111], v17 offset:4608
    v_mfma_f32_16x16x32_bf16 v[172:175], v[68:71], v[52:55], v[172:175]
    s_lshl_b32 s68, s48, 7
    s_add_u32 s68, s68, 13097984
    s_lshl_b32 s61, s49, 7
    s_add_u32 s62, s61, 13100032
    s_add_u32 s61, s61, 13102080
    s_cmp_lt_u32 s50, 2
    s_cselect_b32 s68, s68, s62
    s_cmp_ge_u32 s50, 6
    s_cselect_b32 s68, s61, s68
    s_cselect_b32 s98, 1, 0x3ff
    s_mov_b32 s99, 0
    s_mov_b64 exec, s[98:99]
    buffer_load_dwordx2 v[232:233], v240, s[40:43], s68 offen sc0 sc1
    s_mov_b64 exec, -1
    v_mfma_f32_16x16x32_bf16 v[176:179], v[72:75], v[40:43], v[176:179]
    s_mul_i32 s58, s88, 3072
    s_add_u32 s58, s58, 98304
    s_add_u32 m0, s54, 32768
    s_nop 0
    buffer_load_dwordx4 v6, s[28:31], s58 offen lds
    v_mfma_f32_16x16x32_bf16 v[180:183], v[72:75], v[44:47], v[180:183]
    s_add_u32 m0, s54, 40960
    s_nop 0
    buffer_load_dwordx4 v6, s[32:35], s58 offen lds
    v_mfma_f32_16x16x32_bf16 v[184:187], v[72:75], v[48:51], v[184:187]
    s_mul_i32 s60, s88, 3840
    s_add_u32 m0, s54, 147456
    s_nop 0
    buffer_load_dwordx4 v8, s[36:39], s60 offen lds
    v_mfma_f32_16x16x32_bf16 v[188:191], v[72:75], v[52:55], v[188:191]
    s_waitcnt vmcnt(9) lgkmcnt(0)
    s_barrier
    v_mfma_f32_16x16x32_bf16 v[112:115], v[92:95], v[76:79], v[112:115]
    ds_read_b128 v[40:43], v19 offset:16384
    v_mfma_f32_16x16x32_bf16 v[116:119], v[92:95], v[80:83], v[116:119]
    ds_read_b64_tr_b16 v[56:57], v10 offset:0
    v_mfma_f32_16x16x32_bf16 v[120:123], v[92:95], v[84:87], v[120:123]
    ds_read_b64_tr_b16 v[58:59], v10 offset:1024
    v_mfma_f32_16x16x32_bf16 v[124:127], v[92:95], v[88:91], v[124:127]
    ds_read_b128 v[44:47], v21 offset:16384
    v_mfma_f32_16x16x32_bf16 v[128:131], v[96:99], v[76:79], v[128:131]
    ds_read_b64_tr_b16 v[60:61], v12 offset:0
    v_mfma_f32_16x16x32_bf16 v[132:135], v[96:99], v[80:83], v[132:135]
    ds_read_b64_tr_b16 v[62:63], v12 offset:1024
    v_mfma_f32_16x16x32_bf16 v[136:139], v[96:99], v[84:87], v[136:139]
    ds_read_b128 v[48:51], v23 offset:16384
    v_mfma_f32_16x16x32_bf16 v[140:143], v[96:99], v[88:91], v[140:143]
    ds_read_b64_tr_b16 v[64:65], v10 offset:8192
    v_mfma_f32_16x16x32_bf16 v[144:147], v[100:103], v[76:79], v[144:147]
    ds_read_b64_tr_b16 v[66:67], v10 offset:9216
    v_mfma_f32_16x16x32_bf16 v[148:151], v[100:103], v[80:83], v[148:151]
    v_mfma_f32_16x16x32_bf16 v[152:155], v[100:103], v[84:87], v[152:155]
    ds_read_b128 v[52:55], v25 offset:16384
    v_mfma_f32_16x16x32_bf16 v[156:159], v[100:103], v[88:91], v[156:159]
    ds_read_b64_tr_b16 v[68:69], v12 offset:8192
    v_mfma_f32_16x16x32_bf16 v[160:163], v[104:107], v[76:79], v[160:163]
    ds_read_b64_tr_b16 v[70:71], v12 offset:9216
    v_mfma_f32_16x16x32_bf16 v[164:167], v[104:107], v[80:83], v[164:167]
    ds_read_b64_tr_b16 v[72:73], v17 offset:8192
    v_mfma_f32_16x16x32_bf16 v[168:171], v[104:107], v[84:87], v[168:171]
    ds_read_b64_tr_b16 v[74:75], v17 offset:8704
    v_mfma_f32_16x16x32_bf16 v[172:175], v[104:107], v[88:91], v[172:175]
    s_mul_i32 s58, s89, 3072
    s_add_u32 m0, s54, 49152
    s_nop 0
    buffer_load_dwordx4 v6, s[28:31], s58 offen lds
    v_mfma_f32_16x16x32_bf16 v[176:179], v[108:111], v[76:79], v[176:179]
    s_add_u32 m0, s54, 57344
    s_nop 0
    buffer_load_dwordx4 v6, s[32:35], s58 offen lds
    v_mfma_f32_16x16x32_bf16 v[180:183], v[108:111], v[80:83], v[180:183]
    s_lshl_b32 s59, s89, 1
    s_add_u32 m0, s55, 81920
    s_nop 0
    buffer_load_dwordx4 v4, s[24:27], s59 offen lds
    v_mfma_f32_16x16x32_bf16 v[184:187], v[108:111], v[84:87], v[184:187]
    s_add_u32 m0, s55, 82944
    s_nop 0
    buffer_load_dwordx4 v5, s[24:27], s59 offen lds
    v_mfma_f32_16x16x32_bf16 v[188:191], v[108:111], v[88:91], v[188:191]
    s_waitcnt vmcnt(7) lgkmcnt(0)
    s_barrier
    v_mfma_f32_16x16x32_bf16 v[112:115], v[56:59], v[40:43], v[112:115]
    ds_read_b128 v[76:79], v20 offset:16384
    v_mfma_f32_16x16x32_bf16 v[116:119], v[56:59], v[44:47], v[116:119]
    ds_read_b64_tr_b16 v[92:93], v9 offset:0
    v_mfma_f32_16x16x32_bf16 v[120:123], v[56:59], v[48:51], v[120:123]
    ds_read_b64_tr_b16 v[94:95], v9 offset:1024
    v_mfma_f32_16x16x32_bf16 v[124:127], v[56:59], v[52:55], v[124:127]
    ds_read_b128 v[80:83], v22 offset:16384
    v_mfma_f32_16x16x32_bf16 v[128:131], v[60:63], v[40:43], v[128:131]
    ds_read_b64_tr_b16 v[96:97], v11 offset:0
    v_mfma_f32_16x16x32_bf16 v[132:135], v[60:63], v[44:47], v[132:135]
    ds_read_b64_tr_b16 v[98:99], v11 offset:1024
    v_mfma_f32_16x16x32_bf16 v[136:139], v[60:63], v[48:51], v[136:139]
    v_mfma_f32_16x16x32_bf16 v[140:143], v[60:63], v[52:55], v[140:143]
    ds_read_b128 v[84:87], v24 offset:16384
    s_cmp_ge_u32 s50, 6
    s_cbranch_scc1 P1_GUQ_CI_ROW
    s_mov_b64 exec, s[98:99]
P1_GUQ_CHK:
    v_cmp_ne_u64 s[62:63], s[92:93], v[232:233]
    s_nop 1
    s_cmp_eq_u64 s[62:63], 0
    s_cbranch_scc1 P1_GUQ_OK
    s_add_u32 s3, s3, 1
    s_cmp_gt_u32 s3, 0x200000
    s_cbranch_scc1 K_END
    s_sleep 2
    buffer_load_dwordx2 v[232:233], v240, s[40:43], s68 offen sc0 sc1
    s_waitcnt vmcnt(0)
    s_branch P1_GUQ_CHK
P1_GUQ_OK:
    s_mov_b64 exec, -1
    s_sub_u32 s61, s50, 2
    s_cmp_lt_u32 s61, 4
    s_cbranch_scc1 P1_GUQ_CI_COL
P1_GUQ_CI_ROW:
    s_lshl_b32 s61, s48, 14
    s_add_u32 s61, s61, 11763712
    v_lshlrev_b32 v30, 3, v0
    buffer_load_dwordx2 v[192:193], v30, s[40:43], s61 offen offset:0 sc0 sc1
    buffer_load_dwordx2 v[194:195], v30, s[40:43], s61 offen offset:1024 sc0 sc1
    buffer_load_dwordx2 v[196:197], v30, s[40:43], s61 offen offset:2048 sc0 sc1
    buffer_load_dwordx2 v[198:199], v30, s[40:43], s61 offen offset:3072 sc0 sc1
    s_add_u32 s61, s61, 4096
    buffer_load_dwordx2 v[200:201], v30, s[40:43], s61 offen offset:0 sc0 sc1
    buffer_load_dwordx2 v[202:203], v30, s[40:43], s61 offen offset:1024 sc0 sc1
    buffer_load_dwordx2 v[204:205], v30, s[40:43], s61 offen offset:2048 sc0 sc1
    buffer_load_dwordx2 v[206:207], v30, s[40:43], s61 offen offset:3072 sc0 sc1
    s_add_u32 s61, s61, 4096
    buffer_load_dwordx2 v[208:209], v30, s[40:43], s61 offen offset:0 sc0 sc1
    buffer_load_dwordx2 v[210:211], v30, s[40:43], s61 offen offset:1024 sc0 sc1
    s_branch P1_GUQ_CI_DONE
P1_GUQ_CI_COL:
    s_lshl_b32 s61, s49, 2
    s_add_u32 s61, s61, s50
    s_sub_u32 s61, s61, 2
    s_lshl_b32 s61, s61, 14
    s_add_u32 s61, s61, 12025856
    v_lshlrev_b32 v30, 4, v1
    v_and_b32 v31, 31, v1
    v_cmp_gt_u32 s[62:63], 20, v31
    v_mov_b32 v31, 0x40000000
    s_nop 0
    v_cndmask_b32 v30, v31, v30, s[62:63]
    buffer_load_dwordx4 v[192:195], v30, s[40:43], s61 offen offset:0 sc0 sc1
    buffer_load_dwordx4 v[196:199], v30, s[40:43], s61 offen offset:1024 sc0 sc1
    buffer_load_dwordx4 v[200:203], v30, s[40:43], s61 offen offset:2048 sc0 sc1
    buffer_load_dwordx4 v[204:207], v30, s[40:43], s61 offen offset:3072 sc0 sc1
    s_add_u32 s61, s61, 4096
    buffer_load_dwordx4 v[208:211], v30, s[40:43], s61 offen offset:0 sc0 sc1
    buffer_load_dwordx4 v[212:215], v30, s[40:43], s61 offen offset:1024 sc0 sc1
    buffer_load_dwordx4 v[216:219], v30, s[40:43], s61 offen offset:2048 sc0 sc1
    buffer_load_dwordx4 v[220:223], v30, s[40:43], s61 offen offset:3072 sc0 sc1
    s_add_u32 s61, s61, 4096
    buffer_load_dwordx4 v[224:227], v30, s[40:43], s61 offen offset:0 sc0 sc1
    buffer_load_dwordx4 v[228:231], v30, s[40:43], s61 offen offset:1024 sc0 sc1
P1_GUQ_CI_DONE:
    v_mfma_f32_16x16x32_bf16 v[144:147], v[64:67], v[40:43], v[144:147]
    ds_read_b64_tr_b16 v[100:101], v9 offset:8192
    v_mfma_f32_16x16x32_bf16 v[148:151], v[64:67], v[44:47], v[148:151]
    ds_read_b64_tr_b16 v[102:103], v9 offset:9216
    v_mfma_f32_16x16x32_bf16 v[152:155], v[64:67], v[48:51], v[152:155]
    ds_read_b128 v[88:91], v26 offset:16384
    v_mfma_f32_16x16x32_bf16 v[156:159], v[64:67], v[52:55], v[156:159]
    ds_read_b64_tr_b16 v[104:105], v11 offset:8192
    v_mfma_f32_16x16x32_bf16 v[160:163], v[68:71], v[40:43], v[160:163]
    ds_read_b64_tr_b16 v[106:107], v11 offset:9216
    v_mfma_f32_16x16x32_bf16 v[164:167], v[68:71], v[44:47], v[164:167]
    v_mfma_f32_16x16x32_bf16 v[168:171], v[68:71], v[48:51], v[168:171]
    ds_read_b64_tr_b16 v[108:109], v17 offset:12288
    v_mfma_f32_16x16x32_bf16 v[172:175], v[68:71], v[52:55], v[172:175]
    ds_read_b64_tr_b16 v[110:111], v17 offset:12800
    v_mfma_f32_16x16x32_bf16 v[176:179], v[72:75], v[40:43], v[176:179]
    s_mul_i32 s58, s89, 3072
    s_add_u32 s58, s58, 98304
    s_add_u32 m0, s54, 65536
    s_nop 0
    buffer_load_dwordx4 v6, s[28:31], s58 offen lds
    v_mfma_f32_16x16x32_bf16 v[180:183], v[72:75], v[44:47], v[180:183]
    s_add_u32 m0, s54, 73728
    s_nop 0
    buffer_load_dwordx4 v6, s[32:35], s58 offen lds
    v_mfma_f32_16x16x32_bf16 v[184:187], v[72:75], v[48:51], v[184:187]
    s_mul_i32 s60, s89, 3840
    s_add_u32 m0, s54, 131072
    s_nop 0
    buffer_load_dwordx4 v8, s[36:39], s60 offen lds
    v_mfma_f32_16x16x32_bf16 v[188:191], v[72:75], v[52:55], v[188:191]
    s_waitcnt vmcnt(17) lgkmcnt(0)
    s_barrier
    v_mfma_f32_16x16x32_bf16 v[112:115], v[92:95], v[76:79], v[112:115]
    ds_read_b128 v[40:43], v19 offset:32768
    v_mfma_f32_16x16x32_bf16 v[116:119], v[92:95], v[80:83], v[116:119]
    ds_read_b64_tr_b16 v[56:57], v9 offset:16384
    v_mfma_f32_16x16x32_bf16 v[120:123], v[92:95], v[84:87], v[120:123]
    ds_read_b64_tr_b16 v[58:59], v9 offset:17408
    v_mfma_f32_16x16x32_bf16 v[124:127], v[92:95], v[88:91], v[124:127]
    v_mfma_f32_16x16x32_bf16 v[128:131], v[96:99], v[76:79], v[128:131]
    ds_read_b128 v[44:47], v21 offset:32768
    v_mfma_f32_16x16x32_bf16 v[132:135], v[96:99], v[80:83], v[132:135]
    ds_read_b64_tr_b16 v[60:61], v11 offset:16384
    v_mfma_f32_16x16x32_bf16 v[136:139], v[96:99], v[84:87], v[136:139]
    v_mfma_f32_16x16x32_bf16 v[140:143], v[96:99], v[88:91], v[140:143]
    ds_read_b64_tr_b16 v[62:63], v11 offset:17408
    s_mov_b64 exec, s[96:97]
P1_GUQ_WF:
    v_cmp_ne_u64 s[62:63], s[92:93], v[238:239]
    s_nop 1
    s_cmp_eq_u64 s[62:63], 0
    s_cbranch_scc1 P1_GUQ_WF_OK
    s_add_u32 s3, s3, 1
    s_cmp_gt_u32 s3, 0x200000
    s_cbranch_scc1 K_END
    s_sleep 4
    buffer_load_dwordx2 v[238:239], v240, s[40:43], s94 offen sc0 sc1
    s_waitcnt vmcnt(0)
    s_branch P1_GUQ_WF
P1_GUQ_WF_OK:
    s_mov_b64 exec, -1
    v_mfma_f32_16x16x32_bf16 v[144:147], v[100:103], v[76:79], v[144:147]
    ds_read_b128 v[48:51], v23 offset:32768
    v_mfma_f32_16x16x32_bf16 v[148:151], v[100:103], v[80:83], v[148:151]
    v_mfma_f32_16x16x32_bf16 v[152:155], v[100:103], v[84:87], v[152:155]
    ds_read_b64_tr_b16 v[64:65], v9 offset:24576
    v_mfma_f32_16x16x32_bf16 v[156:159], v[100:103], v[88:91], v[156:159]
    ds_read_b64_tr_b16 v[66:67], v9 offset:25600
    v_mfma_f32_16x16x32_bf16 v[160:163], v[104:107], v[76:79], v[160:163]
    ds_read_b128 v[52:55], v25 offset:32768
    v_mfma_f32_16x16x32_bf16 v[164:167], v[104:107], v[80:83], v[164:167]
    v_mfma_f32_16x16x32_bf16 v[168:171], v[104:107], v[84:87], v[168:171]
    ds_read_b64_tr_b16 v[68:69], v11 offset:24576
    v_mfma_f32_16x16x32_bf16 v[172:175], v[104:107], v[88:91], v[172:175]
    ds_read_b64_tr_b16 v[70:71], v11 offset:25600
    v_mfma_f32_16x16x32_bf16 v[176:179], v[108:111], v[76:79], v[176:179]
    v_mfma_f32_16x16x32_bf16 v[180:183], v[108:111], v[80:83], v[180:183]
    ds_read_b64_tr_b16 v[72:73], v17 offset:16384
    v_mfma_f32_16x16x32_bf16 v[184:187], v[108:111], v[84:87], v[184:187]
    ds_read_b64_tr_b16 v[74:75], v17 offset:16896
    v_mfma_f32_16x16x32_bf16 v[188:191], v[108:111], v[88:91], v[188:191]
    s_waitcnt vmcnt(17) lgkmcnt(0)
    s_barrier
    v_mfma_f32_16x16x32_bf16 v[112:115], v[56:59], v[40:43], v[112:115]
    ds_read_b128 v[76:79], v20 offset:32768
    v_mfma_f32_16x16x32_bf16 v[116:119], v[56:59], v[44:47], v[116:119]
    ds_read_b64_tr_b16 v[92:93], v9 offset:32768
    v_mfma_f32_16x16x32_bf16 v[120:123], v[56:59], v[48:51], v[120:123]
    ds_read_b64_tr_b16 v[94:95], v9 offset:33792
    v_mfma_f32_16x16x32_bf16 v[124:127], v[56:59], v[52:55], v[124:127]
    v_mfma_f32_16x16x32_bf16 v[128:131], v[60:63], v[40:43], v[128:131]
    ds_read_b128 v[80:83], v22 offset:32768
    v_mfma_f32_16x16x32_bf16 v[132:135], v[60:63], v[44:47], v[132:135]
    ds_read_b64_tr_b16 v[96:97], v11 offset:32768
    v_mfma_f32_16x16x32_bf16 v[136:139], v[60:63], v[48:51], v[136:139]
    v_mfma_f32_16x16x32_bf16 v[140:143], v[60:63], v[52:55], v[140:143]
    ds_read_b64_tr_b16 v[98:99], v11 offset:33792
    v_mfma_f32_16x16x32_bf16 v[144:147], v[64:67], v[40:43], v[144:147]
    ds_read_b128 v[84:87], v24 offset:32768
    v_mfma_f32_16x16x32_bf16 v[148:151], v[64:67], v[44:47], v[148:151]
    v_mfma_f32_16x16x32_bf16 v[152:155], v[64:67], v[48:51], v[152:155]
    ds_read_b64_tr_b16 v[100:101], v9 offset:40960
    v_mfma_f32_16x16x32_bf16 v[156:159], v[64:67], v[52:55], v[156:159]
    ds_read_b64_tr_b16 v[102:103], v9 offset:41984
    v_mfma_f32_16x16x32_bf16 v[160:163], v[68:71], v[40:43], v[160:163]
    ds_read_b128 v[88:91], v26 offset:32768
    v_mfma_f32_16x16x32_bf16 v[164:167], v[68:71], v[44:47], v[164:167]
    v_mfma_f32_16x16x32_bf16 v[168:171], v[68:71], v[48:51], v[168:171]
    ds_read_b64_tr_b16 v[104:105], v11 offset:40960
    v_mfma_f32_16x16x32_bf16 v[172:175], v[68:71], v[52:55], v[172:175]
    ds_read_b64_tr_b16 v[106:107], v11 offset:41984
    v_mfma_f32_16x16x32_bf16 v[176:179], v[72:75], v[40:43], v[176:179]
    v_mfma_f32_16x16x32_bf16 v[180:183], v[72:75], v[44:47], v[180:183]
    ds_read_b64_tr_b16 v[108:109], v17 offset:20480
    v_mfma_f32_16x16x32_bf16 v[184:187], v[72:75], v[48:51], v[184:187]
    ds_read_b64_tr_b16 v[110:111], v17 offset:20992
    v_mfma_f32_16x16x32_bf16 v[188:191], v[72:75], v[52:55], v[188:191]
    s_waitcnt vmcnt(3)
    s_cmp_ge_u32 s50, 6
    s_cbranch_scc1 P1_GUQ_CF_DONE
    s_cmp_ge_u32 s50, 2
    s_cbranch_scc1 P1_GUQ_CF_COL
    v_add_f32 v192, v192, v202
    v_add_f32 v193, v193, v203
    v_add_f32 v194, v194, v204
    v_add_f32 v195, v195, v205
    v_add_f32 v196, v196, v206
    v_add_f32 v197, v197, v207
    v_add_f32 v198, v198, v208
    v_add_f32 v199, v199, v209
    v_add_f32 v200, v200, v210
    v_add_f32 v201, v201, v211
    v_add_f32 v192, v192, v194
    v_add_f32 v193, v193, v195
    v_add_f32 v196, v196, v198
    v_add_f32 v197, v197, v199
    v_add_f32 v192, v192, v200
    v_add_f32 v193, v193, v201
    v_add_f32 v192, v192, v196
    v_add_f32 v193, v193, v197
    v_mul_f32 v192, 0x3acccccd, v192
    v_mul_f32 v193, 0x3acccccd, v193
    v_fma_f32 v193, -v192, v192, v193
    v_max_f32 v193, 0, v193
    v_cvt_pk_bf16_f32 v192, v192, v192
    v_lshlrev_b32 v192, 16, v192
    v_cvt_pk_bf16_f32 v193, v193, v193
    v_lshlrev_b32 v193, 16, v193
    v_add_f32 v193, 0x3727c5ac, v193
    v_cvt_pk_bf16_f32 v193, v193, v193
    v_lshlrev_b32 v193, 16, v193
    v_sqrt_f32 v193, v193
    s_nop 0
    v_cvt_pk_bf16_f32 v193, v193, v193
    v_lshlrev_b32 v193, 16, v193
    v_mov_b32 v30, 159744
    v_lshl_add_u32 v30, v0, 3, v30
    ds_write_b64 v30, v[192:193]
    s_branch P1_GUQ_CF_DONE
P1_GUQ_CF_COL:
    v_add_f32 v192, v192, v212
    v_add_f32 v193, v193, v213
    v_add_f32 v194, v194, v214
    v_add_f32 v195, v195, v215
    v_add_f32 v196, v196, v216
    v_add_f32 v197, v197, v217
    v_add_f32 v198, v198, v218
    v_add_f32 v199, v199, v219
    v_add_f32 v200, v200, v220
    v_add_f32 v201, v201, v221
    v_add_f32 v202, v202, v222
    v_add_f32 v203, v203, v223
    v_add_f32 v204, v204, v224
    v_add_f32 v205, v205, v225
    v_add_f32 v206, v206, v226
    v_add_f32 v207, v207, v227
    v_add_f32 v208, v208, v228
    v_add_f32 v209, v209, v229
    v_add_f32 v210, v210, v230
    v_add_f32 v211, v211, v231
    v_add_f32 v192, v192, v200
    v_add_f32 v193, v193, v201
    v_add_f32 v194, v194, v202
    v_add_f32 v195, v195, v203
    v_add_f32 v196, v196, v204
    v_add_f32 v197, v197, v205
    v_add_f32 v198, v198, v206
    v_add_f32 v199, v199, v207
    v_add_f32 v192, v192, v196
    v_add_f32 v193, v193, v197
    v_add_f32 v194, v194, v198
    v_add_f32 v195, v195, v199
    v_add_f32 v192, v192, v208
    v_add_f32 v193, v193, v209
    v_add_f32 v194, v194, v210
    v_add_f32 v195, v195, v211
    v_mov_b32 v196, v192
    v_mov_b32 v197, v193
    v_mov_b32 v198, v194
    v_mov_b32 v199, v195
    v_permlane32_swap_b32 v192, v196
    v_permlane32_swap_b32 v193, v197
    v_permlane32_swap_b32 v194, v198
    v_permlane32_swap_b32 v195, v199
    v_add_f32 v192, v192, v196
    v_add_f32 v193, v193, v197
    v_add_f32 v194, v194, v198
    v_add_f32 v195, v195, v199
    s_sub_u32 s56, s50, 2
    s_mul_i32 s56, s56, 320
    s_add_u32 s56, s56, 160768
    v_lshl_add_u32 v30, v1, 4, s56
    s_mov_b64 exec, 0xfffff
    ds_write_b128 v30, v[192:195]
    s_mov_b64 exec, -1
P1_GUQ_CF_DONE:
    s_waitcnt vmcnt(0) lgkmcnt(0)
    s_barrier
    v_mfma_f32_16x16x32_bf16 v[112:115], v[92:95], v[76:79], v[112:115]
    ds_read_b128 v[40:43], v19 offset:0
    ds_read_b64_tr_b16 v[56:57], v9 offset:49152
    v_mfma_f32_16x16x32_bf16 v[116:119], v[92:95], v[80:83], v[116:119]
    ds_read_b64_tr_b16 v[58:59], v9 offset:50176
    v_mfma_f32_16x16x32_bf16 v[120:123], v[92:95], v[84:87], v[120:123]
    ds_read_b128 v[44:47], v21 offset:0
    v_mfma_f32_16x16x32_bf16 v[124:127], v[92:95], v[88:91], v[124:127]
    ds_read_b64_tr_b16 v[60:61], v11 offset:49152
    v_mfma_f32_16x16x32_bf16 v[128:131], v[96:99], v[76:79], v[128:131]
    ds_read_b64_tr_b16 v[62:63], v11 offset:50176
    v_mfma_f32_16x16x32_bf16 v[132:135], v[96:99], v[80:83], v[132:135]
    ds_read_b128 v[48:51], v23 offset:0
    ds_read_b64_tr_b16 v[64:65], v9 offset:57344
    v_mfma_f32_16x16x32_bf16 v[136:139], v[96:99], v[84:87], v[136:139]
    ds_read_b64_tr_b16 v[66:67], v9 offset:58368
    v_mfma_f32_16x16x32_bf16 v[140:143], v[96:99], v[88:91], v[140:143]
    ds_read_b128 v[52:55], v25 offset:0
    v_mfma_f32_16x16x32_bf16 v[144:147], v[100:103], v[76:79], v[144:147]
    ds_read_b64_tr_b16 v[68:69], v11 offset:57344
    v_mfma_f32_16x16x32_bf16 v[148:151], v[100:103], v[80:83], v[148:151]
    ds_read_b64_tr_b16 v[70:71], v11 offset:58368
    v_mfma_f32_16x16x32_bf16 v[152:155], v[100:103], v[84:87], v[152:155]
    ds_read_b64_tr_b16 v[72:73], v17 offset:0
    ds_read_b64_tr_b16 v[74:75], v17 offset:512
    v_mfma_f32_16x16x32_bf16 v[156:159], v[100:103], v[88:91], v[156:159]
    s_xor_b32 s56, s52, 0
    s_lshl_b32 s57, s51, 2
    s_add_u32 s56, s56, s57
    s_lshl_b32 s56, s56, 7
    s_add_u32 s56, s56, 159744
    v_lshl_add_u32 v30, v2, 3, s56
    ds_read_b64 v[192:193], v30
    v_mfma_f32_16x16x32_bf16 v[160:163], v[104:107], v[76:79], v[160:163]
    s_xor_b32 s56, s52, 1
    s_lshl_b32 s57, s51, 2
    s_add_u32 s56, s56, s57
    s_lshl_b32 s56, s56, 7
    s_add_u32 s56, s56, 159744
    v_lshl_add_u32 v31, v2, 3, s56
    ds_read_b64 v[194:195], v31
    v_mfma_f32_16x16x32_bf16 v[164:167], v[104:107], v[80:83], v[164:167]
    s_xor_b32 s56, s52, 2
    s_lshl_b32 s57, s51, 2
    s_add_u32 s56, s56, s57
    s_lshl_b32 s56, s56, 7
    s_add_u32 s56, s56, 159744
    v_lshl_add_u32 v32, v2, 3, s56
    ds_read_b64 v[196:197], v32
    v_mfma_f32_16x16x32_bf16 v[168:171], v[104:107], v[84:87], v[168:171]
    s_xor_b32 s56, s52, 3
    s_lshl_b32 s57, s51, 2
    s_add_u32 s56, s56, s57
    s_lshl_b32 s56, s56, 7
    s_add_u32 s56, s56, 159744
    v_lshl_add_u32 v33, v2, 3, s56
    ds_read_b64 v[198:199], v33
    v_mfma_f32_16x16x32_bf16 v[172:175], v[104:107], v[88:91], v[172:175]
    s_mul_i32 s56, s52, 320
    s_add_u32 s56, s56, 160768
    v_lshl_add_u32 v34, v3, 4, s56
    ds_read_b128 v[220:223], v34 offset:0
    v_mfma_f32_16x16x32_bf16 v[176:179], v[108:111], v[76:79], v[176:179]
    ds_read_b128 v[224:227], v34 offset:64
    v_mfma_f32_16x16x32_bf16 v[180:183], v[108:111], v[80:83], v[180:183]
    ds_read_b128 v[228:231], v34 offset:128
    v_mfma_f32_16x16x32_bf16 v[184:187], v[108:111], v[84:87], v[184:187]
    ds_read_b128 v[232:235], v34 offset:192
    v_mfma_f32_16x16x32_bf16 v[188:191], v[108:111], v[88:91], v[188:191]
    ds_read_b128 v[236:239], v34 offset:256
    s_waitcnt vmcnt(0) lgkmcnt(0)
    s_barrier
    v_mfma_f32_16x16x32_bf16 v[112:115], v[56:59], v[40:43], v[112:115]
    ds_read_b128 v[76:79], v20 offset:0
    ds_read_b64_tr_b16 v[92:93], v10 offset:0
    v_mfma_f32_16x16x32_bf16 v[116:119], v[56:59], v[44:47], v[116:119]
    ds_read_b64_tr_b16 v[94:95], v10 offset:1024
    v_mfma_f32_16x16x32_bf16 v[120:123], v[56:59], v[48:51], v[120:123]
    ds_read_b128 v[80:83], v22 offset:0
    ds_read_b64_tr_b16 v[96:97], v12 offset:0
    v_mfma_f32_16x16x32_bf16 v[124:127], v[56:59], v[52:55], v[124:127]
    ds_read_b64_tr_b16 v[98:99], v12 offset:1024
    v_mfma_f32_16x16x32_bf16 v[128:131], v[60:63], v[40:43], v[128:131]
    ds_read_b128 v[84:87], v24 offset:0
    v_mfma_f32_16x16x32_bf16 v[132:135], v[60:63], v[44:47], v[132:135]
    ds_read_b64_tr_b16 v[100:101], v10 offset:8192
    ds_read_b64_tr_b16 v[102:103], v10 offset:9216
    v_mfma_f32_16x16x32_bf16 v[136:139], v[60:63], v[48:51], v[136:139]
    ds_read_b128 v[88:91], v26 offset:0
    v_mfma_f32_16x16x32_bf16 v[140:143], v[60:63], v[52:55], v[140:143]
    ds_read_b64_tr_b16 v[104:105], v12 offset:8192
    v_mfma_f32_16x16x32_bf16 v[144:147], v[64:67], v[40:43], v[144:147]
    ds_read_b64_tr_b16 v[106:107], v12 offset:9216
    ds_read_b64_tr_b16 v[108:109], v17 offset:4096
    v_mfma_f32_16x16x32_bf16 v[148:151], v[64:67], v[44:47], v[148:151]
    ds_read_b64_tr_b16 v[110:111], v17 offset:4608
    v_mfma_f32_16x16x32_bf16 v[152:155], v[64:67], v[48:51], v[152:155]
    v_lshlrev_b32 v31, 4, v1
    v_lshlrev_b32 v32, 3, v1
    s_mov_b32 s70, 0x358637bd
    v_mfma_f32_16x16x32_bf16 v[156:159], v[64:67], v[52:55], v[156:159]
    v_rcp_f32 v203, v193
    v_mul_f32 v202, v193, v193
    v_rcp_f32 v208, v195
    v_mul_f32 v207, v195, v195
    v_mfma_f32_16x16x32_bf16 v[160:163], v[68:71], v[40:43], v[160:163]
    v_rcp_f32 v213, v197
    v_mul_f32 v212, v197, v197
    v_mfma_f32_16x16x32_bf16 v[164:167], v[68:71], v[44:47], v[164:167]
    v_rcp_f32 v218, v199
    v_mul_f32 v217, v199, v199
    v_mfma_f32_16x16x32_bf16 v[168:171], v[68:71], v[48:51], v[168:171]
    v_mul_f32 v200, 0xc0135761, v203
    v_mul_f32 v201, v203, v203
    v_mul_f32 v204, 0x3fb8aa3b, v203
    v_mul_f32 v205, 0xc0135761, v208
    v_mul_f32 v206, v208, v208
    v_mul_f32 v209, 0x3fb8aa3b, v208
    v_mfma_f32_16x16x32_bf16 v[172:175], v[68:71], v[52:55], v[172:175]
    v_mul_f32 v210, 0xc0135761, v213
    v_mul_f32 v211, v213, v213
    v_mul_f32 v214, 0x3fb8aa3b, v213
    v_mfma_f32_16x16x32_bf16 v[176:179], v[72:75], v[40:43], v[176:179]
    v_mul_f32 v215, 0xc0135761, v218
    v_mul_f32 v216, v218, v218
    v_mul_f32 v219, 0x3fb8aa3b, v218
    v_mfma_f32_16x16x32_bf16 v[180:183], v[72:75], v[44:47], v[180:183]
    v_mul_f32 v201, v201, v200
    v_mul_f32 v201, 0x3d372713, v201
    v_mul_f32 v206, v206, v205
    v_mul_f32 v206, 0x3d372713, v206
    v_mfma_f32_16x16x32_bf16 v[184:187], v[72:75], v[48:51], v[184:187]
    v_mul_f32 v211, v211, v210
    v_mul_f32 v211, 0x3d372713, v211
    v_mfma_f32_16x16x32_bf16 v[188:191], v[72:75], v[52:55], v[188:191]
    v_mul_f32 v216, v216, v215
    v_mul_f32 v216, 0x3d372713, v216
    s_waitcnt lgkmcnt(0)
    s_barrier
    v_mfma_f32_16x16x32_bf16 v[112:115], v[92:95], v[76:79], v[112:115]
    s_and_b32 s61, s2, 1
    s_lshl_b32 s61, s61, 2
    s_lshr_b32 s62, s2, 6
    s_add_u32 s61, s61, s62
    s_mul_i32 s61, s61, 48
    s_mul_i32 s62, s52, 12
    s_add_u32 s61, s61, s62
    s_mul_i32 s61, s61, 5120
    s_mul_i32 s62, s51, 10240
    s_add_u32 s61, s61, s62
    s_add_u32 s61, s61, 8912896
    s_mul_i32 s63, s52, 20480
    s_add_u32 s63, s63, s62
    s_add_u32 s63, s63, 77824
    v_lshlrev_b32 v241, 4, v1
    v_mfma_f32_16x16x32_bf16 v[116:119], v[92:95], v[80:83], v[116:119]
    s_add_u32 m0, s63, 0
    s_nop 0
    buffer_load_dwordx4 v241, s[40:43], s61 offen sc0 sc1 lds
    s_add_u32 s61, s61, 1024
    v_mfma_f32_16x16x32_bf16 v[120:123], v[92:95], v[84:87], v[120:123]
    v_mfma_f32_16x16x32_bf16 v[124:127], v[92:95], v[88:91], v[124:127]
    s_add_u32 m0, s63, 1024
    s_nop 0
    buffer_load_dwordx4 v241, s[40:43], s61 offen sc0 sc1 lds
    s_add_u32 s61, s61, 1024
    v_mfma_f32_16x16x32_bf16 v[128:131], v[96:99], v[76:79], v[128:131]
    v_mfma_f32_16x16x32_bf16 v[132:135], v[96:99], v[80:83], v[132:135]
    s_add_u32 m0, s63, 2048
    s_nop 0
    buffer_load_dwordx4 v241, s[40:43], s61 offen sc0 sc1 lds
    s_add_u32 s61, s61, 1024
    v_mfma_f32_16x16x32_bf16 v[136:139], v[96:99], v[84:87], v[136:139]
    v_mfma_f32_16x16x32_bf16 v[140:143], v[96:99], v[88:91], v[140:143]
    s_add_u32 m0, s63, 3072
    s_nop 0
    buffer_load_dwordx4 v241, s[40:43], s61 offen sc0 sc1 lds
    s_add_u32 s61, s61, 1024
    v_mfma_f32_16x16x32_bf16 v[144:147], v[100:103], v[76:79], v[144:147]
    v_mfma_f32_16x16x32_bf16 v[148:151], v[100:103], v[80:83], v[148:151]
    s_add_u32 m0, s63, 4096
    s_nop 0
    buffer_load_dwordx4 v241, s[40:43], s61 offen sc0 sc1 lds
    s_add_u32 s61, s61, 1024
    v_mfma_f32_16x16x32_bf16 v[152:155], v[100:103], v[84:87], v[152:155]
    s_add_u32 m0, s63, 5120
    s_nop 0
    buffer_load_dwordx4 v241, s[40:43], s61 offen sc0 sc1 lds
    s_add_u32 s61, s61, 1024
    v_mfma_f32_16x16x32_bf16 v[156:159], v[100:103], v[88:91], v[156:159]
    v_mfma_f32_16x16x32_bf16 v[160:163], v[104:107], v[76:79], v[160:163]
    s_add_u32 m0, s63, 6144
    s_nop 0
    buffer_load_dwordx4 v241, s[40:43], s61 offen sc0 sc1 lds
    s_add_u32 s61, s61, 1024
    v_mfma_f32_16x16x32_bf16 v[164:167], v[104:107], v[80:83], v[164:167]
    v_mfma_f32_16x16x32_bf16 v[168:171], v[104:107], v[84:87], v[168:171]
    s_add_u32 m0, s63, 7168
    s_nop 0
    buffer_load_dwordx4 v241, s[40:43], s61 offen sc0 sc1 lds
    s_add_u32 s61, s61, 1024
    v_mfma_f32_16x16x32_bf16 v[172:175], v[104:107], v[88:91], v[172:175]
    v_mfma_f32_16x16x32_bf16 v[176:179], v[108:111], v[76:79], v[176:179]
    s_add_u32 m0, s63, 8192
    s_nop 0
    buffer_load_dwordx4 v241, s[40:43], s61 offen sc0 sc1 lds
    s_add_u32 s61, s61, 1024
    v_mfma_f32_16x16x32_bf16 v[180:183], v[108:111], v[80:83], v[180:183]
    v_mfma_f32_16x16x32_bf16 v[184:187], v[108:111], v[84:87], v[184:187]
    s_add_u32 m0, s63, 9216
    s_nop 0
    buffer_load_dwordx4 v241, s[40:43], s61 offen sc0 sc1 lds
    s_add_u32 s61, s61, 1024
    v_mfma_f32_16x16x32_bf16 v[188:191], v[108:111], v[88:91], v[188:191]
    s_xor_b32 s56, s52, 0
    s_lshl_b32 s57, s51, 2
    s_add_u32 s56, s56, s57
    s_lshl_b32 s57, s48, 3
    s_add_u32 s56, s56, s57
    s_mul_i32 s57, s56, 48
    s_lshl_b32 s58, s53, 2
    s_add_u32 s57, s57, s58
    s_add_u32 s57, s57, s52
    s_lshl_b32 s57, s57, 10
    v_fma_f32 v112, -v192, v220, v112
    v_fma_f32 v113, -v192, v221, v113
    v_fma_f32 v114, -v192, v222, v114
    v_fma_f32 v115, -v192, v223, v115
    v_fma_f32 v128, -v192, v224, v128
    v_fma_f32 v129, -v192, v225, v129
    v_fma_f32 v130, -v192, v226, v130
    v_fma_f32 v131, -v192, v227, v131
    v_mul_f32 v40, v112, v112
    v_mul_f32 v41, v113, v113
    v_mul_f32 v42, v114, v114
    v_mul_f32 v43, v115, v115
    v_mul_f32 v44, v128, v128
    v_mul_f32 v45, v129, v129
    v_mul_f32 v46, v130, v130
    v_mul_f32 v47, v131, v131
    v_fma_f32 v40, v40, v201, v200
    v_fma_f32 v41, v41, v201, v200
    v_fma_f32 v42, v42, v201, v200
    v_fma_f32 v43, v43, v201, v200
    v_fma_f32 v44, v44, v201, v200
    v_fma_f32 v45, v45, v201, v200
    v_fma_f32 v46, v46, v201, v200
    v_fma_f32 v47, v47, v201, v200
    v_mul_f32 v40, v40, v112
    v_mul_f32 v41, v41, v113
    v_mul_f32 v42, v42, v114
    v_mul_f32 v43, v43, v115
    v_mul_f32 v44, v44, v128
    v_mul_f32 v45, v45, v129
    v_mul_f32 v46, v46, v130
    v_mul_f32 v47, v47, v131
    v_exp_f32 v40, v40
    v_fma_f32 v144, -v192, v228, v144
    v_exp_f32 v41, v41
    v_fma_f32 v145, -v192, v229, v145
    v_exp_f32 v42, v42
    v_fma_f32 v146, -v192, v230, v146
    v_exp_f32 v43, v43
    v_fma_f32 v147, -v192, v231, v147
    v_exp_f32 v44, v44
    v_fma_f32 v160, -v192, v232, v160
    v_exp_f32 v45, v45
    v_fma_f32 v161, -v192, v233, v161
    v_exp_f32 v46, v46
    v_fma_f32 v162, -v192, v234, v162
    v_exp_f32 v47, v47
    v_fma_f32 v163, -v192, v235, v163
    v_fma_f32 v40, v40, v202, v202
    v_fma_f32 v41, v41, v202, v202
    v_fma_f32 v42, v42, v202, v202
    v_fma_f32 v43, v43, v202, v202
    v_fma_f32 v44, v44, v202, v202
    v_fma_f32 v45, v45, v202, v202
    v_fma_f32 v46, v46, v202, v202
    v_fma_f32 v47, v47, v202, v202
    v_rcp_f32 v40, v40
    v_mul_f32 v112, v112, v144
    v_rcp_f32 v41, v41
    v_mul_f32 v113, v113, v145
    v_rcp_f32 v42, v42
    v_mul_f32 v114, v114, v146
    v_rcp_f32 v43, v43
    v_mul_f32 v115, v115, v147
    v_rcp_f32 v44, v44
    v_mul_f32 v128, v128, v160
    v_rcp_f32 v45, v45
    v_mul_f32 v129, v129, v161
    v_rcp_f32 v46, v46
    v_mul_f32 v130, v130, v162
    v_rcp_f32 v47, v47
    v_mul_f32 v131, v131, v163
    v_mul_f32 v112, v112, v40
    v_mul_f32 v113, v113, v41
    v_mul_f32 v114, v114, v42
    v_mul_f32 v115, v115, v43
    v_mul_f32 v128, v128, v44
    v_mul_f32 v129, v129, v45
    v_mul_f32 v130, v130, v46
    v_mul_f32 v131, v131, v47
    v_cvt_pk_bf16_f32 v56, v112, v113
    v_cvt_pk_bf16_f32 v57, v114, v115
    v_cvt_pk_bf16_f32 v58, v128, v129
    v_cvt_pk_bf16_f32 v59, v130, v131
    buffer_store_dwordx4 v[56:59], v31, s[40:43], s57 offen sc0 sc1
    s_mul_i32 s57, s56, 20480
    s_lshl_b32 s58, s53, 11
    s_add_u32 s57, s57, s58
    s_lshl_b32 s58, s52, 9
    s_add_u32 s57, s57, s58
    s_add_u32 s57, s57, 6291456
    v_fma_f32 v176, -v192, v236, v176
    v_fma_f32 v177, -v192, v237, v177
    v_fma_f32 v178, -v192, v238, v178
    v_fma_f32 v179, -v192, v239, v179
    v_mul_f32 v48, v176, v204
    v_mul_f32 v49, v177, v204
    v_mul_f32 v50, v178, v204
    v_mul_f32 v51, v179, v204
    v_exp_f32 v48, v48 clamp
    v_mul_f32 v176, v176, v203
    v_exp_f32 v49, v49 clamp
    v_mul_f32 v177, v177, v203
    v_exp_f32 v50, v50 clamp
    v_mul_f32 v178, v178, v203
    v_exp_f32 v51, v51 clamp
    v_mul_f32 v179, v179, v203
    v_max_f32 v176, s70, v176
    v_max_f32 v177, s70, v177
    v_max_f32 v178, s70, v178
    v_max_f32 v179, s70, v179
    v_add_f32 v176, v176, v48
    v_add_f32 v177, v177, v49
    v_add_f32 v178, v178, v50
    v_add_f32 v179, v179, v51
    v_cvt_pk_bf16_f32 v64, v176, v177
    v_cvt_pk_bf16_f32 v65, v178, v179
    buffer_store_dwordx2 v[64:65], v32, s[40:43], s57 offen sc0 sc1
    s_xor_b32 s56, s52, 1
    s_lshl_b32 s57, s51, 2
    s_add_u32 s56, s56, s57
    s_lshl_b32 s57, s48, 3
    s_add_u32 s56, s56, s57
    s_mul_i32 s57, s56, 48
    s_lshl_b32 s58, s53, 2
    s_add_u32 s57, s57, s58
    s_add_u32 s57, s57, s52
    s_lshl_b32 s57, s57, 10
    v_fma_f32 v116, -v194, v220, v116
    v_fma_f32 v117, -v194, v221, v117
    v_fma_f32 v118, -v194, v222, v118
    v_fma_f32 v119, -v194, v223, v119
    v_fma_f32 v132, -v194, v224, v132
    v_fma_f32 v133, -v194, v225, v133
    v_fma_f32 v134, -v194, v226, v134
    v_fma_f32 v135, -v194, v227, v135
    v_mul_f32 v40, v116, v116
    v_mul_f32 v41, v117, v117
    v_mul_f32 v42, v118, v118
    v_mul_f32 v43, v119, v119
    v_mul_f32 v44, v132, v132
    v_mul_f32 v45, v133, v133
    v_mul_f32 v46, v134, v134
    v_mul_f32 v47, v135, v135
    v_fma_f32 v40, v40, v206, v205
    v_fma_f32 v41, v41, v206, v205
    v_fma_f32 v42, v42, v206, v205
    v_fma_f32 v43, v43, v206, v205
    v_fma_f32 v44, v44, v206, v205
    v_fma_f32 v45, v45, v206, v205
    v_fma_f32 v46, v46, v206, v205
    v_fma_f32 v47, v47, v206, v205
    v_mul_f32 v40, v40, v116
    v_mul_f32 v41, v41, v117
    v_mul_f32 v42, v42, v118
    v_mul_f32 v43, v43, v119
    v_mul_f32 v44, v44, v132
    v_mul_f32 v45, v45, v133
    v_mul_f32 v46, v46, v134
    v_mul_f32 v47, v47, v135
    v_exp_f32 v40, v40
    v_fma_f32 v148, -v194, v228, v148
    v_exp_f32 v41, v41
    v_fma_f32 v149, -v194, v229, v149
    v_exp_f32 v42, v42
    v_fma_f32 v150, -v194, v230, v150
    v_exp_f32 v43, v43
    v_fma_f32 v151, -v194, v231, v151
    v_exp_f32 v44, v44
    v_fma_f32 v164, -v194, v232, v164
    v_exp_f32 v45, v45
    v_fma_f32 v165, -v194, v233, v165
    v_exp_f32 v46, v46
    v_fma_f32 v166, -v194, v234, v166
    v_exp_f32 v47, v47
    v_fma_f32 v167, -v194, v235, v167
    v_fma_f32 v40, v40, v207, v207
    v_fma_f32 v41, v41, v207, v207
    v_fma_f32 v42, v42, v207, v207
    v_fma_f32 v43, v43, v207, v207
    v_fma_f32 v44, v44, v207, v207
    v_fma_f32 v45, v45, v207, v207
    v_fma_f32 v46, v46, v207, v207
    v_fma_f32 v47, v47, v207, v207
    v_rcp_f32 v40, v40
    v_mul_f32 v116, v116, v148
    v_rcp_f32 v41, v41
    v_mul_f32 v117, v117, v149
    v_rcp_f32 v42, v42
    v_mul_f32 v118, v118, v150
    v_rcp_f32 v43, v43
    v_mul_f32 v119, v119, v151
    v_rcp_f32 v44, v44
    v_mul_f32 v132, v132, v164
    v_rcp_f32 v45, v45
    v_mul_f32 v133, v133, v165
    v_rcp_f32 v46, v46
    v_mul_f32 v134, v134, v166
    v_rcp_f32 v47, v47
    v_mul_f32 v135, v135, v167
    v_mul_f32 v116, v116, v40
    v_mul_f32 v117, v117, v41
    v_mul_f32 v118, v118, v42
    v_mul_f32 v119, v119, v43
    v_mul_f32 v132, v132, v44
    v_mul_f32 v133, v133, v45
    v_mul_f32 v134, v134, v46
    v_mul_f32 v135, v135, v47
    v_cvt_pk_bf16_f32 v60, v116, v117
    v_cvt_pk_bf16_f32 v61, v118, v119
    v_cvt_pk_bf16_f32 v62, v132, v133
    v_cvt_pk_bf16_f32 v63, v134, v135
    buffer_store_dwordx4 v[60:63], v31, s[40:43], s57 offen sc0 sc1
    s_mul_i32 s57, s56, 20480
    s_lshl_b32 s58, s53, 11
    s_add_u32 s57, s57, s58
    s_lshl_b32 s58, s52, 9
    s_add_u32 s57, s57, s58
    s_add_u32 s57, s57, 6291456
    v_fma_f32 v180, -v194, v236, v180
    v_fma_f32 v181, -v194, v237, v181
    v_fma_f32 v182, -v194, v238, v182
    v_fma_f32 v183, -v194, v239, v183
    v_mul_f32 v48, v180, v209
    v_mul_f32 v49, v181, v209
    v_mul_f32 v50, v182, v209
    v_mul_f32 v51, v183, v209
    v_exp_f32 v48, v48 clamp
    v_mul_f32 v180, v180, v208
    v_exp_f32 v49, v49 clamp
    v_mul_f32 v181, v181, v208
    v_exp_f32 v50, v50 clamp
    v_mul_f32 v182, v182, v208
    v_exp_f32 v51, v51 clamp
    v_mul_f32 v183, v183, v208
    v_max_f32 v180, s70, v180
    v_max_f32 v181, s70, v181
    v_max_f32 v182, s70, v182
    v_max_f32 v183, s70, v183
    v_add_f32 v180, v180, v48
    v_add_f32 v181, v181, v49
    v_add_f32 v182, v182, v50
    v_add_f32 v183, v183, v51
    v_cvt_pk_bf16_f32 v66, v180, v181
    v_cvt_pk_bf16_f32 v67, v182, v183
    buffer_store_dwordx2 v[66:67], v32, s[40:43], s57 offen sc0 sc1
    s_xor_b32 s56, s52, 2
    s_lshl_b32 s57, s51, 2
    s_add_u32 s56, s56, s57
    s_lshl_b32 s57, s48, 3
    s_add_u32 s56, s56, s57
    s_mul_i32 s57, s56, 48
    s_lshl_b32 s58, s53, 2
    s_add_u32 s57, s57, s58
    s_add_u32 s57, s57, s52
    s_lshl_b32 s57, s57, 10
    v_fma_f32 v120, -v196, v220, v120
    v_fma_f32 v121, -v196, v221, v121
    v_fma_f32 v122, -v196, v222, v122
    v_fma_f32 v123, -v196, v223, v123
    v_fma_f32 v136, -v196, v224, v136
    v_fma_f32 v137, -v196, v225, v137
    v_fma_f32 v138, -v196, v226, v138
    v_fma_f32 v139, -v196, v227, v139
    v_mul_f32 v40, v120, v120
    v_mul_f32 v41, v121, v121
    v_mul_f32 v42, v122, v122
    v_mul_f32 v43, v123, v123
    v_mul_f32 v44, v136, v136
    v_mul_f32 v45, v137, v137
    v_mul_f32 v46, v138, v138
    v_mul_f32 v47, v139, v139
    v_fma_f32 v40, v40, v211, v210
    v_fma_f32 v41, v41, v211, v210
    v_fma_f32 v42, v42, v211, v210
    v_fma_f32 v43, v43, v211, v210
    v_fma_f32 v44, v44, v211, v210
    v_fma_f32 v45, v45, v211, v210
    v_fma_f32 v46, v46, v211, v210
    v_fma_f32 v47, v47, v211, v210
    v_mul_f32 v40, v40, v120
    v_mul_f32 v41, v41, v121
    v_mul_f32 v42, v42, v122
    v_mul_f32 v43, v43, v123
    v_mul_f32 v44, v44, v136
    v_mul_f32 v45, v45, v137
    v_mul_f32 v46, v46, v138
    v_mul_f32 v47, v47, v139
    v_exp_f32 v40, v40
    v_fma_f32 v152, -v196, v228, v152
    v_exp_f32 v41, v41
    v_fma_f32 v153, -v196, v229, v153
    v_exp_f32 v42, v42
    v_fma_f32 v154, -v196, v230, v154
    v_exp_f32 v43, v43
    v_fma_f32 v155, -v196, v231, v155
    v_exp_f32 v44, v44
    v_fma_f32 v168, -v196, v232, v168
    v_exp_f32 v45, v45
    v_fma_f32 v169, -v196, v233, v169
    v_exp_f32 v46, v46
    v_fma_f32 v170, -v196, v234, v170
    v_exp_f32 v47, v47
    v_fma_f32 v171, -v196, v235, v171
    v_fma_f32 v40, v40, v212, v212
    v_fma_f32 v41, v41, v212, v212
    v_fma_f32 v42, v42, v212, v212
    v_fma_f32 v43, v43, v212, v212
    v_fma_f32 v44, v44, v212, v212
    v_fma_f32 v45, v45, v212, v212
    v_fma_f32 v46, v46, v212, v212
    v_fma_f32 v47, v47, v212, v212
    v_rcp_f32 v40, v40
    v_mul_f32 v120, v120, v152
    v_rcp_f32 v41, v41
    v_mul_f32 v121, v121, v153
    v_rcp_f32 v42, v42
    v_mul_f32 v122, v122, v154
    v_rcp_f32 v43, v43
    v_mul_f32 v123, v123, v155
    v_rcp_f32 v44, v44
    v_mul_f32 v136, v136, v168
    v_rcp_f32 v45, v45
    v_mul_f32 v137, v137, v169
    v_rcp_f32 v46, v46
    v_mul_f32 v138, v138, v170
    v_rcp_f32 v47, v47
    v_mul_f32 v139, v139, v171
    v_mul_f32 v120, v120, v40
    v_mul_f32 v121, v121, v41
    v_mul_f32 v122, v122, v42
    v_mul_f32 v123, v123, v43
    v_mul_f32 v136, v136, v44
    v_mul_f32 v137, v137, v45
    v_mul_f32 v138, v138, v46
    v_mul_f32 v139, v139, v47
    v_cvt_pk_bf16_f32 v56, v120, v121
    v_cvt_pk_bf16_f32 v57, v122, v123
    v_cvt_pk_bf16_f32 v58, v136, v137
    v_cvt_pk_bf16_f32 v59, v138, v139
    buffer_store_dwordx4 v[56:59], v31, s[40:43], s57 offen sc0 sc1
    s_mul_i32 s57, s56, 20480
    s_lshl_b32 s58, s53, 11
    s_add_u32 s57, s57, s58
    s_lshl_b32 s58, s52, 9
    s_add_u32 s57, s57, s58
    s_add_u32 s57, s57, 6291456
    v_fma_f32 v184, -v196, v236, v184
    v_fma_f32 v185, -v196, v237, v185
    v_fma_f32 v186, -v196, v238, v186
    v_fma_f32 v187, -v196, v239, v187
    v_mul_f32 v48, v184, v214
    v_mul_f32 v49, v185, v214
    v_mul_f32 v50, v186, v214
    v_mul_f32 v51, v187, v214
    v_exp_f32 v48, v48 clamp
    v_mul_f32 v184, v184, v213
    v_exp_f32 v49, v49 clamp
    v_mul_f32 v185, v185, v213
    v_exp_f32 v50, v50 clamp
    v_mul_f32 v186, v186, v213
    v_exp_f32 v51, v51 clamp
    v_mul_f32 v187, v187, v213
    v_max_f32 v184, s70, v184
    v_max_f32 v185, s70, v185
    v_max_f32 v186, s70, v186
    v_max_f32 v187, s70, v187
    v_add_f32 v184, v184, v48
    v_add_f32 v185, v185, v49
    v_add_f32 v186, v186, v50
    v_add_f32 v187, v187, v51
    v_cvt_pk_bf16_f32 v64, v184, v185
    v_cvt_pk_bf16_f32 v65, v186, v187
    buffer_store_dwordx2 v[64:65], v32, s[40:43], s57 offen sc0 sc1
    s_xor_b32 s56, s52, 3
    s_lshl_b32 s57, s51, 2
    s_add_u32 s56, s56, s57
    s_lshl_b32 s57, s48, 3
    s_add_u32 s56, s56, s57
    s_mul_i32 s57, s56, 48
    s_lshl_b32 s58, s53, 2
    s_add_u32 s57, s57, s58
    s_add_u32 s57, s57, s52
    s_lshl_b32 s57, s57, 10
    v_fma_f32 v124, -v198, v220, v124
    v_fma_f32 v125, -v198, v221, v125
    v_fma_f32 v126, -v198, v222, v126
    v_fma_f32 v127, -v198, v223, v127
    v_fma_f32 v140, -v198, v224, v140
    v_fma_f32 v141, -v198, v225, v141
    v_fma_f32 v142, -v198, v226, v142
    v_fma_f32 v143, -v198, v227, v143
    v_mul_f32 v40, v124, v124
    v_mul_f32 v41, v125, v125
    v_mul_f32 v42, v126, v126
    v_mul_f32 v43, v127, v127
    v_mul_f32 v44, v140, v140
    v_mul_f32 v45, v141, v141
    v_mul_f32 v46, v142, v142
    v_mul_f32 v47, v143, v143
    v_fma_f32 v40, v40, v216, v215
    v_fma_f32 v41, v41, v216, v215
    v_fma_f32 v42, v42, v216, v215
    v_fma_f32 v43, v43, v216, v215
    v_fma_f32 v44, v44, v216, v215
    v_fma_f32 v45, v45, v216, v215
    v_fma_f32 v46, v46, v216, v215
    v_fma_f32 v47, v47, v216, v215
    v_mul_f32 v40, v40, v124
    v_mul_f32 v41, v41, v125
    v_mul_f32 v42, v42, v126
    v_mul_f32 v43, v43, v127
    v_mul_f32 v44, v44, v140
    v_mul_f32 v45, v45, v141
    v_mul_f32 v46, v46, v142
    v_mul_f32 v47, v47, v143
    v_exp_f32 v40, v40
    v_fma_f32 v156, -v198, v228, v156
    v_exp_f32 v41, v41
    v_fma_f32 v157, -v198, v229, v157
    v_exp_f32 v42, v42
    v_fma_f32 v158, -v198, v230, v158
    v_exp_f32 v43, v43
    v_fma_f32 v159, -v198, v231, v159
    v_exp_f32 v44, v44
    v_fma_f32 v172, -v198, v232, v172
    v_exp_f32 v45, v45
    v_fma_f32 v173, -v198, v233, v173
    v_exp_f32 v46, v46
    v_fma_f32 v174, -v198, v234, v174
    v_exp_f32 v47, v47
    v_fma_f32 v175, -v198, v235, v175
    v_fma_f32 v40, v40, v217, v217
    v_fma_f32 v41, v41, v217, v217
    v_fma_f32 v42, v42, v217, v217
    v_fma_f32 v43, v43, v217, v217
    v_fma_f32 v44, v44, v217, v217
    v_fma_f32 v45, v45, v217, v217
    v_fma_f32 v46, v46, v217, v217
    v_fma_f32 v47, v47, v217, v217
    v_rcp_f32 v40, v40
    v_mul_f32 v124, v124, v156
    v_rcp_f32 v41, v41
    v_mul_f32 v125, v125, v157
    v_rcp_f32 v42, v42
    v_mul_f32 v126, v126, v158
    v_rcp_f32 v43, v43
    v_mul_f32 v127, v127, v159
    v_rcp_f32 v44, v44
    v_mul_f32 v140, v140, v172
    v_rcp_f32 v45, v45
    v_mul_f32 v141, v141, v173
    v_rcp_f32 v46, v46
    v_mul_f32 v142, v142, v174
    v_rcp_f32 v47, v47
    v_mul_f32 v143, v143, v175
    v_mul_f32 v124, v124, v40
    v_mul_f32 v125, v125, v41
    v_mul_f32 v126, v126, v42
    v_mul_f32 v127, v127, v43
    v_mul_f32 v140, v140, v44
    v_mul_f32 v141, v141, v45
    v_mul_f32 v142, v142, v46
    v_mul_f32 v143, v143, v47
    v_cvt_pk_bf16_f32 v60, v124, v125
    v_cvt_pk_bf16_f32 v61, v126, v127
    v_cvt_pk_bf16_f32 v62, v140, v141
    v_cvt_pk_bf16_f32 v63, v142, v143
    buffer_store_dwordx4 v[60:63], v31, s[40:43], s57 offen sc0 sc1
    s_mul_i32 s57, s56, 20480
    s_lshl_b32 s58, s53, 11
    s_add_u32 s57, s57, s58
    s_lshl_b32 s58, s52, 9
    s_add_u32 s57, s57, s58
    s_add_u32 s57, s57, 6291456
    v_fma_f32 v188, -v198, v236, v188
    v_fma_f32 v189, -v198, v237, v189
    v_fma_f32 v190, -v198, v238, v190
    v_fma_f32 v191, -v198, v239, v191
    v_mul_f32 v48, v188, v219
    v_mul_f32 v49, v189, v219
    v_mul_f32 v50, v190, v219
    v_mul_f32 v51, v191, v219
    v_exp_f32 v48, v48 clamp
    v_mul_f32 v188, v188, v218
    v_exp_f32 v49, v49 clamp
    v_mul_f32 v189, v189, v218
    v_exp_f32 v50, v50 clamp
    v_mul_f32 v190, v190, v218
    v_exp_f32 v51, v51 clamp
    v_mul_f32 v191, v191, v218
    v_max_f32 v188, s70, v188
    v_max_f32 v189, s70, v189
    v_max_f32 v190, s70, v190
    v_max_f32 v191, s70, v191
    v_add_f32 v188, v188, v48
    v_add_f32 v189, v189, v49
    v_add_f32 v190, v190, v50
    v_add_f32 v191, v191, v51
    v_cvt_pk_bf16_f32 v66, v188, v189
    v_cvt_pk_bf16_f32 v67, v190, v191
    buffer_store_dwordx2 v[66:67], v32, s[40:43], s57 offen sc0 sc1
    s_lshl_b32 s71, s48, 1
    s_add_u32 s71, s71, s51
    s_lshl_b32 s71, s71, 9
    s_lshl_b32 s70, s53, 5
    s_add_u32 s71, s71, s70
    s_lshl_b32 s70, s52, 3
    s_add_u32 s71, s71, s70
    s_add_u32 s71, s71, 13074432
    s_mov_b32 s70, 0
    s_branch P2_START
P1_GU:
    s_lshl_b32 s59, s80, 1
    s_add_u32 m0, s55, 81920
    s_nop 0
    buffer_load_dwordx4 v4, s[24:27], s59 offen lds
    s_add_u32 m0, s55, 82944
    s_nop 0
    buffer_load_dwordx4 v5, s[24:27], s59 offen lds
    s_mul_i32 s58, s80, 3072
    s_add_u32 m0, s54, 0
    s_nop 0
    buffer_load_dwordx4 v6, s[28:31], s58 offen lds
    s_add_u32 m0, s54, 8192
    s_nop 0
    buffer_load_dwordx4 v6, s[32:35], s58 offen lds
    v_lshrrev_b32 v30, 2, v2
    v_and_b32 v31, 3, v2
    v_lshl_add_u32 v32, v3, 3, v30
    v_and_b32 v33, 1, v3
    v_lshl_or_b32 v34, v33, 2, v30
    s_lshl_b32 s56, s52, 1
    v_xor_b32 v34, s56, v34
    v_lshlrev_b32 v35, 8, v32
    v_lshl_add_u32 v35, v31, 3, v35
    v_lshl_add_u32 v9, v34, 5, v35
    v_xor_b32 v34, 1, v34
    v_lshl_add_u32 v11, v34, 5, v35
    v_add_u32 v10, 0x10000, v9
    v_add_u32 v12, 0x10000, v11
    v_lshrrev_b32 v34, 1, v30
    v_lshl_or_b32 v34, v33, 1, v34
    v_xor_b32 v34, s52, v34
    v_lshlrev_b32 v35, 7, v32
    v_lshl_add_u32 v35, v31, 3, v35
    v_lshl_add_u32 v35, v34, 5, v35
    v_add_u32 v17, 131072, v35
    v_lshrrev_b32 v30, 1, v2
    v_xor_b32 v30, v30, v3
    v_lshlrev_b32 v30, 4, v30
    v_lshl_add_u32 v30, v2, 7, v30
    v_xor_b32 v31, 64, v30
    s_lshl_b32 s57, s51, 13
    s_add_u32 s57, s57, 81920
    s_xor_b32 s56, s52, 0
    s_lshl_b32 s56, s56, 11
    s_add_u32 s56, s56, s57
    v_add_u32 v19, s56, v30
    v_add_u32 v20, s56, v31
    s_xor_b32 s56, s52, 1
    s_lshl_b32 s56, s56, 11
    s_add_u32 s56, s56, s57
    v_add_u32 v21, s56, v30
    v_add_u32 v22, s56, v31
    s_xor_b32 s56, s52, 2
    s_lshl_b32 s56, s56, 11
    s_add_u32 s56, s56, s57
    v_add_u32 v23, s56, v30
    v_add_u32 v24, s56, v31
    s_xor_b32 s56, s52, 3
    s_lshl_b32 s56, s56, 11
    s_add_u32 s56, s56, s57
    v_add_u32 v25, s56, v30
    v_add_u32 v26, s56, v31
    s_barrier
    s_mul_i32 s58, s80, 3072
    s_add_u32 s58, s58, 98304
    s_add_u32 m0, s54, 16384
    s_nop 0
    buffer_load_dwordx4 v6, s[28:31], s58 offen lds
    s_add_u32 m0, s54, 24576
    s_nop 0
    buffer_load_dwordx4 v6, s[32:35], s58 offen lds
    s_mov_b32 s92, s16
    s_mov_b32 s93, s17
    s_mov_b32 s94, 1966080
    s_mov_b32 s95, 0x20000
    s_mul_i32 s56, s48, 12
    s_add_u32 s56, s56, s53
    s_lshr_b32 s60, s56, 2
    s_and_b32 s61, s56, 3
    s_mul_i32 s62, s60, 40960
    s_mul_i32 s63, s61, 320
    s_add_u32 s62, s62, s63
    s_mov_b32 s59, 3277
    v_mov_b32 v34, 0x40000000
    v_add_u32 v30, 0, v0
    v_mul_u32_u24 v31, s59, v30
    v_lshrrev_b32 v31, 16, v31
    v_mul_u32_u24 v33, 20, v31
    v_sub_u32 v33, v30, v33
    v_mul_u32_u24 v31, 1280, v31
    v_lshl_add_u32 v31, v33, 4, v31
    s_add_u32 m0, s54, 65536
    s_nop 0
    buffer_load_dwordx4 v31, s[92:95], s62 offen lds
    v_add_u32 v30, 512, v0
    v_mul_u32_u24 v31, s59, v30
    v_lshrrev_b32 v31, 16, v31
    v_mul_u32_u24 v33, 20, v31
    v_sub_u32 v33, v30, v33
    v_mul_u32_u24 v31, 1280, v31
    v_lshl_add_u32 v31, v33, 4, v31
    v_cmp_gt_u32 vcc, 640, v30
    s_nop 1
    v_cndmask_b32 v31, v34, v31, vcc
    s_add_u32 m0, s54, 73728
    s_nop 0
    buffer_load_dwordx4 v31, s[92:95], s62 offen lds
    s_mul_i32 s90, s61, 96
    s_add_u32 s90, s90, s60
    s_mul_i32 s90, s90, 5
    s_add_u32 s90, s90, s50
    s_lshl_b32 s90, s90, 10
    s_add_u32 s90, s90, 8912896
    s_lshl_b32 s100, s61, 9
    s_lshl_b32 s62, s60, 3
    s_add_u32 s100, s100, s62
    s_add_u32 s100, s100, 13090816
    s_mov_b32 s96, s8
    s_mov_b32 s97, s9
    s_mov_b32 s98, 819200
    s_mov_b32 s99, 0x20000
    s_lshl_b32 s56, s48, 1
    s_add_u32 s56, s56, s53
    s_sub_u32 s56, s56, 10
    s_and_b32 s60, s56, 7
    s_lshr_b32 s61, s56, 3
    s_mul_i32 s62, s61, 204800
    s_mul_i32 s63, s60, 160
    s_add_u32 s62, s62, s63
    s_mov_b32 s59, 52429
    v_add_u32 v30, 0, v0
    v_mul_u32_u24 v31, s59, v30
    v_lshrrev_b32 v31, 19, v31
    v_mul_u32_u24 v33, 10, v31
    v_sub_u32 v33, v30, v33
    v_mul_u32_u24 v31, 1280, v31
    v_lshl_add_u32 v31, v33, 4, v31
    s_add_u32 m0, s54, 131072
    s_nop 0
    buffer_load_dwordx4 v31, s[96:99], s62 offen lds
    v_add_u32 v30, 512, v0
    v_mul_u32_u24 v31, s59, v30
    v_lshrrev_b32 v31, 19, v31
    v_mul_u32_u24 v33, 10, v31
    v_sub_u32 v33, v30, v33
    v_mul_u32_u24 v31, 1280, v31
    v_lshl_add_u32 v31, v33, 4, v31
    s_add_u32 m0, s54, 139264
    s_nop 0
    buffer_load_dwordx4 v31, s[96:99], s62 offen lds
    v_add_u32 v30, 1024, v0
    v_mul_u32_u24 v31, s59, v30
    v_lshrrev_b32 v31, 19, v31
    v_mul_u32_u24 v33, 10, v31
    v_sub_u32 v33, v30, v33
    v_mul_u32_u24 v31, 1280, v31
    v_lshl_add_u32 v31, v33, 4, v31
    s_add_u32 m0, s54, 147456
    s_nop 0
    buffer_load_dwordx4 v31, s[96:99], s62 offen lds
    v_add_u32 v30, 1536, v1
    v_mul_u32_u24 v31, s59, v30
    v_lshrrev_b32 v31, 19, v31
    v_mul_u32_u24 v33, 10, v31
    v_sub_u32 v33, v30, v33
    v_mul_u32_u24 v31, 1280, v31
    v_lshl_add_u32 v31, v33, 4, v31
    s_mov_b32 m0, 155648
    s_nop 0
    buffer_load_dwordx4 v31, s[96:99], s62 offen lds
    s_lshl_b32 s91, s60, 2
    s_add_u32 s91, s91, s61
    s_mul_i32 s91, s91, 25
    s_add_u32 s91, s91, s50
    s_lshl_b32 s91, s91, 10
    s_add_u32 s91, s91, 10878976
    s_lshl_b32 s101, s60, 7
    s_lshl_b32 s62, s61, 3
    s_add_u32 s101, s101, s62
    s_add_u32 s101, s101, 13092864
    s_cmp_ge_u32 s50, 5
    s_cselect_b32 s90, 0x40000000, s90
    s_cselect_b32 s91, 0x40000000, s91
    s_min_u32 s56, s50, 4
    s_lshl_b32 s56, s56, 5
    v_lshrrev_b32 v30, 2, v2
    v_and_b32 v31, 3, v2
    v_lshl_add_u32 v31, v31, 3, s56
    v_lshl_add_u32 v32, v3, 2, v30
    v_mul_u32_u24 v33, 320, v32
    v_add_u32 v33, v33, v31
    v_add_u32 v220, 65536, v33
    v_lshlrev_b32 v223, 4, v1
    v_mul_u32_u24 v33, 160, v32
    v_add_u32 v33, v33, v31
    v_add_u32 v221, 131072, v33
    v_mul_u32_u24 v33, 20, v30
    v_add_u32 v33, v33, v3
    v_mul_u32_u24 v33, 160, v33
    v_add_u32 v33, v33, v31
    v_add_u32 v222, 133632, v33
    v_mov_b32 v27, 0x3f803f80
    v_mov_b32 v244, 0x3f803f80
    v_mov_b32 v245, 0x3f803f80
    v_mov_b32 v246, 0x3f803f80
    v_mov_b32 v247, 0x3f803f80
    v_mov_b32 v112, 0
    v_mov_b32 v113, 0
    v_mov_b32 v114, 0
    v_mov_b32 v115, 0
    v_mov_b32 v116, 0
    v_mov_b32 v117, 0
    v_mov_b32 v118, 0
    v_mov_b32 v119, 0
    v_mov_b32 v120, 0
    v_mov_b32 v121, 0
    v_mov_b32 v122, 0
    v_mov_b32 v123, 0
    v_mov_b32 v124, 0
    v_mov_b32 v125, 0
    v_mov_b32 v126, 0
    v_mov_b32 v127, 0
    v_mov_b32 v128, 0
    v_mov_b32 v129, 0
    v_mov_b32 v130, 0
    v_mov_b32 v131, 0
    v_mov_b32 v132, 0
    v_mov_b32 v133, 0
    v_mov_b32 v134, 0
    v_mov_b32 v135, 0
    v_mov_b32 v136, 0
    v_mov_b32 v137, 0
    v_mov_b32 v138, 0
    v_mov_b32 v139, 0
    v_mov_b32 v140, 0
    v_mov_b32 v141, 0
    v_mov_b32 v142, 0
    v_mov_b32 v143, 0
    v_mov_b32 v144, 0
    v_mov_b32 v145, 0
    v_mov_b32 v146, 0
    v_mov_b32 v147, 0
    v_mov_b32 v148, 0
    v_mov_b32 v149, 0
    v_mov_b32 v150, 0
    v_mov_b32 v151, 0
    v_mov_b32 v152, 0
    v_mov_b32 v153, 0
    v_mov_b32 v154, 0
    v_mov_b32 v155, 0
    v_mov_b32 v156, 0
    v_mov_b32 v157, 0
    v_mov_b32 v158, 0
    v_mov_b32 v159, 0
    v_mov_b32 v160, 0
    v_mov_b32 v161, 0
    v_mov_b32 v162, 0
    v_mov_b32 v163, 0
    v_mov_b32 v164, 0
    v_mov_b32 v165, 0
    v_mov_b32 v166, 0
    v_mov_b32 v167, 0
    v_mov_b32 v168, 0
    v_mov_b32 v169, 0
    v_mov_b32 v170, 0
    v_mov_b32 v171, 0
    v_mov_b32 v172, 0
    v_mov_b32 v173, 0
    v_mov_b32 v174, 0
    v_mov_b32 v175, 0
    s_cmp_lg_u32 s51, 0
    s_cselect_b64 vcc, -1, 0
    s_waitcnt vmcnt(8)
    s_barrier
    ds_read_b128 v[40:43], v19 offset:0
    ds_read_b64_tr_b16 v[56:57], v9 offset:0
    ds_read_b64_tr_b16 v[58:59], v9 offset:1024
    ds_read_b128 v[44:47], v21 offset:0
    ds_read_b64_tr_b16 v[60:61], v11 offset:0
    ds_read_b64_tr_b16 v[62:63], v11 offset:1024
    ds_read_b128 v[48:51], v23 offset:0
    ds_read_b64_tr_b16 v[64:65], v9 offset:8192
    ds_read_b64_tr_b16 v[66:67], v9 offset:9216
    ds_read_b128 v[52:55], v25 offset:0
    ds_read_b64_tr_b16 v[68:69], v11 offset:8192
    ds_read_b64_tr_b16 v[70:71], v11 offset:9216
    s_lshl_b32 s59, s81, 1
    s_add_u32 m0, s55, 98304
    s_nop 0
    buffer_load_dwordx4 v4, s[24:27], s59 offen lds
    s_add_u32 m0, s55, 99328
    s_nop 0
    buffer_load_dwordx4 v5, s[24:27], s59 offen lds
    s_mul_i32 s58, s81, 3072
    s_add_u32 m0, s54, 32768
    s_nop 0
    buffer_load_dwordx4 v6, s[28:31], s58 offen lds
    s_add_u32 m0, s54, 40960
    s_nop 0
    buffer_load_dwordx4 v6, s[32:35], s58 offen lds
    s_mul_i32 s58, s81, 3072
    s_add_u32 s58, s58, 98304
    s_add_u32 m0, s54, 49152
    s_nop 0
    buffer_load_dwordx4 v6, s[28:31], s58 offen lds
    s_add_u32 m0, s54, 57344
    s_nop 0
    buffer_load_dwordx4 v6, s[32:35], s58 offen lds
    s_waitcnt vmcnt(6) lgkmcnt(0)
    s_barrier
    v_mfma_f32_16x16x32_bf16 v[112:115], v[56:59], v[40:43], v[112:115]
    ds_read_b128 v[76:79], v20 offset:0
    ds_read_b64_tr_b16 v[92:93], v9 offset:16384
    v_mfma_f32_16x16x32_bf16 v[116:119], v[56:59], v[44:47], v[116:119]
    ds_read_b64_tr_b16 v[94:95], v9 offset:17408
    ds_read_b128 v[80:83], v22 offset:0
    v_mfma_f32_16x16x32_bf16 v[120:123], v[56:59], v[48:51], v[120:123]
    ds_read_b64_tr_b16 v[96:97], v11 offset:16384
    ds_read_b64_tr_b16 v[98:99], v11 offset:17408
    v_mfma_f32_16x16x32_bf16 v[124:127], v[56:59], v[52:55], v[124:127]
    ds_read_b128 v[84:87], v24 offset:0
    ds_read_b64_tr_b16 v[100:101], v9 offset:24576
    v_mfma_f32_16x16x32_bf16 v[128:131], v[60:63], v[40:43], v[128:131]
    ds_read_b64_tr_b16 v[102:103], v9 offset:25600
    ds_read_b128 v[88:91], v26 offset:0
    v_mfma_f32_16x16x32_bf16 v[132:135], v[60:63], v[44:47], v[132:135]
    ds_read_b64_tr_b16 v[104:105], v11 offset:24576
    ds_read_b64_tr_b16 v[106:107], v11 offset:25600
    v_mfma_f32_16x16x32_bf16 v[136:139], v[60:63], v[48:51], v[136:139]
    ds_read_b64_tr_b16 v[192:193], v220 offset:0
    ds_read_b64_tr_b16 v[194:195], v220 offset:5120
    v_mfma_f32_16x16x32_bf16 v[140:143], v[60:63], v[52:55], v[140:143]
    ds_read_b64_tr_b16 v[196:197], v220 offset:160
    v_mfma_f32_16x16x32_bf16 v[144:147], v[64:67], v[40:43], v[144:147]
    ds_read_b64_tr_b16 v[198:199], v220 offset:5280
    ds_read_b64_tr_b16 v[200:201], v221 offset:0
    v_mfma_f32_16x16x32_bf16 v[148:151], v[64:67], v[44:47], v[148:151]
    ds_read_b64_tr_b16 v[202:203], v221 offset:3200
    ds_read_b64_tr_b16 v[204:205], v221 offset:6400
    v_mfma_f32_16x16x32_bf16 v[152:155], v[64:67], v[48:51], v[152:155]
    ds_read_b64_tr_b16 v[206:207], v221 offset:9600
    ds_read_b64_tr_b16 v[208:209], v222 offset:0
    v_mfma_f32_16x16x32_bf16 v[156:159], v[64:67], v[52:55], v[156:159]
    ds_read_b64_tr_b16 v[210:211], v221 offset:12800
    ds_read_b64_tr_b16 v[212:213], v221 offset:16000
    v_mfma_f32_16x16x32_bf16 v[160:163], v[68:71], v[40:43], v[160:163]
    ds_read_b64_tr_b16 v[214:215], v221 offset:19200
    ds_read_b64_tr_b16 v[216:217], v221 offset:22400
    v_mfma_f32_16x16x32_bf16 v[164:167], v[68:71], v[44:47], v[164:167]
    ds_read_b64_tr_b16 v[218:219], v222 offset:12800
    s_lshl_b32 s59, s82, 1
    s_add_u32 m0, s55, 114688
    s_nop 0
    buffer_load_dwordx4 v4, s[24:27], s59 offen lds
    v_mfma_f32_16x16x32_bf16 v[168:171], v[68:71], v[48:51], v[168:171]
    s_add_u32 m0, s55, 115712
    s_nop 0
    buffer_load_dwordx4 v5, s[24:27], s59 offen lds
    s_mul_i32 s58, s82, 3072
    s_add_u32 s58, s58, 98304
    s_add_u32 m0, s54, 0
    s_nop 0
    buffer_load_dwordx4 v6, s[28:31], s58 offen lds
    v_mfma_f32_16x16x32_bf16 v[172:175], v[68:71], v[52:55], v[172:175]
    s_add_u32 m0, s54, 8192
    s_nop 0
    buffer_load_dwordx4 v6, s[32:35], s58 offen lds
    s_waitcnt vmcnt(6) lgkmcnt(0)
    s_barrier
    v_mfma_f32_16x16x32_bf16 v[112:115], v[92:95], v[76:79], v[112:115]
    ds_read_b128 v[40:43], v19 offset:16384
    ds_read_b64_tr_b16 v[56:57], v9 offset:32768
    v_mfma_f32_16x16x32_bf16 v[116:119], v[92:95], v[80:83], v[116:119]
    ds_read_b64_tr_b16 v[58:59], v9 offset:33792
    v_mfma_f32_16x16x32_bf16 v[120:123], v[92:95], v[84:87], v[120:123]
    ds_read_b128 v[44:47], v21 offset:16384
    v_mfma_f32_16x16x32_bf16 v[124:127], v[92:95], v[88:91], v[124:127]
    ds_read_b64_tr_b16 v[60:61], v11 offset:32768
    v_mfma_f32_16x16x32_bf16 v[128:131], v[96:99], v[76:79], v[128:131]
    ds_read_b64_tr_b16 v[62:63], v11 offset:33792
    ds_read_b128 v[48:51], v23 offset:16384
    v_mfma_f32_16x16x32_bf16 v[132:135], v[96:99], v[80:83], v[132:135]
    ds_read_b64_tr_b16 v[64:65], v9 offset:40960
    v_mfma_f32_16x16x32_bf16 v[136:139], v[96:99], v[84:87], v[136:139]
    ds_read_b64_tr_b16 v[66:67], v9 offset:41984
    v_mfma_f32_16x16x32_bf16 v[140:143], v[96:99], v[88:91], v[140:143]
    ds_read_b128 v[52:55], v25 offset:16384
    v_mfma_f32_16x16x32_bf16 v[144:147], v[100:103], v[76:79], v[144:147]
    ds_read_b64_tr_b16 v[68:69], v11 offset:40960
    ds_read_b64_tr_b16 v[70:71], v11 offset:41984
    v_mfma_f32_16x16x32_bf16 v[148:151], v[100:103], v[80:83], v[148:151]
    buffer_store_dwordx4 v[192:195], v223, s[40:43], s90 offen sc0 sc1
    s_add_u32 s90, s90, 245760
    v_mfma_f32_16x16x32_bf16 v[152:155], v[100:103], v[84:87], v[152:155]
    buffer_store_dwordx4 v[196:199], v223, s[40:43], s90 offen sc0 sc1
    v_mfma_f32_16x16x32_bf16 v[156:159], v[100:103], v[88:91], v[156:159]
    s_mul_i32 s58, s82, 3072
    s_add_u32 m0, s54, 65536
    s_nop 0
    buffer_load_dwordx4 v6, s[28:31], s58 offen lds
    v_mfma_f32_16x16x32_bf16 v[160:163], v[104:107], v[76:79], v[160:163]
    s_add_u32 m0, s54, 73728
    s_nop 0
    buffer_load_dwordx4 v6, s[32:35], s58 offen lds
    s_mul_i32 s58, s83, 3072
    s_add_u32 m0, s54, 16384
    s_nop 0
    buffer_load_dwordx4 v6, s[28:31], s58 offen lds
    v_mfma_f32_16x16x32_bf16 v[164:167], v[104:107], v[80:83], v[164:167]
    s_add_u32 m0, s54, 24576
    s_nop 0
    buffer_load_dwordx4 v6, s[32:35], s58 offen lds
    v_mfma_f32_16x16x32_bf16 v[168:171], v[104:107], v[84:87], v[168:171]
    s_lshl_b32 s59, s83, 1
    s_add_u32 m0, s55, 81920
    s_nop 0
    buffer_load_dwordx4 v4, s[24:27], s59 offen lds
    v_mfma_f32_16x16x32_bf16 v[172:175], v[104:107], v[88:91], v[172:175]
    s_add_u32 m0, s55, 82944
    s_nop 0
    buffer_load_dwordx4 v5, s[24:27], s59 offen lds
    s_waitcnt vmcnt(12) lgkmcnt(0)
    s_barrier
    v_mfma_f32_16x16x32_bf16 v[112:115], v[56:59], v[40:43], v[112:115]
    ds_read_b128 v[76:79], v20 offset:16384
    ds_read_b64_tr_b16 v[92:93], v9 offset:49152
    v_mfma_f32_16x16x32_bf16 v[116:119], v[56:59], v[44:47], v[116:119]
    ds_read_b64_tr_b16 v[94:95], v9 offset:50176
    v_mfma_f32_16x16x32_bf16 v[120:123], v[56:59], v[48:51], v[120:123]
    ds_read_b128 v[80:83], v22 offset:16384
    v_mfma_f32_16x16x32_bf16 v[124:127], v[56:59], v[52:55], v[124:127]
    ds_read_b64_tr_b16 v[96:97], v11 offset:49152
    v_mfma_f32_16x16x32_bf16 v[128:131], v[60:63], v[40:43], v[128:131]
    ds_read_b64_tr_b16 v[98:99], v11 offset:50176
    v_mfma_f32_16x16x32_bf16 v[132:135], v[60:63], v[44:47], v[132:135]
    ds_read_b128 v[84:87], v24 offset:16384
    v_mfma_f32_16x16x32_bf16 v[136:139], v[60:63], v[48:51], v[136:139]
    ds_read_b64_tr_b16 v[100:101], v9 offset:57344
    v_mfma_f32_16x16x32_bf16 v[140:143], v[60:63], v[52:55], v[140:143]
    ds_read_b64_tr_b16 v[102:103], v9 offset:58368
    v_mfma_f32_16x16x32_bf16 v[144:147], v[64:67], v[40:43], v[144:147]
    ds_read_b128 v[88:91], v26 offset:16384
    v_mfma_f32_16x16x32_bf16 v[148:151], v[64:67], v[44:47], v[148:151]
    ds_read_b64_tr_b16 v[104:105], v11 offset:57344
    v_mfma_f32_16x16x32_bf16 v[152:155], v[64:67], v[48:51], v[152:155]
    ds_read_b64_tr_b16 v[106:107], v11 offset:58368
    v_mfma_f32_16x16x32_bf16 v[156:159], v[64:67], v[52:55], v[156:159]
    buffer_store_dwordx4 v[200:203], v223, s[40:43], s91 offen sc0 sc1
    s_add_u32 s91, s91, 5120
    v_mfma_f32_16x16x32_bf16 v[160:163], v[68:71], v[40:43], v[160:163]
    buffer_store_dwordx4 v[204:207], v223, s[40:43], s91 offen sc0 sc1
    s_add_u32 s91, s91, 5120
    v_mfma_f32_16x16x32_bf16 v[164:167], v[68:71], v[44:47], v[164:167]
    s_cmp_lg_u32 s50, 7
    s_cbranch_scc1 P1_GU_NL
    v_mov_b32 v30, 0
    buffer_load_dwordx2 v[238:239], v30, s[44:47], 0 offen offset:16 sc0 sc1
P1_GU_NL:
    v_mfma_f32_16x16x32_bf16 v[168:171], v[68:71], v[48:51], v[168:171]
    s_mul_i32 s58, s83, 3072
    s_add_u32 s58, s58, 98304
    s_add_u32 m0, s54, 32768
    s_nop 0
    buffer_load_dwordx4 v6, s[28:31], s58 offen lds
    v_mfma_f32_16x16x32_bf16 v[172:175], v[68:71], v[52:55], v[172:175]
    s_add_u32 m0, s54, 40960
    s_nop 0
    buffer_load_dwordx4 v6, s[32:35], s58 offen lds
    s_waitcnt vmcnt(8) lgkmcnt(0)
    s_barrier
    v_mfma_f32_16x16x32_bf16 v[112:115], v[92:95], v[76:79], v[112:115]
    ds_read_b128 v[40:43], v19 offset:32768
    ds_read_b64_tr_b16 v[56:57], v10 offset:0
    v_mfma_f32_16x16x32_bf16 v[116:119], v[92:95], v[80:83], v[116:119]
    ds_read_b64_tr_b16 v[58:59], v10 offset:1024
    v_mfma_f32_16x16x32_bf16 v[120:123], v[92:95], v[84:87], v[120:123]
    ds_read_b128 v[44:47], v21 offset:32768
    v_mfma_f32_16x16x32_bf16 v[124:127], v[92:95], v[88:91], v[124:127]
    ds_read_b64_tr_b16 v[60:61], v12 offset:0
    v_mfma_f32_16x16x32_bf16 v[128:131], v[96:99], v[76:79], v[128:131]
    ds_read_b64_tr_b16 v[62:63], v12 offset:1024
    v_mfma_f32_16x16x32_bf16 v[132:135], v[96:99], v[80:83], v[132:135]
    ds_read_b128 v[48:51], v23 offset:32768
    v_mfma_f32_16x16x32_bf16 v[136:139], v[96:99], v[84:87], v[136:139]
    ds_read_b64_tr_b16 v[64:65], v10 offset:8192
    v_mfma_f32_16x16x32_bf16 v[140:143], v[96:99], v[88:91], v[140:143]
    ds_read_b64_tr_b16 v[66:67], v10 offset:9216
    v_mfma_f32_16x16x32_bf16 v[144:147], v[100:103], v[76:79], v[144:147]
    ds_read_b128 v[52:55], v25 offset:32768
    ds_read_b64_tr_b16 v[68:69], v12 offset:8192
    v_mfma_f32_16x16x32_bf16 v[148:151], v[100:103], v[80:83], v[148:151]
    ds_read_b64_tr_b16 v[70:71], v12 offset:9216
    v_mfma_f32_16x16x32_bf16 v[152:155], v[100:103], v[84:87], v[152:155]
    buffer_store_dwordx4 v[208:211], v223, s[40:43], s91 offen sc0 sc1
    s_add_u32 s91, s91, 5120
    v_mfma_f32_16x16x32_bf16 v[156:159], v[100:103], v[88:91], v[156:159]
    buffer_store_dwordx4 v[212:215], v223, s[40:43], s91 offen sc0 sc1
    s_add_u32 s91, s91, 5120
    v_mfma_f32_16x16x32_bf16 v[160:163], v[104:107], v[76:79], v[160:163]
    s_mul_i32 s58, s84, 3072
    s_add_u32 m0, s54, 49152
    s_nop 0
    buffer_load_dwordx4 v6, s[28:31], s58 offen lds
    v_mfma_f32_16x16x32_bf16 v[164:167], v[104:107], v[80:83], v[164:167]
    s_add_u32 m0, s54, 57344
    s_nop 0
    buffer_load_dwordx4 v6, s[32:35], s58 offen lds
    v_mfma_f32_16x16x32_bf16 v[168:171], v[104:107], v[84:87], v[168:171]
    s_lshl_b32 s59, s84, 1
    s_add_u32 m0, s55, 98304
    s_nop 0
    buffer_load_dwordx4 v4, s[24:27], s59 offen lds
    v_mfma_f32_16x16x32_bf16 v[172:175], v[104:107], v[88:91], v[172:175]
    s_add_u32 m0, s55, 99328
    s_nop 0
    buffer_load_dwordx4 v5, s[24:27], s59 offen lds
    s_waitcnt vmcnt(18) lgkmcnt(0)
    s_barrier
    v_mfma_f32_16x16x32_bf16 v[112:115], v[56:59], v[40:43], v[112:115]
    ds_read_b128 v[76:79], v20 offset:32768
    v_mfma_f32_16x16x32_bf16 v[116:119], v[56:59], v[44:47], v[116:119]
    ds_read_b64_tr_b16 v[92:93], v9 offset:0
    v_mfma_f32_16x16x32_bf16 v[120:123], v[56:59], v[48:51], v[120:123]
    ds_read_b64_tr_b16 v[94:95], v9 offset:1024
    v_mfma_f32_16x16x32_bf16 v[124:127], v[56:59], v[52:55], v[124:127]
    ds_read_b128 v[80:83], v22 offset:32768
    v_mfma_f32_16x16x32_bf16 v[128:131], v[60:63], v[40:43], v[128:131]
    ds_read_b64_tr_b16 v[96:97], v11 offset:0
    v_mfma_f32_16x16x32_bf16 v[132:135], v[60:63], v[44:47], v[132:135]
    ds_read_b64_tr_b16 v[98:99], v11 offset:1024
    v_mfma_f32_16x16x32_bf16 v[136:139], v[60:63], v[48:51], v[136:139]
    ds_read_b128 v[84:87], v24 offset:32768
    v_mfma_f32_16x16x32_bf16 v[140:143], v[60:63], v[52:55], v[140:143]
    ds_read_b64_tr_b16 v[100:101], v9 offset:8192
    v_mfma_f32_16x16x32_bf16 v[144:147], v[64:67], v[40:43], v[144:147]
    ds_read_b64_tr_b16 v[102:103], v9 offset:9216
    v_mfma_f32_16x16x32_bf16 v[148:151], v[64:67], v[44:47], v[148:151]
    ds_read_b128 v[88:91], v26 offset:32768
    v_mfma_f32_16x16x32_bf16 v[152:155], v[64:67], v[48:51], v[152:155]
    ds_read_b64_tr_b16 v[104:105], v11 offset:8192
    v_mfma_f32_16x16x32_bf16 v[156:159], v[64:67], v[52:55], v[156:159]
    ds_read_b64_tr_b16 v[106:107], v11 offset:9216
    v_mfma_f32_16x16x32_bf16 v[160:163], v[68:71], v[40:43], v[160:163]
    buffer_store_dwordx4 v[216:219], v223, s[40:43], s91 offen sc0 sc1
    s_add_u32 s91, s91, 5120
    v_mfma_f32_16x16x32_bf16 v[164:167], v[68:71], v[44:47], v[164:167]
    s_mul_i32 s58, s84, 3072
    s_add_u32 s58, s58, 98304
    s_add_u32 m0, s54, 65536
    s_nop 0
    buffer_load_dwordx4 v6, s[28:31], s58 offen lds
    v_mfma_f32_16x16x32_bf16 v[168:171], v[68:71], v[48:51], v[168:171]
    s_add_u32 m0, s54, 73728
    s_nop 0
    buffer_load_dwordx4 v6, s[32:35], s58 offen lds
    v_mfma_f32_16x16x32_bf16 v[172:175], v[68:71], v[52:55], v[172:175]
    s_waitcnt vmcnt(13) lgkmcnt(0)
    s_barrier
    v_mfma_f32_16x16x32_bf16 v[112:115], v[92:95], v[76:79], v[112:115]
    ds_read_b128 v[40:43], v19 offset:0
    v_mfma_f32_16x16x32_bf16 v[116:119], v[92:95], v[80:83], v[116:119]
    ds_read_b64_tr_b16 v[56:57], v9 offset:16384
    v_mfma_f32_16x16x32_bf16 v[120:123], v[92:95], v[84:87], v[120:123]
    ds_read_b64_tr_b16 v[58:59], v9 offset:17408
    v_mfma_f32_16x16x32_bf16 v[124:127], v[92:95], v[88:91], v[124:127]
    ds_read_b128 v[44:47], v21 offset:0
    v_mfma_f32_16x16x32_bf16 v[128:131], v[96:99], v[76:79], v[128:131]
    ds_read_b64_tr_b16 v[60:61], v11 offset:16384
    v_mfma_f32_16x16x32_bf16 v[132:135], v[96:99], v[80:83], v[132:135]
    ds_read_b64_tr_b16 v[62:63], v11 offset:17408
    v_mfma_f32_16x16x32_bf16 v[136:139], v[96:99], v[84:87], v[136:139]
    ds_read_b128 v[48:51], v23 offset:0
    v_mfma_f32_16x16x32_bf16 v[140:143], v[96:99], v[88:91], v[140:143]
    ds_read_b64_tr_b16 v[64:65], v9 offset:24576
    v_mfma_f32_16x16x32_bf16 v[144:147], v[100:103], v[76:79], v[144:147]
    ds_read_b64_tr_b16 v[66:67], v9 offset:25600
    v_mfma_f32_16x16x32_bf16 v[148:151], v[100:103], v[80:83], v[148:151]
    ds_read_b128 v[52:55], v25 offset:0
    v_mfma_f32_16x16x32_bf16 v[152:155], v[100:103], v[84:87], v[152:155]
    ds_read_b64_tr_b16 v[68:69], v11 offset:24576
    v_mfma_f32_16x16x32_bf16 v[156:159], v[100:103], v[88:91], v[156:159]
    ds_read_b64_tr_b16 v[70:71], v11 offset:25600
    v_mfma_f32_16x16x32_bf16 v[160:163], v[104:107], v[76:79], v[160:163]
    s_mul_i32 s58, s85, 3072
    s_add_u32 m0, s54, 0
    s_nop 0
    buffer_load_dwordx4 v6, s[28:31], s58 offen lds
    v_mfma_f32_16x16x32_bf16 v[164:167], v[104:107], v[80:83], v[164:167]
    s_add_u32 m0, s54, 8192
    s_nop 0
    buffer_load_dwordx4 v6, s[32:35], s58 offen lds
    v_mfma_f32_16x16x32_bf16 v[168:171], v[104:107], v[84:87], v[168:171]
    s_lshl_b32 s59, s85, 1
    s_add_u32 m0, s55, 114688
    s_nop 0
    buffer_load_dwordx4 v4, s[24:27], s59 offen lds
    v_mfma_f32_16x16x32_bf16 v[172:175], v[104:107], v[88:91], v[172:175]
    s_add_u32 m0, s55, 115712
    s_nop 0
    buffer_load_dwordx4 v5, s[24:27], s59 offen lds
    s_waitcnt vmcnt(6) lgkmcnt(0)
    s_barrier
    s_cmp_lg_u32 s50, 7
    s_cbranch_scc1 P1_GU_NC_DONE
P1_GU_NC:
    v_readfirstlane_b32 s61, v238
    s_nop 1
    s_cmp_lg_u32 s61, 0
    s_cbranch_scc1 P1_GU_NC_OK
    s_add_u32 s3, s3, 1
    s_cmp_gt_u32 s3, 0x200000
    s_cbranch_scc1 K_END
    s_sleep 2
    v_mov_b32 v30, 0
    buffer_load_dwordx2 v[238:239], v30, s[44:47], 0 offen offset:16 sc0 sc1
    s_waitcnt vmcnt(0)
    s_branch P1_GU_NC
P1_GU_NC_OK:
    v_mov_b32 v30, 162048
    v_mov_b32 v31, 0
    ds_write_b64 v30, v[238:239]
    s_mov_b64 exec, 1
    buffer_store_dwordx2 v[238:239], v31, s[40:43], s100 offen sc0 sc1
    buffer_store_dwordx2 v[238:239], v31, s[40:43], s101 offen sc0 sc1
    s_mov_b64 exec, -1
P1_GU_NC_DONE:
    v_mfma_f32_16x16x32_bf16 v[112:115], v[56:59], v[40:43], v[112:115]
    ds_read_b128 v[76:79], v20 offset:0
    v_mfma_f32_16x16x32_bf16 v[116:119], v[56:59], v[44:47], v[116:119]
    ds_read_b64_tr_b16 v[92:93], v9 offset:32768
    v_mfma_f32_16x16x32_bf16 v[120:123], v[56:59], v[48:51], v[120:123]
    ds_read_b64_tr_b16 v[94:95], v9 offset:33792
    v_mfma_f32_16x16x32_bf16 v[124:127], v[56:59], v[52:55], v[124:127]
    ds_read_b128 v[80:83], v22 offset:0
    v_mfma_f32_16x16x32_bf16 v[128:131], v[60:63], v[40:43], v[128:131]
    ds_read_b64_tr_b16 v[96:97], v11 offset:32768
    v_mfma_f32_16x16x32_bf16 v[132:135], v[60:63], v[44:47], v[132:135]
    ds_read_b64_tr_b16 v[98:99], v11 offset:33792
    v_mfma_f32_16x16x32_bf16 v[136:139], v[60:63], v[48:51], v[136:139]
    ds_read_b128 v[84:87], v24 offset:0
    v_mfma_f32_16x16x32_bf16 v[140:143], v[60:63], v[52:55], v[140:143]
    ds_read_b64_tr_b16 v[100:101], v9 offset:40960
    v_mfma_f32_16x16x32_bf16 v[144:147], v[64:67], v[40:43], v[144:147]
    ds_read_b64_tr_b16 v[102:103], v9 offset:41984
    v_mfma_f32_16x16x32_bf16 v[148:151], v[64:67], v[44:47], v[148:151]
    ds_read_b128 v[88:91], v26 offset:0
    v_mfma_f32_16x16x32_bf16 v[152:155], v[64:67], v[48:51], v[152:155]
    ds_read_b64_tr_b16 v[104:105], v11 offset:40960
    v_mfma_f32_16x16x32_bf16 v[156:159], v[64:67], v[52:55], v[156:159]
    ds_read_b64_tr_b16 v[106:107], v11 offset:41984
    v_mfma_f32_16x16x32_bf16 v[160:163], v[68:71], v[40:43], v[160:163]
    s_mul_i32 s58, s85, 3072
    s_add_u32 s58, s58, 98304
    s_add_u32 m0, s54, 16384
    s_nop 0
    buffer_load_dwordx4 v6, s[28:31], s58 offen lds
    v_mfma_f32_16x16x32_bf16 v[164:167], v[68:71], v[44:47], v[164:167]
    s_add_u32 m0, s54, 24576
    s_nop 0
    buffer_load_dwordx4 v6, s[32:35], s58 offen lds
    v_mfma_f32_16x16x32_bf16 v[168:171], v[68:71], v[48:51], v[168:171]
    v_mfma_f32_16x16x32_bf16 v[192:195], v[244:247], v[40:43], 0
    v_mfma_f32_16x16x32_bf16 v[172:175], v[68:71], v[52:55], v[172:175]
    v_mfma_f32_16x16x32_bf16 v[196:199], v[40:43], v[40:43], 0
    s_cbranch_vccnz P1_GU_cs6
    v_mfma_f32_16x16x32_bf16 v[200:203], v[244:247], v[56:59], 0
    v_mfma_f32_16x16x32_bf16 v[204:207], v[244:247], v[60:63], 0
    v_mfma_f32_16x16x32_bf16 v[208:211], v[244:247], v[64:67], 0
    v_mfma_f32_16x16x32_bf16 v[212:215], v[244:247], v[68:71], 0
P1_GU_cs6:
    s_waitcnt vmcnt(9) lgkmcnt(0)
    s_barrier
    v_mfma_f32_16x16x32_bf16 v[112:115], v[92:95], v[76:79], v[112:115]
    ds_read_b128 v[40:43], v19 offset:16384
    ds_read_b64_tr_b16 v[56:57], v9 offset:49152
    v_mfma_f32_16x16x32_bf16 v[116:119], v[92:95], v[80:83], v[116:119]
    ds_read_b64_tr_b16 v[58:59], v9 offset:50176
    v_mfma_f32_16x16x32_bf16 v[120:123], v[92:95], v[84:87], v[120:123]
    ds_read_b128 v[44:47], v21 offset:16384
    v_mfma_f32_16x16x32_bf16 v[124:127], v[92:95], v[88:91], v[124:127]
    ds_read_b64_tr_b16 v[60:61], v11 offset:49152
    v_mfma_f32_16x16x32_bf16 v[128:131], v[96:99], v[76:79], v[128:131]
    ds_read_b64_tr_b16 v[62:63], v11 offset:50176
    v_mfma_f32_16x16x32_bf16 v[132:135], v[96:99], v[80:83], v[132:135]
    ds_read_b128 v[48:51], v23 offset:16384
    ds_read_b64_tr_b16 v[64:65], v9 offset:57344
    v_mfma_f32_16x16x32_bf16 v[136:139], v[96:99], v[84:87], v[136:139]
    ds_read_b64_tr_b16 v[66:67], v9 offset:58368
    v_mfma_f32_16x16x32_bf16 v[140:143], v[96:99], v[88:91], v[140:143]
    ds_read_b128 v[52:55], v25 offset:16384
    v_mfma_f32_16x16x32_bf16 v[144:147], v[100:103], v[76:79], v[144:147]
    ds_read_b64_tr_b16 v[68:69], v11 offset:57344
    v_mfma_f32_16x16x32_bf16 v[148:151], v[100:103], v[80:83], v[148:151]
    ds_read_b64_tr_b16 v[70:71], v11 offset:58368
    v_mfma_f32_16x16x32_bf16 v[152:155], v[100:103], v[84:87], v[152:155]
    v_mov_b32 v35, 162048
    ds_read_b64 v[238:239], v35
    s_mul_i32 s58, s86, 3072
    s_add_u32 m0, s54, 32768
    s_nop 0
    buffer_load_dwordx4 v6, s[28:31], s58 offen lds
    v_mfma_f32_16x16x32_bf16 v[156:159], v[100:103], v[88:91], v[156:159]
    s_add_u32 m0, s54, 40960
    s_nop 0
    buffer_load_dwordx4 v6, s[32:35], s58 offen lds
    v_mfma_f32_16x16x32_bf16 v[160:163], v[104:107], v[76:79], v[160:163]
    s_lshl_b32 s59, s86, 1
    s_add_u32 m0, s55, 81920
    s_nop 0
    buffer_load_dwordx4 v4, s[24:27], s59 offen lds
    v_mfma_f32_16x16x32_bf16 v[164:167], v[104:107], v[80:83], v[164:167]
    s_add_u32 m0, s55, 82944
    s_nop 0
    buffer_load_dwordx4 v5, s[24:27], s59 offen lds
    v_mfma_f32_16x16x32_bf16 v[168:171], v[104:107], v[84:87], v[168:171]
    v_mfma_f32_16x16x32_bf16 v[192:195], v[244:247], v[76:79], v[192:195]
    v_mfma_f32_16x16x32_bf16 v[172:175], v[104:107], v[88:91], v[172:175]
    v_mfma_f32_16x16x32_bf16 v[196:199], v[76:79], v[76:79], v[196:199]
    s_cbranch_vccz P1_GU_cs7
    v_mfma_f32_16x16x32_bf16 v[200:203], v[244:247], v[92:95], 0
    v_mfma_f32_16x16x32_bf16 v[204:207], v[244:247], v[96:99], 0
    v_mfma_f32_16x16x32_bf16 v[208:211], v[244:247], v[100:103], 0
    v_mfma_f32_16x16x32_bf16 v[212:215], v[244:247], v[104:107], 0
P1_GU_cs7:
    s_waitcnt vmcnt(10) lgkmcnt(0)
    s_barrier
    v_mfma_f32_16x16x32_bf16 v[112:115], v[56:59], v[40:43], v[112:115]
    ds_read_b128 v[76:79], v20 offset:16384
    ds_read_b64_tr_b16 v[92:93], v10 offset:0
    v_mfma_f32_16x16x32_bf16 v[116:119], v[56:59], v[44:47], v[116:119]
    ds_read_b64_tr_b16 v[94:95], v10 offset:1024
    v_mfma_f32_16x16x32_bf16 v[120:123], v[56:59], v[48:51], v[120:123]
    ds_read_b128 v[80:83], v22 offset:16384
    v_mfma_f32_16x16x32_bf16 v[124:127], v[56:59], v[52:55], v[124:127]
    ds_read_b64_tr_b16 v[96:97], v12 offset:0
    v_mfma_f32_16x16x32_bf16 v[128:131], v[60:63], v[40:43], v[128:131]
    ds_read_b64_tr_b16 v[98:99], v12 offset:1024
    v_mfma_f32_16x16x32_bf16 v[132:135], v[60:63], v[44:47], v[132:135]
    ds_read_b128 v[84:87], v24 offset:16384
    v_mfma_f32_16x16x32_bf16 v[136:139], v[60:63], v[48:51], v[136:139]
    ds_read_b64_tr_b16 v[100:101], v10 offset:8192
    v_mfma_f32_16x16x32_bf16 v[140:143], v[60:63], v[52:55], v[140:143]
    ds_read_b64_tr_b16 v[102:103], v10 offset:9216
    v_mfma_f32_16x16x32_bf16 v[144:147], v[64:67], v[40:43], v[144:147]
    ds_read_b128 v[88:91], v26 offset:16384
    ds_read_b64_tr_b16 v[104:105], v12 offset:8192
    v_mfma_f32_16x16x32_bf16 v[148:151], v[64:67], v[44:47], v[148:151]
    ds_read_b64_tr_b16 v[106:107], v12 offset:9216
    v_mfma_f32_16x16x32_bf16 v[152:155], v[64:67], v[48:51], v[152:155]
    v_and_b32 v32, 3, v2
    v_cmp_eq_u32 s[62:63], 1, v32
    v_cmp_eq_u32 s[64:65], 2, v32
    v_cmp_eq_u32 s[66:67], 3, v32
    v_lshrrev_b32 v32, 2, v2
    v_cndmask_b32 v193, v196, v197, s[62:63]
    v_cndmask_b32 v193, v193, v198, s[64:65]
    v_cndmask_b32 v193, v193, v199, s[66:67]
    v_cmp_eq_u32 s[62:63], v32, v3
    v_mfma_f32_16x16x32_bf16 v[156:159], v[64:67], v[52:55], v[156:159]
    s_lshl_b32 s61, s48, 4
    s_add_u32 s61, s61, s49
    s_lshl_b32 s61, s61, 10
    s_lshl_b32 s64, s50, 7
    s_add_u32 s61, s61, s64
    s_add_u32 s61, s61, 11763712
    v_lshlrev_b32 v30, 3, v2
    s_mov_b64 exec, s[62:63]
    buffer_store_dwordx2 v[192:193], v30, s[40:43], s61 offen sc0 sc1
    s_mov_b64 exec, -1
    v_mfma_f32_16x16x32_bf16 v[160:163], v[68:71], v[40:43], v[160:163]
    v_cmp_eq_u32 s[62:63], 1, v3
    v_cmp_eq_u32 s[64:65], 2, v3
    v_cmp_eq_u32 s[66:67], 3, v3
    s_lshl_b32 s61, s49, 2
    s_add_u32 s61, s61, s52
    s_lshl_b32 s61, s61, 4
    s_add_u32 s61, s61, s48
    s_lshl_b32 s61, s61, 1
    s_add_u32 s61, s61, s51
    s_lshl_b32 s61, s61, 9
    s_add_u32 s61, s61, 12025856
    v_cndmask_b32 v31, v200, v204, s[62:63]
    v_cndmask_b32 v31, v31, v208, s[64:65]
    v_cndmask_b32 v31, v31, v212, s[66:67]
    v_lshlrev_b32 v30, 2, v1
    buffer_store_dword v31, v30, s[40:43], s61 offen sc0 sc1
    v_mfma_f32_16x16x32_bf16 v[164:167], v[68:71], v[44:47], v[164:167]
    v_readfirstlane_b32 s92, v238
    v_readfirstlane_b32 s93, v239
    v_mfma_f32_16x16x32_bf16 v[168:171], v[68:71], v[48:51], v[168:171]
    s_mul_i32 s58, s86, 3072
    s_add_u32 s58, s58, 98304
    s_add_u32 m0, s54, 49152
    s_nop 0
    buffer_load_dwordx4 v6, s[28:31], s58 offen lds
    v_mfma_f32_16x16x32_bf16 v[172:175], v[68:71], v[52:55], v[172:175]
    s_add_u32 m0, s54, 57344
    s_nop 0
    buffer_load_dwordx4 v6, s[32:35], s58 offen lds
    s_waitcnt vmcnt(10) lgkmcnt(0)
    s_barrier
    v_mfma_f32_16x16x32_bf16 v[112:115], v[92:95], v[76:79], v[112:115]
    ds_read_b128 v[40:43], v19 offset:32768
    v_mfma_f32_16x16x32_bf16 v[116:119], v[92:95], v[80:83], v[116:119]
    ds_read_b64_tr_b16 v[56:57], v9 offset:0
    v_mfma_f32_16x16x32_bf16 v[120:123], v[92:95], v[84:87], v[120:123]
    ds_read_b64_tr_b16 v[58:59], v9 offset:1024
    v_mfma_f32_16x16x32_bf16 v[124:127], v[92:95], v[88:91], v[124:127]
    ds_read_b128 v[44:47], v21 offset:32768
    v_mfma_f32_16x16x32_bf16 v[128:131], v[96:99], v[76:79], v[128:131]
    ds_read_b64_tr_b16 v[60:61], v11 offset:0
    v_mfma_f32_16x16x32_bf16 v[132:135], v[96:99], v[80:83], v[132:135]
    ds_read_b64_tr_b16 v[62:63], v11 offset:1024
    v_mfma_f32_16x16x32_bf16 v[136:139], v[96:99], v[84:87], v[136:139]
    ds_read_b128 v[48:51], v23 offset:32768
    v_mfma_f32_16x16x32_bf16 v[140:143], v[96:99], v[88:91], v[140:143]
    ds_read_b64_tr_b16 v[64:65], v9 offset:8192
    v_mfma_f32_16x16x32_bf16 v[144:147], v[100:103], v[76:79], v[144:147]
    ds_read_b64_tr_b16 v[66:67], v9 offset:9216
    v_mfma_f32_16x16x32_bf16 v[148:151], v[100:103], v[80:83], v[148:151]
    ds_read_b128 v[52:55], v25 offset:32768
    v_mfma_f32_16x16x32_bf16 v[152:155], v[100:103], v[84:87], v[152:155]
    ds_read_b64_tr_b16 v[68:69], v11 offset:8192
    v_mfma_f32_16x16x32_bf16 v[156:159], v[100:103], v[88:91], v[156:159]
    ds_read_b64_tr_b16 v[70:71], v11 offset:9216
    v_mfma_f32_16x16x32_bf16 v[160:163], v[104:107], v[76:79], v[160:163]
    s_mul_i32 s58, s87, 3072
    s_add_u32 m0, s54, 65536
    s_nop 0
    buffer_load_dwordx4 v6, s[28:31], s58 offen lds
    v_mfma_f32_16x16x32_bf16 v[164:167], v[104:107], v[80:83], v[164:167]
    s_add_u32 m0, s54, 73728
    s_nop 0
    buffer_load_dwordx4 v6, s[32:35], s58 offen lds
    v_mfma_f32_16x16x32_bf16 v[168:171], v[104:107], v[84:87], v[168:171]
    s_lshl_b32 s59, s87, 1
    s_add_u32 m0, s55, 98304
    s_nop 0
    buffer_load_dwordx4 v4, s[24:27], s59 offen lds
    v_mfma_f32_16x16x32_bf16 v[172:175], v[104:107], v[88:91], v[172:175]
    s_add_u32 m0, s55, 99328
    s_nop 0
    buffer_load_dwordx4 v5, s[24:27], s59 offen lds
    s_waitcnt vmcnt(6) lgkmcnt(0)
    s_barrier
    s_cmp_lg_u32 s50, 7
    s_cbranch_scc1 P1_GU_SIG
    s_lshl_b32 s61, s48, 7
    s_lshl_b32 s62, s49, 3
    s_add_u32 s61, s61, s62
    s_add_u32 s61, s61, 13097984
    v_mov_b32 v31, 0
    v_mov_b32 v32, s92
    v_mov_b32 v33, s93
    s_mov_b64 exec, 1
    buffer_store_dwordx2 v[32:33], v31, s[40:43], s61 offen sc0 sc1
    s_lshl_b32 s61, s49, 7
    s_lshl_b32 s62, s48, 3
    s_add_u32 s61, s61, s62
    s_add_u32 s61, s61, 13100032
    buffer_store_dwordx2 v[32:33], v31, s[40:43], s61 offen sc0 sc1
    s_mov_b64 exec, -1
P1_GU_SIG:
    v_mfma_f32_16x16x32_bf16 v[112:115], v[56:59], v[40:43], v[112:115]
    ds_read_b128 v[76:79], v20 offset:32768
    v_mfma_f32_16x16x32_bf16 v[116:119], v[56:59], v[44:47], v[116:119]
    ds_read_b64_tr_b16 v[92:93], v9 offset:16384
    v_mfma_f32_16x16x32_bf16 v[120:123], v[56:59], v[48:51], v[120:123]
    ds_read_b64_tr_b16 v[94:95], v9 offset:17408
    v_mfma_f32_16x16x32_bf16 v[124:127], v[56:59], v[52:55], v[124:127]
    ds_read_b128 v[80:83], v22 offset:32768
    v_mfma_f32_16x16x32_bf16 v[128:131], v[60:63], v[40:43], v[128:131]
    ds_read_b64_tr_b16 v[96:97], v11 offset:16384
    v_mfma_f32_16x16x32_bf16 v[132:135], v[60:63], v[44:47], v[132:135]
    ds_read_b64_tr_b16 v[98:99], v11 offset:17408
    v_mfma_f32_16x16x32_bf16 v[136:139], v[60:63], v[48:51], v[136:139]
    ds_read_b128 v[84:87], v24 offset:32768
    v_mfma_f32_16x16x32_bf16 v[140:143], v[60:63], v[52:55], v[140:143]
    v_mfma_f32_16x16x32_bf16 v[144:147], v[64:67], v[40:43], v[144:147]
    ds_read_b64_tr_b16 v[100:101], v9 offset:24576
    v_mfma_f32_16x16x32_bf16 v[148:151], v[64:67], v[44:47], v[148:151]
    ds_read_b64_tr_b16 v[102:103], v9 offset:25600
    v_mfma_f32_16x16x32_bf16 v[152:155], v[64:67], v[48:51], v[152:155]
    ds_read_b128 v[88:91], v26 offset:32768
    v_mfma_f32_16x16x32_bf16 v[156:159], v[64:67], v[52:55], v[156:159]
    ds_read_b64_tr_b16 v[104:105], v11 offset:24576
    v_mfma_f32_16x16x32_bf16 v[160:163], v[68:71], v[40:43], v[160:163]
    ds_read_b64_tr_b16 v[106:107], v11 offset:25600
    v_mfma_f32_16x16x32_bf16 v[164:167], v[68:71], v[44:47], v[164:167]
    s_mul_i32 s58, s87, 3072
    s_add_u32 s58, s58, 98304
    s_add_u32 m0, s54, 0
    s_nop 0
    buffer_load_dwordx4 v6, s[28:31], s58 offen lds
    v_mfma_f32_16x16x32_bf16 v[168:171], v[68:71], v[48:51], v[168:171]
    s_add_u32 m0, s54, 8192
    s_nop 0
    buffer_load_dwordx4 v6, s[32:35], s58 offen lds
    v_mfma_f32_16x16x32_bf16 v[172:175], v[68:71], v[52:55], v[172:175]
    s_waitcnt vmcnt(10) lgkmcnt(0)
    s_barrier
    v_mfma_f32_16x16x32_bf16 v[112:115], v[92:95], v[76:79], v[112:115]
    ds_read_b128 v[40:43], v19 offset:0
    ds_read_b64_tr_b16 v[56:57], v9 offset:32768
    v_mfma_f32_16x16x32_bf16 v[116:119], v[92:95], v[80:83], v[116:119]
    ds_read_b64_tr_b16 v[58:59], v9 offset:33792
    v_mfma_f32_16x16x32_bf16 v[120:123], v[92:95], v[84:87], v[120:123]
    ds_read_b128 v[44:47], v21 offset:0
    v_mfma_f32_16x16x32_bf16 v[124:127], v[92:95], v[88:91], v[124:127]
    ds_read_b64_tr_b16 v[60:61], v11 offset:32768
    v_mfma_f32_16x16x32_bf16 v[128:131], v[96:99], v[76:79], v[128:131]
    ds_read_b64_tr_b16 v[62:63], v11 offset:33792
    v_mfma_f32_16x16x32_bf16 v[132:135], v[96:99], v[80:83], v[132:135]
    ds_read_b128 v[48:51], v23 offset:0
    v_mfma_f32_16x16x32_bf16 v[136:139], v[96:99], v[84:87], v[136:139]
    ds_read_b64_tr_b16 v[64:65], v9 offset:40960
    v_mfma_f32_16x16x32_bf16 v[140:143], v[96:99], v[88:91], v[140:143]
    ds_read_b64_tr_b16 v[66:67], v9 offset:41984
    v_mfma_f32_16x16x32_bf16 v[144:147], v[100:103], v[76:79], v[144:147]
    ds_read_b128 v[52:55], v25 offset:0
    v_mfma_f32_16x16x32_bf16 v[148:151], v[100:103], v[80:83], v[148:151]
    ds_read_b64_tr_b16 v[68:69], v11 offset:40960
    v_mfma_f32_16x16x32_bf16 v[152:155], v[100:103], v[84:87], v[152:155]
    ds_read_b64_tr_b16 v[70:71], v11 offset:41984
    v_mfma_f32_16x16x32_bf16 v[156:159], v[100:103], v[88:91], v[156:159]
    s_and_b32 s61, s2, 1
    s_lshl_b32 s61, s61, 2
    s_lshr_b32 s62, s2, 6
    s_add_u32 s61, s61, s62
    s_lshr_b32 s94, s61, 1
    s_lshl_b32 s94, s94, 9
    s_mul_i32 s62, s52, 96
    s_add_u32 s94, s94, s62
    s_add_u32 s94, s94, 13090816
    s_lshl_b32 s61, s61, 7
    s_lshl_b32 s62, s52, 3
    s_add_u32 s61, s61, s62
    s_add_u32 s61, s61, 13092864
    s_cmp_lg_u32 s51, 0
    s_cselect_b32 s94, s61, s94
    s_cselect_b32 s96, 1, 0xfff
    s_mov_b32 s97, 0
    v_lshlrev_b32 v240, 3, v1
    s_mov_b64 exec, s[96:97]
    buffer_load_dwordx2 v[238:239], v240, s[40:43], s94 offen sc0 sc1
    s_mov_b64 exec, -1
    v_mfma_f32_16x16x32_bf16 v[160:163], v[104:107], v[76:79], v[160:163]
    s_mul_i32 s58, s88, 3072
    s_add_u32 m0, s54, 16384
    s_nop 0
    buffer_load_dwordx4 v6, s[28:31], s58 offen lds
    v_mfma_f32_16x16x32_bf16 v[164:167], v[104:107], v[80:83], v[164:167]
    s_add_u32 m0, s54, 24576
    s_nop 0
    buffer_load_dwordx4 v6, s[32:35], s58 offen lds
    v_mfma_f32_16x16x32_bf16 v[168:171], v[104:107], v[84:87], v[168:171]
    s_lshl_b32 s59, s88, 1
    s_add_u32 m0, s55, 114688
    s_nop 0
    buffer_load_dwordx4 v4, s[24:27], s59 offen lds
    v_mfma_f32_16x16x32_bf16 v[172:175], v[104:107], v[88:91], v[172:175]
    s_add_u32 m0, s55, 115712
    s_nop 0
    buffer_load_dwordx4 v5, s[24:27], s59 offen lds
    s_waitcnt vmcnt(11) lgkmcnt(0)
    s_barrier
    v_mfma_f32_16x16x32_bf16 v[112:115], v[56:59], v[40:43], v[112:115]
    ds_read_b128 v[76:79], v20 offset:0
    v_mfma_f32_16x16x32_bf16 v[116:119], v[56:59], v[44:47], v[116:119]
    ds_read_b64_tr_b16 v[92:93], v9 offset:49152
    v_mfma_f32_16x16x32_bf16 v[120:123], v[56:59], v[48:51], v[120:123]
    ds_read_b64_tr_b16 v[94:95], v9 offset:50176
    v_mfma_f32_16x16x32_bf16 v[124:127], v[56:59], v[52:55], v[124:127]
    ds_read_b128 v[80:83], v22 offset:0
    v_mfma_f32_16x16x32_bf16 v[128:131], v[60:63], v[40:43], v[128:131]
    ds_read_b64_tr_b16 v[96:97], v11 offset:49152
    v_mfma_f32_16x16x32_bf16 v[132:135], v[60:63], v[44:47], v[132:135]
    ds_read_b64_tr_b16 v[98:99], v11 offset:50176
    v_mfma_f32_16x16x32_bf16 v[136:139], v[60:63], v[48:51], v[136:139]
    ds_read_b128 v[84:87], v24 offset:0
    v_mfma_f32_16x16x32_bf16 v[140:143], v[60:63], v[52:55], v[140:143]
    ds_read_b64_tr_b16 v[100:101], v9 offset:57344
    v_mfma_f32_16x16x32_bf16 v[144:147], v[64:67], v[40:43], v[144:147]
    ds_read_b64_tr_b16 v[102:103], v9 offset:58368
    v_mfma_f32_16x16x32_bf16 v[148:151], v[64:67], v[44:47], v[148:151]
    ds_read_b128 v[88:91], v26 offset:0
    v_mfma_f32_16x16x32_bf16 v[152:155], v[64:67], v[48:51], v[152:155]
    ds_read_b64_tr_b16 v[104:105], v11 offset:57344
    v_mfma_f32_16x16x32_bf16 v[156:159], v[64:67], v[52:55], v[156:159]
    ds_read_b64_tr_b16 v[106:107], v11 offset:58368
    v_mfma_f32_16x16x32_bf16 v[160:163], v[68:71], v[40:43], v[160:163]
    s_lshl_b32 s68, s48, 7
    s_add_u32 s68, s68, 13097984
    s_lshl_b32 s61, s49, 7
    s_add_u32 s62, s61, 13100032
    s_add_u32 s61, s61, 13102080
    s_cmp_lt_u32 s50, 2
    s_cselect_b32 s68, s68, s62
    s_cmp_ge_u32 s50, 6
    s_cselect_b32 s68, s61, s68
    s_cselect_b32 s98, 1, 0x3ff
    s_mov_b32 s99, 0
    s_mov_b64 exec, s[98:99]
    buffer_load_dwordx2 v[232:233], v240, s[40:43], s68 offen sc0 sc1
    s_mov_b64 exec, -1
    v_mfma_f32_16x16x32_bf16 v[164:167], v[68:71], v[44:47], v[164:167]
    s_mul_i32 s58, s88, 3072
    s_add_u32 s58, s58, 98304
    s_add_u32 m0, s54, 32768
    s_nop 0
    buffer_load_dwordx4 v6, s[28:31], s58 offen lds
    v_mfma_f32_16x16x32_bf16 v[168:171], v[68:71], v[48:51], v[168:171]
    s_add_u32 m0, s54, 40960
    s_nop 0
    buffer_load_dwordx4 v6, s[32:35], s58 offen lds
    v_mfma_f32_16x16x32_bf16 v[172:175], v[68:71], v[52:55], v[172:175]
    s_waitcnt vmcnt(10) lgkmcnt(0)
    s_barrier
    v_mfma_f32_16x16x32_bf16 v[112:115], v[92:95], v[76:79], v[112:115]
    ds_read_b128 v[40:43], v19 offset:16384
    v_mfma_f32_16x16x32_bf16 v[116:119], v[92:95], v[80:83], v[116:119]
    ds_read_b64_tr_b16 v[56:57], v10 offset:0
    v_mfma_f32_16x16x32_bf16 v[120:123], v[92:95], v[84:87], v[120:123]
    ds_read_b64_tr_b16 v[58:59], v10 offset:1024
    v_mfma_f32_16x16x32_bf16 v[124:127], v[92:95], v[88:91], v[124:127]
    ds_read_b128 v[44:47], v21 offset:16384
    v_mfma_f32_16x16x32_bf16 v[128:131], v[96:99], v[76:79], v[128:131]
    ds_read_b64_tr_b16 v[60:61], v12 offset:0
    v_mfma_f32_16x16x32_bf16 v[132:135], v[96:99], v[80:83], v[132:135]
    ds_read_b64_tr_b16 v[62:63], v12 offset:1024
    v_mfma_f32_16x16x32_bf16 v[136:139], v[96:99], v[84:87], v[136:139]
    ds_read_b128 v[48:51], v23 offset:16384
    v_mfma_f32_16x16x32_bf16 v[140:143], v[96:99], v[88:91], v[140:143]
    ds_read_b64_tr_b16 v[64:65], v10 offset:8192
    v_mfma_f32_16x16x32_bf16 v[144:147], v[100:103], v[76:79], v[144:147]
    ds_read_b64_tr_b16 v[66:67], v10 offset:9216
    v_mfma_f32_16x16x32_bf16 v[148:151], v[100:103], v[80:83], v[148:151]
    ds_read_b128 v[52:55], v25 offset:16384
    v_mfma_f32_16x16x32_bf16 v[152:155], v[100:103], v[84:87], v[152:155]
    ds_read_b64_tr_b16 v[68:69], v12 offset:8192
    v_mfma_f32_16x16x32_bf16 v[156:159], v[100:103], v[88:91], v[156:159]
    ds_read_b64_tr_b16 v[70:71], v12 offset:9216
    v_mfma_f32_16x16x32_bf16 v[160:163], v[104:107], v[76:79], v[160:163]
    s_mul_i32 s58, s89, 3072
    s_add_u32 m0, s54, 49152
    s_nop 0
    buffer_load_dwordx4 v6, s[28:31], s58 offen lds
    v_mfma_f32_16x16x32_bf16 v[164:167], v[104:107], v[80:83], v[164:167]
    s_add_u32 m0, s54, 57344
    s_nop 0
    buffer_load_dwordx4 v6, s[32:35], s58 offen lds
    v_mfma_f32_16x16x32_bf16 v[168:171], v[104:107], v[84:87], v[168:171]
    s_lshl_b32 s59, s89, 1
    s_add_u32 m0, s55, 81920
    s_nop 0
    buffer_load_dwordx4 v4, s[24:27], s59 offen lds
    v_mfma_f32_16x16x32_bf16 v[172:175], v[104:107], v[88:91], v[172:175]
    s_add_u32 m0, s55, 82944
    s_nop 0
    buffer_load_dwordx4 v5, s[24:27], s59 offen lds
    s_waitcnt vmcnt(6) lgkmcnt(0)
    s_barrier
    v_mfma_f32_16x16x32_bf16 v[112:115], v[56:59], v[40:43], v[112:115]
    ds_read_b128 v[76:79], v20 offset:16384
    v_mfma_f32_16x16x32_bf16 v[116:119], v[56:59], v[44:47], v[116:119]
    ds_read_b64_tr_b16 v[92:93], v9 offset:0
    v_mfma_f32_16x16x32_bf16 v[120:123], v[56:59], v[48:51], v[120:123]
    ds_read_b64_tr_b16 v[94:95], v9 offset:1024
    v_mfma_f32_16x16x32_bf16 v[124:127], v[56:59], v[52:55], v[124:127]
    ds_read_b128 v[80:83], v22 offset:16384
    v_mfma_f32_16x16x32_bf16 v[128:131], v[60:63], v[40:43], v[128:131]
    ds_read_b64_tr_b16 v[96:97], v11 offset:0
    v_mfma_f32_16x16x32_bf16 v[132:135], v[60:63], v[44:47], v[132:135]
    ds_read_b64_tr_b16 v[98:99], v11 offset:1024
    v_mfma_f32_16x16x32_bf16 v[136:139], v[60:63], v[48:51], v[136:139]
    ds_read_b128 v[84:87], v24 offset:16384
    v_mfma_f32_16x16x32_bf16 v[140:143], v[60:63], v[52:55], v[140:143]
    s_cmp_ge_u32 s50, 6
    s_cbranch_scc1 P1_GU_CI_ROW
    s_mov_b64 exec, s[98:99]
P1_GU_CHK:
    v_cmp_ne_u64 s[62:63], s[92:93], v[232:233]
    s_nop 1
    s_cmp_eq_u64 s[62:63], 0
    s_cbranch_scc1 P1_GU_OK
    s_add_u32 s3, s3, 1
    s_cmp_gt_u32 s3, 0x200000
    s_cbranch_scc1 K_END
    s_sleep 2
    buffer_load_dwordx2 v[232:233], v240, s[40:43], s68 offen sc0 sc1
    s_waitcnt vmcnt(0)
    s_branch P1_GU_CHK
P1_GU_OK:
    s_mov_b64 exec, -1
    s_sub_u32 s61, s50, 2
    s_cmp_lt_u32 s61, 4
    s_cbranch_scc1 P1_GU_CI_COL
P1_GU_CI_ROW:
    s_lshl_b32 s61, s48, 14
    s_add_u32 s61, s61, 11763712
    v_lshlrev_b32 v30, 3, v0
    buffer_load_dwordx2 v[192:193], v30, s[40:43], s61 offen offset:0 sc0 sc1
    buffer_load_dwordx2 v[194:195], v30, s[40:43], s61 offen offset:1024 sc0 sc1
    buffer_load_dwordx2 v[196:197], v30, s[40:43], s61 offen offset:2048 sc0 sc1
    buffer_load_dwordx2 v[198:199], v30, s[40:43], s61 offen offset:3072 sc0 sc1
    s_add_u32 s61, s61, 4096
    buffer_load_dwordx2 v[200:201], v30, s[40:43], s61 offen offset:0 sc0 sc1
    buffer_load_dwordx2 v[202:203], v30, s[40:43], s61 offen offset:1024 sc0 sc1
    buffer_load_dwordx2 v[204:205], v30, s[40:43], s61 offen offset:2048 sc0 sc1
    buffer_load_dwordx2 v[206:207], v30, s[40:43], s61 offen offset:3072 sc0 sc1
    s_add_u32 s61, s61, 4096
    buffer_load_dwordx2 v[208:209], v30, s[40:43], s61 offen offset:0 sc0 sc1
    buffer_load_dwordx2 v[210:211], v30, s[40:43], s61 offen offset:1024 sc0 sc1
    s_branch P1_GU_CI_DONE
P1_GU_CI_COL:
    s_lshl_b32 s61, s49, 2
    s_add_u32 s61, s61, s50
    s_sub_u32 s61, s61, 2
    s_lshl_b32 s61, s61, 14
    s_add_u32 s61, s61, 12025856
    v_lshlrev_b32 v30, 4, v1
    v_and_b32 v31, 31, v1
    v_cmp_gt_u32 s[62:63], 16, v31
    v_mov_b32 v31, 0x40000000
    s_nop 0
    v_cndmask_b32 v30, v31, v30, s[62:63]
    buffer_load_dwordx4 v[192:195], v30, s[40:43], s61 offen offset:0 sc0 sc1
    buffer_load_dwordx4 v[196:199], v30, s[40:43], s61 offen offset:1024 sc0 sc1
    buffer_load_dwordx4 v[200:203], v30, s[40:43], s61 offen offset:2048 sc0 sc1
    buffer_load_dwordx4 v[204:207], v30, s[40:43], s61 offen offset:3072 sc0 sc1
    s_add_u32 s61, s61, 4096
    buffer_load_dwordx4 v[208:211], v30, s[40:43], s61 offen offset:0 sc0 sc1
    buffer_load_dwordx4 v[212:215], v30, s[40:43], s61 offen offset:1024 sc0 sc1
    buffer_load_dwordx4 v[216:219], v30, s[40:43], s61 offen offset:2048 sc0 sc1
    buffer_load_dwordx4 v[220:223], v30, s[40:43], s61 offen offset:3072 sc0 sc1
    s_add_u32 s61, s61, 4096
    buffer_load_dwordx4 v[224:227], v30, s[40:43], s61 offen offset:0 sc0 sc1
    buffer_load_dwordx4 v[228:231], v30, s[40:43], s61 offen offset:1024 sc0 sc1
P1_GU_CI_DONE:
    v_mfma_f32_16x16x32_bf16 v[144:147], v[64:67], v[40:43], v[144:147]
    ds_read_b64_tr_b16 v[100:101], v9 offset:8192
    v_mfma_f32_16x16x32_bf16 v[148:151], v[64:67], v[44:47], v[148:151]
    ds_read_b64_tr_b16 v[102:103], v9 offset:9216
    v_mfma_f32_16x16x32_bf16 v[152:155], v[64:67], v[48:51], v[152:155]
    ds_read_b128 v[88:91], v26 offset:16384
    v_mfma_f32_16x16x32_bf16 v[156:159], v[64:67], v[52:55], v[156:159]
    ds_read_b64_tr_b16 v[104:105], v11 offset:8192
    v_mfma_f32_16x16x32_bf16 v[160:163], v[68:71], v[40:43], v[160:163]
    ds_read_b64_tr_b16 v[106:107], v11 offset:9216
    v_mfma_f32_16x16x32_bf16 v[164:167], v[68:71], v[44:47], v[164:167]
    s_mul_i32 s58, s89, 3072
    s_add_u32 s58, s58, 98304
    s_add_u32 m0, s54, 65536
    s_nop 0
    buffer_load_dwordx4 v6, s[28:31], s58 offen lds
    v_mfma_f32_16x16x32_bf16 v[168:171], v[68:71], v[48:51], v[168:171]
    s_add_u32 m0, s54, 73728
    s_nop 0
    buffer_load_dwordx4 v6, s[32:35], s58 offen lds
    v_mfma_f32_16x16x32_bf16 v[172:175], v[68:71], v[52:55], v[172:175]
    s_waitcnt vmcnt(19) lgkmcnt(0)
    s_barrier
    v_mfma_f32_16x16x32_bf16 v[112:115], v[92:95], v[76:79], v[112:115]
    ds_read_b128 v[40:43], v19 offset:32768
    v_mfma_f32_16x16x32_bf16 v[116:119], v[92:95], v[80:83], v[116:119]
    ds_read_b64_tr_b16 v[56:57], v9 offset:16384
    v_mfma_f32_16x16x32_bf16 v[120:123], v[92:95], v[84:87], v[120:123]
    ds_read_b64_tr_b16 v[58:59], v9 offset:17408
    v_mfma_f32_16x16x32_bf16 v[124:127], v[92:95], v[88:91], v[124:127]
    v_mfma_f32_16x16x32_bf16 v[128:131], v[96:99], v[76:79], v[128:131]
    ds_read_b128 v[44:47], v21 offset:32768
    v_mfma_f32_16x16x32_bf16 v[132:135], v[96:99], v[80:83], v[132:135]
    ds_read_b64_tr_b16 v[60:61], v11 offset:16384
    v_mfma_f32_16x16x32_bf16 v[136:139], v[96:99], v[84:87], v[136:139]
    ds_read_b64_tr_b16 v[62:63], v11 offset:17408
    v_mfma_f32_16x16x32_bf16 v[140:143], v[96:99], v[88:91], v[140:143]
    s_mov_b64 exec, s[96:97]
P1_GU_WF:
    v_cmp_ne_u64 s[62:63], s[92:93], v[238:239]
    s_nop 1
    s_cmp_eq_u64 s[62:63], 0
    s_cbranch_scc1 P1_GU_WF_OK
    s_add_u32 s3, s3, 1
    s_cmp_gt_u32 s3, 0x200000
    s_cbranch_scc1 K_END
    s_sleep 4
    buffer_load_dwordx2 v[238:239], v240, s[40:43], s94 offen sc0 sc1
    s_waitcnt vmcnt(0)
    s_branch P1_GU_WF
P1_GU_WF_OK:
    s_mov_b64 exec, -1
    v_mfma_f32_16x16x32_bf16 v[144:147], v[100:103], v[76:79], v[144:147]
    ds_read_b128 v[48:51], v23 offset:32768
    v_mfma_f32_16x16x32_bf16 v[148:151], v[100:103], v[80:83], v[148:151]
    ds_read_b64_tr_b16 v[64:65], v9 offset:24576
    v_mfma_f32_16x16x32_bf16 v[152:155], v[100:103], v[84:87], v[152:155]
    ds_read_b64_tr_b16 v[66:67], v9 offset:25600
    v_mfma_f32_16x16x32_bf16 v[156:159], v[100:103], v[88:91], v[156:159]
    v_mfma_f32_16x16x32_bf16 v[160:163], v[104:107], v[76:79], v[160:163]
    ds_read_b128 v[52:55], v25 offset:32768
    v_mfma_f32_16x16x32_bf16 v[164:167], v[104:107], v[80:83], v[164:167]
    ds_read_b64_tr_b16 v[68:69], v11 offset:24576
    v_mfma_f32_16x16x32_bf16 v[168:171], v[104:107], v[84:87], v[168:171]
    ds_read_b64_tr_b16 v[70:71], v11 offset:25600
    v_mfma_f32_16x16x32_bf16 v[172:175], v[104:107], v[88:91], v[172:175]
    s_waitcnt vmcnt(16) lgkmcnt(0)
    s_barrier
    v_mfma_f32_16x16x32_bf16 v[112:115], v[56:59], v[40:43], v[112:115]
    ds_read_b128 v[76:79], v20 offset:32768
    v_mfma_f32_16x16x32_bf16 v[116:119], v[56:59], v[44:47], v[116:119]
    ds_read_b64_tr_b16 v[92:93], v9 offset:32768
    v_mfma_f32_16x16x32_bf16 v[120:123], v[56:59], v[48:51], v[120:123]
    ds_read_b64_tr_b16 v[94:95], v9 offset:33792
    v_mfma_f32_16x16x32_bf16 v[124:127], v[56:59], v[52:55], v[124:127]
    v_mfma_f32_16x16x32_bf16 v[128:131], v[60:63], v[40:43], v[128:131]
    ds_read_b128 v[80:83], v22 offset:32768
    v_mfma_f32_16x16x32_bf16 v[132:135], v[60:63], v[44:47], v[132:135]
    ds_read_b64_tr_b16 v[96:97], v11 offset:32768
    v_mfma_f32_16x16x32_bf16 v[136:139], v[60:63], v[48:51], v[136:139]
    ds_read_b64_tr_b16 v[98:99], v11 offset:33792
    v_mfma_f32_16x16x32_bf16 v[140:143], v[60:63], v[52:55], v[140:143]
    v_mfma_f32_16x16x32_bf16 v[144:147], v[64:67], v[40:43], v[144:147]
    ds_read_b128 v[84:87], v24 offset:32768
    v_mfma_f32_16x16x32_bf16 v[148:151], v[64:67], v[44:47], v[148:151]
    ds_read_b64_tr_b16 v[100:101], v9 offset:40960
    v_mfma_f32_16x16x32_bf16 v[152:155], v[64:67], v[48:51], v[152:155]
    ds_read_b64_tr_b16 v[102:103], v9 offset:41984
    v_mfma_f32_16x16x32_bf16 v[156:159], v[64:67], v[52:55], v[156:159]
    v_mfma_f32_16x16x32_bf16 v[160:163], v[68:71], v[40:43], v[160:163]
    ds_read_b128 v[88:91], v26 offset:32768
    v_mfma_f32_16x16x32_bf16 v[164:167], v[68:71], v[44:47], v[164:167]
    ds_read_b64_tr_b16 v[104:105], v11 offset:40960
    v_mfma_f32_16x16x32_bf16 v[168:171], v[68:71], v[48:51], v[168:171]
    ds_read_b64_tr_b16 v[106:107], v11 offset:41984
    v_mfma_f32_16x16x32_bf16 v[172:175], v[68:71], v[52:55], v[172:175]
    s_waitcnt vmcnt(2)
    s_cmp_ge_u32 s50, 6
    s_cbranch_scc1 P1_GU_CF_DONE
    s_cmp_ge_u32 s50, 2
    s_cbranch_scc1 P1_GU_CF_COL
    v_add_f32 v192, v192, v202
    v_add_f32 v193, v193, v203
    v_add_f32 v194, v194, v204
    v_add_f32 v195, v195, v205
    v_add_f32 v196, v196, v206
    v_add_f32 v197, v197, v207
    v_add_f32 v198, v198, v208
    v_add_f32 v199, v199, v209
    v_add_f32 v200, v200, v210
    v_add_f32 v201, v201, v211
    v_add_f32 v192, v192, v194
    v_add_f32 v193, v193, v195
    v_add_f32 v196, v196, v198
    v_add_f32 v197, v197, v199
    v_add_f32 v192, v192, v200
    v_add_f32 v193, v193, v201
    v_add_f32 v192, v192, v196
    v_add_f32 v193, v193, v197
    v_mul_f32 v192, 0x3acccccd, v192
    v_mul_f32 v193, 0x3acccccd, v193
    v_fma_f32 v193, -v192, v192, v193
    v_max_f32 v193, 0, v193
    v_cvt_pk_bf16_f32 v192, v192, v192
    v_lshlrev_b32 v192, 16, v192
    v_cvt_pk_bf16_f32 v193, v193, v193
    v_lshlrev_b32 v193, 16, v193
    v_add_f32 v193, 0x3727c5ac, v193
    v_cvt_pk_bf16_f32 v193, v193, v193
    v_lshlrev_b32 v193, 16, v193
    v_sqrt_f32 v193, v193
    s_nop 0
    v_cvt_pk_bf16_f32 v193, v193, v193
    v_lshlrev_b32 v193, 16, v193
    v_mov_b32 v30, 159744
    v_lshl_add_u32 v30, v0, 3, v30
    ds_write_b64 v30, v[192:193]
    s_branch P1_GU_CF_DONE
P1_GU_CF_COL:
    v_add_f32 v192, v192, v212
    v_add_f32 v193, v193, v213
    v_add_f32 v194, v194, v214
    v_add_f32 v195, v195, v215
    v_add_f32 v196, v196, v216
    v_add_f32 v197, v197, v217
    v_add_f32 v198, v198, v218
    v_add_f32 v199, v199, v219
    v_add_f32 v200, v200, v220
    v_add_f32 v201, v201, v221
    v_add_f32 v202, v202, v222
    v_add_f32 v203, v203, v223
    v_add_f32 v204, v204, v224
    v_add_f32 v205, v205, v225
    v_add_f32 v206, v206, v226
    v_add_f32 v207, v207, v227
    v_add_f32 v208, v208, v228
    v_add_f32 v209, v209, v229
    v_add_f32 v210, v210, v230
    v_add_f32 v211, v211, v231
    v_add_f32 v192, v192, v200
    v_add_f32 v193, v193, v201
    v_add_f32 v194, v194, v202
    v_add_f32 v195, v195, v203
    v_add_f32 v196, v196, v204
    v_add_f32 v197, v197, v205
    v_add_f32 v198, v198, v206
    v_add_f32 v199, v199, v207
    v_add_f32 v192, v192, v196
    v_add_f32 v193, v193, v197
    v_add_f32 v194, v194, v198
    v_add_f32 v195, v195, v199
    v_add_f32 v192, v192, v208
    v_add_f32 v193, v193, v209
    v_add_f32 v194, v194, v210
    v_add_f32 v195, v195, v211
    v_mov_b32 v196, v192
    v_mov_b32 v197, v193
    v_mov_b32 v198, v194
    v_mov_b32 v199, v195
    v_permlane32_swap_b32 v192, v196
    v_permlane32_swap_b32 v193, v197
    v_permlane32_swap_b32 v194, v198
    v_permlane32_swap_b32 v195, v199
    v_add_f32 v192, v192, v196
    v_add_f32 v193, v193, v197
    v_add_f32 v194, v194, v198
    v_add_f32 v195, v195, v199
    s_sub_u32 s56, s50, 2
    s_mul_i32 s56, s56, 320
    s_add_u32 s56, s56, 160768
    v_lshl_add_u32 v30, v1, 4, s56
    s_mov_b64 exec, 0xfffff
    ds_write_b128 v30, v[192:195]
    s_mov_b64 exec, -1
P1_GU_CF_DONE:
    s_waitcnt vmcnt(12) lgkmcnt(0)
    s_barrier
    v_mfma_f32_16x16x32_bf16 v[112:115], v[92:95], v[76:79], v[112:115]
    ds_read_b128 v[40:43], v19 offset:0
    ds_read_b64_tr_b16 v[56:57], v9 offset:49152
    v_mfma_f32_16x16x32_bf16 v[116:119], v[92:95], v[80:83], v[116:119]
    ds_read_b64_tr_b16 v[58:59], v9 offset:50176
    v_mfma_f32_16x16x32_bf16 v[120:123], v[92:95], v[84:87], v[120:123]
    ds_read_b128 v[44:47], v21 offset:0
    v_mfma_f32_16x16x32_bf16 v[124:127], v[92:95], v[88:91], v[124:127]
    ds_read_b64_tr_b16 v[60:61], v11 offset:49152
    ds_read_b64_tr_b16 v[62:63], v11 offset:50176
    v_mfma_f32_16x16x32_bf16 v[128:131], v[96:99], v[76:79], v[128:131]
    ds_read_b128 v[48:51], v23 offset:0
    v_mfma_f32_16x16x32_bf16 v[132:135], v[96:99], v[80:83], v[132:135]
    ds_read_b64_tr_b16 v[64:65], v9 offset:57344
    v_mfma_f32_16x16x32_bf16 v[136:139], v[96:99], v[84:87], v[136:139]
    ds_read_b64_tr_b16 v[66:67], v9 offset:58368
    ds_read_b128 v[52:55], v25 offset:0
    v_mfma_f32_16x16x32_bf16 v[140:143], v[96:99], v[88:91], v[140:143]
    ds_read_b64_tr_b16 v[68:69], v11 offset:57344
    v_mfma_f32_16x16x32_bf16 v[144:147], v[100:103], v[76:79], v[144:147]
    ds_read_b64_tr_b16 v[70:71], v11 offset:58368
    v_mfma_f32_16x16x32_bf16 v[148:151], v[100:103], v[80:83], v[148:151]
    s_xor_b32 s56, s52, 0
    s_lshl_b32 s57, s51, 2
    s_add_u32 s56, s56, s57
    s_lshl_b32 s56, s56, 7
    s_add_u32 s56, s56, 159744
    v_lshl_add_u32 v30, v2, 3, s56
    ds_read_b64 v[192:193], v30
    s_xor_b32 s56, s52, 1
    s_lshl_b32 s57, s51, 2
    s_add_u32 s56, s56, s57
    s_lshl_b32 s56, s56, 7
    s_add_u32 s56, s56, 159744
    v_lshl_add_u32 v31, v2, 3, s56
    ds_read_b64 v[194:195], v31
    v_mfma_f32_16x16x32_bf16 v[152:155], v[100:103], v[84:87], v[152:155]
    s_xor_b32 s56, s52, 2
    s_lshl_b32 s57, s51, 2
    s_add_u32 s56, s56, s57
    s_lshl_b32 s56, s56, 7
    s_add_u32 s56, s56, 159744
    v_lshl_add_u32 v32, v2, 3, s56
    ds_read_b64 v[196:197], v32
    v_mfma_f32_16x16x32_bf16 v[156:159], v[100:103], v[88:91], v[156:159]
    s_xor_b32 s56, s52, 3
    s_lshl_b32 s57, s51, 2
    s_add_u32 s56, s56, s57
    s_lshl_b32 s56, s56, 7
    s_add_u32 s56, s56, 159744
    v_lshl_add_u32 v33, v2, 3, s56
    ds_read_b64 v[198:199], v33
    v_mfma_f32_16x16x32_bf16 v[160:163], v[104:107], v[76:79], v[160:163]
    s_mul_i32 s56, s52, 320
    s_add_u32 s56, s56, 160768
    v_lshl_add_u32 v34, v3, 4, s56
    ds_read_b128 v[220:223], v34 offset:0
    v_mfma_f32_16x16x32_bf16 v[164:167], v[104:107], v[80:83], v[164:167]
    ds_read_b128 v[224:227], v34 offset:64
    v_mfma_f32_16x16x32_bf16 v[168:171], v[104:107], v[84:87], v[168:171]
    ds_read_b128 v[228:231], v34 offset:128
    v_mfma_f32_16x16x32_bf16 v[172:175], v[104:107], v[88:91], v[172:175]
    ds_read_b128 v[232:235], v34 offset:192
    s_waitcnt vmcnt(0) lgkmcnt(0)
    s_barrier
    v_mfma_f32_16x16x32_bf16 v[112:115], v[56:59], v[40:43], v[112:115]
    ds_read_b128 v[76:79], v20 offset:0
    ds_read_b64_tr_b16 v[92:93], v10 offset:0
    v_mfma_f32_16x16x32_bf16 v[116:119], v[56:59], v[44:47], v[116:119]
    ds_read_b64_tr_b16 v[94:95], v10 offset:1024
    ds_read_b128 v[80:83], v22 offset:0
    v_mfma_f32_16x16x32_bf16 v[120:123], v[56:59], v[48:51], v[120:123]
    ds_read_b64_tr_b16 v[96:97], v12 offset:0
    v_mfma_f32_16x16x32_bf16 v[124:127], v[56:59], v[52:55], v[124:127]
    ds_read_b64_tr_b16 v[98:99], v12 offset:1024
    ds_read_b128 v[84:87], v24 offset:0
    v_mfma_f32_16x16x32_bf16 v[128:131], v[60:63], v[40:43], v[128:131]
    ds_read_b64_tr_b16 v[100:101], v10 offset:8192
    v_mfma_f32_16x16x32_bf16 v[132:135], v[60:63], v[44:47], v[132:135]
    ds_read_b64_tr_b16 v[102:103], v10 offset:9216
    ds_read_b128 v[88:91], v26 offset:0
    v_mfma_f32_16x16x32_bf16 v[136:139], v[60:63], v[48:51], v[136:139]
    ds_read_b64_tr_b16 v[104:105], v12 offset:8192
    v_mfma_f32_16x16x32_bf16 v[140:143], v[60:63], v[52:55], v[140:143]
    ds_read_b64_tr_b16 v[106:107], v12 offset:9216
    v_lshlrev_b32 v31, 4, v1
    v_lshlrev_b32 v32, 3, v1
    s_mov_b32 s70, 0x358637bd
    v_mfma_f32_16x16x32_bf16 v[144:147], v[64:67], v[40:43], v[144:147]
    v_rcp_f32 v203, v193
    v_mul_f32 v202, v193, v193
    v_rcp_f32 v208, v195
    v_mul_f32 v207, v195, v195
    v_mfma_f32_16x16x32_bf16 v[148:151], v[64:67], v[44:47], v[148:151]
    v_rcp_f32 v213, v197
    v_mul_f32 v212, v197, v197
    v_mfma_f32_16x16x32_bf16 v[152:155], v[64:67], v[48:51], v[152:155]
    v_rcp_f32 v218, v199
    v_mul_f32 v217, v199, v199
    v_mul_f32 v200, 0xc0135761, v203
    v_mul_f32 v201, v203, v203
    v_mul_f32 v204, 0x3fb8aa3b, v203
    v_mfma_f32_16x16x32_bf16 v[156:159], v[64:67], v[52:55], v[156:159]
    v_mul_f32 v205, 0xc0135761, v208
    v_mul_f32 v206, v208, v208
    v_mul_f32 v209, 0x3fb8aa3b, v208
    v_mfma_f32_16x16x32_bf16 v[160:163], v[68:71], v[40:43], v[160:163]
    v_mul_f32 v210, 0xc0135761, v213
    v_mul_f32 v211, v213, v213
    v_mul_f32 v214, 0x3fb8aa3b, v213
    v_mul_f32 v215, 0xc0135761, v218
    v_mul_f32 v216, v218, v218
    v_mul_f32 v219, 0x3fb8aa3b, v218
    v_mfma_f32_16x16x32_bf16 v[164:167], v[68:71], v[44:47], v[164:167]
    v_mul_f32 v201, v201, v200
    v_mul_f32 v201, 0x3d372713, v201
    v_mfma_f32_16x16x32_bf16 v[168:171], v[68:71], v[48:51], v[168:171]
    v_mul_f32 v206, v206, v205
    v_mul_f32 v206, 0x3d372713, v206
    v_mul_f32 v211, v211, v210
    v_mul_f32 v211, 0x3d372713, v211
    v_mfma_f32_16x16x32_bf16 v[172:175], v[68:71], v[52:55], v[172:175]
    v_mul_f32 v216, v216, v215
    v_mul_f32 v216, 0x3d372713, v216
    s_waitcnt lgkmcnt(0)
    s_barrier
    v_mfma_f32_16x16x32_bf16 v[112:115], v[92:95], v[76:79], v[112:115]
    s_and_b32 s61, s2, 1
    s_lshl_b32 s61, s61, 2
    s_lshr_b32 s62, s2, 6
    s_add_u32 s61, s61, s62
    s_mul_i32 s61, s61, 48
    s_mul_i32 s62, s52, 12
    s_add_u32 s61, s61, s62
    s_mul_i32 s61, s61, 5120
    s_mul_i32 s62, s51, 10240
    s_add_u32 s61, s61, s62
    s_add_u32 s61, s61, 8912896
    s_mul_i32 s63, s52, 20480
    s_add_u32 s63, s63, s62
    s_add_u32 s63, s63, 77824
    v_lshlrev_b32 v241, 4, v1
    v_mfma_f32_16x16x32_bf16 v[116:119], v[92:95], v[80:83], v[116:119]
    s_add_u32 m0, s63, 0
    s_nop 0
    buffer_load_dwordx4 v241, s[40:43], s61 offen sc0 sc1 lds
    s_add_u32 s61, s61, 1024
    v_mfma_f32_16x16x32_bf16 v[120:123], v[92:95], v[84:87], v[120:123]
    s_add_u32 m0, s63, 1024
    s_nop 0
    buffer_load_dwordx4 v241, s[40:43], s61 offen sc0 sc1 lds
    s_add_u32 s61, s61, 1024
    v_mfma_f32_16x16x32_bf16 v[124:127], v[92:95], v[88:91], v[124:127]
    v_mfma_f32_16x16x32_bf16 v[128:131], v[96:99], v[76:79], v[128:131]
    s_add_u32 m0, s63, 2048
    s_nop 0
    buffer_load_dwordx4 v241, s[40:43], s61 offen sc0 sc1 lds
    s_add_u32 s61, s61, 1024
    v_mfma_f32_16x16x32_bf16 v[132:135], v[96:99], v[80:83], v[132:135]
    s_add_u32 m0, s63, 3072
    s_nop 0
    buffer_load_dwordx4 v241, s[40:43], s61 offen sc0 sc1 lds
    s_add_u32 s61, s61, 1024
    v_mfma_f32_16x16x32_bf16 v[136:139], v[96:99], v[84:87], v[136:139]
    v_mfma_f32_16x16x32_bf16 v[140:143], v[96:99], v[88:91], v[140:143]
    s_add_u32 m0, s63, 4096
    s_nop 0
    buffer_load_dwordx4 v241, s[40:43], s61 offen sc0 sc1 lds
    s_add_u32 s61, s61, 1024
    v_mfma_f32_16x16x32_bf16 v[144:147], v[100:103], v[76:79], v[144:147]
    s_add_u32 m0, s63, 5120
    s_nop 0
    buffer_load_dwordx4 v241, s[40:43], s61 offen sc0 sc1 lds
    s_add_u32 s61, s61, 1024
    v_mfma_f32_16x16x32_bf16 v[148:151], v[100:103], v[80:83], v[148:151]
    v_mfma_f32_16x16x32_bf16 v[152:155], v[100:103], v[84:87], v[152:155]
    s_add_u32 m0, s63, 6144
    s_nop 0
    buffer_load_dwordx4 v241, s[40:43], s61 offen sc0 sc1 lds
    s_add_u32 s61, s61, 1024
    v_mfma_f32_16x16x32_bf16 v[156:159], v[100:103], v[88:91], v[156:159]
    s_add_u32 m0, s63, 7168
    s_nop 0
    buffer_load_dwordx4 v241, s[40:43], s61 offen sc0 sc1 lds
    s_add_u32 s61, s61, 1024
    v_mfma_f32_16x16x32_bf16 v[160:163], v[104:107], v[76:79], v[160:163]
    v_mfma_f32_16x16x32_bf16 v[164:167], v[104:107], v[80:83], v[164:167]
    s_add_u32 m0, s63, 8192
    s_nop 0
    buffer_load_dwordx4 v241, s[40:43], s61 offen sc0 sc1 lds
    s_add_u32 s61, s61, 1024
    v_mfma_f32_16x16x32_bf16 v[168:171], v[104:107], v[84:87], v[168:171]
    s_add_u32 m0, s63, 9216
    s_nop 0
    buffer_load_dwordx4 v241, s[40:43], s61 offen sc0 sc1 lds
    s_add_u32 s61, s61, 1024
    v_mfma_f32_16x16x32_bf16 v[172:175], v[104:107], v[88:91], v[172:175]
    s_xor_b32 s56, s52, 0
    s_lshl_b32 s57, s51, 2
    s_add_u32 s56, s56, s57
    s_lshl_b32 s57, s48, 3
    s_add_u32 s56, s56, s57
    s_mul_i32 s57, s56, 48
    s_lshl_b32 s58, s53, 2
    s_add_u32 s57, s57, s58
    s_add_u32 s57, s57, s52
    s_lshl_b32 s57, s57, 10
    v_fma_f32 v112, -v192, v220, v112
    v_fma_f32 v113, -v192, v221, v113
    v_fma_f32 v114, -v192, v222, v114
    v_fma_f32 v115, -v192, v223, v115
    v_fma_f32 v128, -v192, v224, v128
    v_fma_f32 v129, -v192, v225, v129
    v_fma_f32 v130, -v192, v226, v130
    v_fma_f32 v131, -v192, v227, v131
    v_mul_f32 v40, v112, v112
    v_mul_f32 v41, v113, v113
    v_mul_f32 v42, v114, v114
    v_mul_f32 v43, v115, v115
    v_mul_f32 v44, v128, v128
    v_mul_f32 v45, v129, v129
    v_mul_f32 v46, v130, v130
    v_mul_f32 v47, v131, v131
    v_fma_f32 v40, v40, v201, v200
    v_fma_f32 v41, v41, v201, v200
    v_fma_f32 v42, v42, v201, v200
    v_fma_f32 v43, v43, v201, v200
    v_fma_f32 v44, v44, v201, v200
    v_fma_f32 v45, v45, v201, v200
    v_fma_f32 v46, v46, v201, v200
    v_fma_f32 v47, v47, v201, v200
    v_mul_f32 v40, v40, v112
    v_mul_f32 v41, v41, v113
    v_mul_f32 v42, v42, v114
    v_mul_f32 v43, v43, v115
    v_mul_f32 v44, v44, v128
    v_mul_f32 v45, v45, v129
    v_mul_f32 v46, v46, v130
    v_mul_f32 v47, v47, v131
    v_exp_f32 v40, v40
    v_fma_f32 v144, -v192, v228, v144
    v_exp_f32 v41, v41
    v_fma_f32 v145, -v192, v229, v145
    v_exp_f32 v42, v42
    v_fma_f32 v146, -v192, v230, v146
    v_exp_f32 v43, v43
    v_fma_f32 v147, -v192, v231, v147
    v_exp_f32 v44, v44
    v_fma_f32 v160, -v192, v232, v160
    v_exp_f32 v45, v45
    v_fma_f32 v161, -v192, v233, v161
    v_exp_f32 v46, v46
    v_fma_f32 v162, -v192, v234, v162
    v_exp_f32 v47, v47
    v_fma_f32 v163, -v192, v235, v163
    v_fma_f32 v40, v40, v202, v202
    v_fma_f32 v41, v41, v202, v202
    v_fma_f32 v42, v42, v202, v202
    v_fma_f32 v43, v43, v202, v202
    v_fma_f32 v44, v44, v202, v202
    v_fma_f32 v45, v45, v202, v202
    v_fma_f32 v46, v46, v202, v202
    v_fma_f32 v47, v47, v202, v202
    v_rcp_f32 v40, v40
    v_mul_f32 v112, v112, v144
    v_rcp_f32 v41, v41
    v_mul_f32 v113, v113, v145
    v_rcp_f32 v42, v42
    v_mul_f32 v114, v114, v146
    v_rcp_f32 v43, v43
    v_mul_f32 v115, v115, v147
    v_rcp_f32 v44, v44
    v_mul_f32 v128, v128, v160
    v_rcp_f32 v45, v45
    v_mul_f32 v129, v129, v161
    v_rcp_f32 v46, v46
    v_mul_f32 v130, v130, v162
    v_rcp_f32 v47, v47
    v_mul_f32 v131, v131, v163
    v_mul_f32 v112, v112, v40
    v_mul_f32 v113, v113, v41
    v_mul_f32 v114, v114, v42
    v_mul_f32 v115, v115, v43
    v_mul_f32 v128, v128, v44
    v_mul_f32 v129, v129, v45
    v_mul_f32 v130, v130, v46
    v_mul_f32 v131, v131, v47
    v_cvt_pk_bf16_f32 v56, v112, v113
    v_cvt_pk_bf16_f32 v57, v114, v115
    v_cvt_pk_bf16_f32 v58, v128, v129
    v_cvt_pk_bf16_f32 v59, v130, v131
    buffer_store_dwordx4 v[56:59], v31, s[40:43], s57 offen sc0 sc1
    s_xor_b32 s56, s52, 1
    s_lshl_b32 s57, s51, 2
    s_add_u32 s56, s56, s57
    s_lshl_b32 s57, s48, 3
    s_add_u32 s56, s56, s57
    s_mul_i32 s57, s56, 48
    s_lshl_b32 s58, s53, 2
    s_add_u32 s57, s57, s58
    s_add_u32 s57, s57, s52
    s_lshl_b32 s57, s57, 10
    v_fma_f32 v116, -v194, v220, v116
    v_fma_f32 v117, -v194, v221, v117
    v_fma_f32 v118, -v194, v222, v118
    v_fma_f32 v119, -v194, v223, v119
    v_fma_f32 v132, -v194, v224, v132
    v_fma_f32 v133, -v194, v225, v133
    v_fma_f32 v134, -v194, v226, v134
    v_fma_f32 v135, -v194, v227, v135
    v_mul_f32 v40, v116, v116
    v_mul_f32 v41, v117, v117
    v_mul_f32 v42, v118, v118
    v_mul_f32 v43, v119, v119
    v_mul_f32 v44, v132, v132
    v_mul_f32 v45, v133, v133
    v_mul_f32 v46, v134, v134
    v_mul_f32 v47, v135, v135
    v_fma_f32 v40, v40, v206, v205
    v_fma_f32 v41, v41, v206, v205
    v_fma_f32 v42, v42, v206, v205
    v_fma_f32 v43, v43, v206, v205
    v_fma_f32 v44, v44, v206, v205
    v_fma_f32 v45, v45, v206, v205
    v_fma_f32 v46, v46, v206, v205
    v_fma_f32 v47, v47, v206, v205
    v_mul_f32 v40, v40, v116
    v_mul_f32 v41, v41, v117
    v_mul_f32 v42, v42, v118
    v_mul_f32 v43, v43, v119
    v_mul_f32 v44, v44, v132
    v_mul_f32 v45, v45, v133
    v_mul_f32 v46, v46, v134
    v_mul_f32 v47, v47, v135
    v_exp_f32 v40, v40
    v_fma_f32 v148, -v194, v228, v148
    v_exp_f32 v41, v41
    v_fma_f32 v149, -v194, v229, v149
    v_exp_f32 v42, v42
    v_fma_f32 v150, -v194, v230, v150
    v_exp_f32 v43, v43
    v_fma_f32 v151, -v194, v231, v151
    v_exp_f32 v44, v44
    v_fma_f32 v164, -v194, v232, v164
    v_exp_f32 v45, v45
    v_fma_f32 v165, -v194, v233, v165
    v_exp_f32 v46, v46
    v_fma_f32 v166, -v194, v234, v166
    v_exp_f32 v47, v47
    v_fma_f32 v167, -v194, v235, v167
    v_fma_f32 v40, v40, v207, v207
    v_fma_f32 v41, v41, v207, v207
    v_fma_f32 v42, v42, v207, v207
    v_fma_f32 v43, v43, v207, v207
    v_fma_f32 v44, v44, v207, v207
    v_fma_f32 v45, v45, v207, v207
    v_fma_f32 v46, v46, v207, v207
    v_fma_f32 v47, v47, v207, v207
    v_rcp_f32 v40, v40
    v_mul_f32 v116, v116, v148
    v_rcp_f32 v41, v41
    v_mul_f32 v117, v117, v149
    v_rcp_f32 v42, v42
    v_mul_f32 v118, v118, v150
    v_rcp_f32 v43, v43
    v_mul_f32 v119, v119, v151
    v_rcp_f32 v44, v44
    v_mul_f32 v132, v132, v164
    v_rcp_f32 v45, v45
    v_mul_f32 v133, v133, v165
    v_rcp_f32 v46, v46
    v_mul_f32 v134, v134, v166
    v_rcp_f32 v47, v47
    v_mul_f32 v135, v135, v167
    v_mul_f32 v116, v116, v40
    v_mul_f32 v117, v117, v41
    v_mul_f32 v118, v118, v42
    v_mul_f32 v119, v119, v43
    v_mul_f32 v132, v132, v44
    v_mul_f32 v133, v133, v45
    v_mul_f32 v134, v134, v46
    v_mul_f32 v135, v135, v47
    v_cvt_pk_bf16_f32 v60, v116, v117
    v_cvt_pk_bf16_f32 v61, v118, v119
    v_cvt_pk_bf16_f32 v62, v132, v133
    v_cvt_pk_bf16_f32 v63, v134, v135
    buffer_store_dwordx4 v[60:63], v31, s[40:43], s57 offen sc0 sc1
    s_xor_b32 s56, s52, 2
    s_lshl_b32 s57, s51, 2
    s_add_u32 s56, s56, s57
    s_lshl_b32 s57, s48, 3
    s_add_u32 s56, s56, s57
    s_mul_i32 s57, s56, 48
    s_lshl_b32 s58, s53, 2
    s_add_u32 s57, s57, s58
    s_add_u32 s57, s57, s52
    s_lshl_b32 s57, s57, 10
    v_fma_f32 v120, -v196, v220, v120
    v_fma_f32 v121, -v196, v221, v121
    v_fma_f32 v122, -v196, v222, v122
    v_fma_f32 v123, -v196, v223, v123
    v_fma_f32 v136, -v196, v224, v136
    v_fma_f32 v137, -v196, v225, v137
    v_fma_f32 v138, -v196, v226, v138
    v_fma_f32 v139, -v196, v227, v139
    v_mul_f32 v40, v120, v120
    v_mul_f32 v41, v121, v121
    v_mul_f32 v42, v122, v122
    v_mul_f32 v43, v123, v123
    v_mul_f32 v44, v136, v136
    v_mul_f32 v45, v137, v137
    v_mul_f32 v46, v138, v138
    v_mul_f32 v47, v139, v139
    v_fma_f32 v40, v40, v211, v210
    v_fma_f32 v41, v41, v211, v210
    v_fma_f32 v42, v42, v211, v210
    v_fma_f32 v43, v43, v211, v210
    v_fma_f32 v44, v44, v211, v210
    v_fma_f32 v45, v45, v211, v210
    v_fma_f32 v46, v46, v211, v210
    v_fma_f32 v47, v47, v211, v210
    v_mul_f32 v40, v40, v120
    v_mul_f32 v41, v41, v121
    v_mul_f32 v42, v42, v122
    v_mul_f32 v43, v43, v123
    v_mul_f32 v44, v44, v136
    v_mul_f32 v45, v45, v137
    v_mul_f32 v46, v46, v138
    v_mul_f32 v47, v47, v139
    v_exp_f32 v40, v40
    v_fma_f32 v152, -v196, v228, v152
    v_exp_f32 v41, v41
    v_fma_f32 v153, -v196, v229, v153
    v_exp_f32 v42, v42
    v_fma_f32 v154, -v196, v230, v154
    v_exp_f32 v43, v43
    v_fma_f32 v155, -v196, v231, v155
    v_exp_f32 v44, v44
    v_fma_f32 v168, -v196, v232, v168
    v_exp_f32 v45, v45
    v_fma_f32 v169, -v196, v233, v169
    v_exp_f32 v46, v46
    v_fma_f32 v170, -v196, v234, v170
    v_exp_f32 v47, v47
    v_fma_f32 v171, -v196, v235, v171
    v_fma_f32 v40, v40, v212, v212
    v_fma_f32 v41, v41, v212, v212
    v_fma_f32 v42, v42, v212, v212
    v_fma_f32 v43, v43, v212, v212
    v_fma_f32 v44, v44, v212, v212
    v_fma_f32 v45, v45, v212, v212
    v_fma_f32 v46, v46, v212, v212
    v_fma_f32 v47, v47, v212, v212
    v_rcp_f32 v40, v40
    v_mul_f32 v120, v120, v152
    v_rcp_f32 v41, v41
    v_mul_f32 v121, v121, v153
    v_rcp_f32 v42, v42
    v_mul_f32 v122, v122, v154
    v_rcp_f32 v43, v43
    v_mul_f32 v123, v123, v155
    v_rcp_f32 v44, v44
    v_mul_f32 v136, v136, v168
    v_rcp_f32 v45, v45
    v_mul_f32 v137, v137, v169
    v_rcp_f32 v46, v46
    v_mul_f32 v138, v138, v170
    v_rcp_f32 v47, v47
    v_mul_f32 v139, v139, v171
    v_mul_f32 v120, v120, v40
    v_mul_f32 v121, v121, v41
    v_mul_f32 v122, v122, v42
    v_mul_f32 v123, v123, v43
    v_mul_f32 v136, v136, v44
    v_mul_f32 v137, v137, v45
    v_mul_f32 v138, v138, v46
    v_mul_f32 v139, v139, v47
    v_cvt_pk_bf16_f32 v56, v120, v121
    v_cvt_pk_bf16_f32 v57, v122, v123
    v_cvt_pk_bf16_f32 v58, v136, v137
    v_cvt_pk_bf16_f32 v59, v138, v139
    buffer_store_dwordx4 v[56:59], v31, s[40:43], s57 offen sc0 sc1
    s_xor_b32 s56, s52, 3
    s_lshl_b32 s57, s51, 2
    s_add_u32 s56, s56, s57
    s_lshl_b32 s57, s48, 3
    s_add_u32 s56, s56, s57
    s_mul_i32 s57, s56, 48
    s_lshl_b32 s58, s53, 2
    s_add_u32 s57, s57, s58
    s_add_u32 s57, s57, s52
    s_lshl_b32 s57, s57, 10
    v_fma_f32 v124, -v198, v220, v124
    v_fma_f32 v125, -v198, v221, v125
    v_fma_f32 v126, -v198, v222, v126
    v_fma_f32 v127, -v198, v223, v127
    v_fma_f32 v140, -v198, v224, v140
    v_fma_f32 v141, -v198, v225, v141
    v_fma_f32 v142, -v198, v226, v142
    v_fma_f32 v143, -v198, v227, v143
    v_mul_f32 v40, v124, v124
    v_mul_f32 v41, v125, v125
    v_mul_f32 v42, v126, v126
    v_mul_f32 v43, v127, v127
    v_mul_f32 v44, v140, v140
    v_mul_f32 v45, v141, v141
    v_mul_f32 v46, v142, v142
    v_mul_f32 v47, v143, v143
    v_fma_f32 v40, v40, v216, v215
    v_fma_f32 v41, v41, v216, v215
    v_fma_f32 v42, v42, v216, v215
    v_fma_f32 v43, v43, v216, v215
    v_fma_f32 v44, v44, v216, v215
    v_fma_f32 v45, v45, v216, v215
    v_fma_f32 v46, v46, v216, v215
    v_fma_f32 v47, v47, v216, v215
    v_mul_f32 v40, v40, v124
    v_mul_f32 v41, v41, v125
    v_mul_f32 v42, v42, v126
    v_mul_f32 v43, v43, v127
    v_mul_f32 v44, v44, v140
    v_mul_f32 v45, v45, v141
    v_mul_f32 v46, v46, v142
    v_mul_f32 v47, v47, v143
    v_exp_f32 v40, v40
    v_fma_f32 v156, -v198, v228, v156
    v_exp_f32 v41, v41
    v_fma_f32 v157, -v198, v229, v157
    v_exp_f32 v42, v42
    v_fma_f32 v158, -v198, v230, v158
    v_exp_f32 v43, v43
    v_fma_f32 v159, -v198, v231, v159
    v_exp_f32 v44, v44
    v_fma_f32 v172, -v198, v232, v172
    v_exp_f32 v45, v45
    v_fma_f32 v173, -v198, v233, v173
    v_exp_f32 v46, v46
    v_fma_f32 v174, -v198, v234, v174
    v_exp_f32 v47, v47
    v_fma_f32 v175, -v198, v235, v175
    v_fma_f32 v40, v40, v217, v217
    v_fma_f32 v41, v41, v217, v217
    v_fma_f32 v42, v42, v217, v217
    v_fma_f32 v43, v43, v217, v217
    v_fma_f32 v44, v44, v217, v217
    v_fma_f32 v45, v45, v217, v217
    v_fma_f32 v46, v46, v217, v217
    v_fma_f32 v47, v47, v217, v217
    v_rcp_f32 v40, v40
    v_mul_f32 v124, v124, v156
    v_rcp_f32 v41, v41
    v_mul_f32 v125, v125, v157
    v_rcp_f32 v42, v42
    v_mul_f32 v126, v126, v158
    v_rcp_f32 v43, v43
    v_mul_f32 v127, v127, v159
    v_rcp_f32 v44, v44
    v_mul_f32 v140, v140, v172
    v_rcp_f32 v45, v45
    v_mul_f32 v141, v141, v173
    v_rcp_f32 v46, v46
    v_mul_f32 v142, v142, v174
    v_rcp_f32 v47, v47
    v_mul_f32 v143, v143, v175
    v_mul_f32 v124, v124, v40
    v_mul_f32 v125, v125, v41
    v_mul_f32 v126, v126, v42
    v_mul_f32 v127, v127, v43
    v_mul_f32 v140, v140, v44
    v_mul_f32 v141, v141, v45
    v_mul_f32 v142, v142, v46
    v_mul_f32 v143, v143, v47
    v_cvt_pk_bf16_f32 v60, v124, v125
    v_cvt_pk_bf16_f32 v61, v126, v127
    v_cvt_pk_bf16_f32 v62, v140, v141
    v_cvt_pk_bf16_f32 v63, v142, v143
    buffer_store_dwordx4 v[60:63], v31, s[40:43], s57 offen sc0 sc1
    s_lshl_b32 s71, s48, 1
    s_add_u32 s71, s71, s51
    s_lshl_b32 s71, s71, 9
    s_lshl_b32 s70, s53, 5
    s_add_u32 s71, s71, s70
    s_lshl_b32 s70, s52, 3
    s_add_u32 s71, s71, s70
    s_add_u32 s71, s71, 13074432
    s_mov_b32 s70, 0
    s_branch P2_START
P1_KV:
    s_mul_i32 s58, s49, 320
    s_add_u32 s58, s58, 1280
    s_mov_b32 s59, 3277
    v_add_u32 v30, 0, v0
    v_mul_u32_u24 v31, s59, v30
    v_lshrrev_b32 v31, 16, v31
    v_mul_u32_u24 v33, 20, v31
    v_sub_u32 v30, v30, v33
    v_bfe_u32 v33, v31, 3, 1
    v_lshlrev_b32 v33, 1, v33
    v_xor_b32 v30, v30, v33
    v_and_b32 v33, 31, v31
    v_mul_u32_u24 v33, 3840, v33
    v_lshl_add_u32 v30, v30, 4, v33
    v_lshrrev_b32 v31, 5, v31
    v_mul_u32_u24 v31, 1280, v31
    v_add3_u32 v6, v30, v31, s58
    v_add_u32 v30, 512, v0
    v_mul_u32_u24 v31, s59, v30
    v_lshrrev_b32 v31, 16, v31
    v_mul_u32_u24 v33, 20, v31
    v_sub_u32 v30, v30, v33
    v_bfe_u32 v33, v31, 3, 1
    v_lshlrev_b32 v33, 1, v33
    v_xor_b32 v30, v30, v33
    v_and_b32 v33, 31, v31
    v_mul_u32_u24 v33, 3840, v33
    v_lshl_add_u32 v30, v30, 4, v33
    v_lshrrev_b32 v31, 5, v31
    v_mul_u32_u24 v31, 1280, v31
    v_add3_u32 v7, v30, v31, s58
    s_movk_i32 s56, 512
    s_cmp_lt_u32 s50, 4
    s_cselect_b32 s56, 1024, s56
    v_add_u32 v30, s56, v0
    v_mul_u32_u24 v31, s59, v30
    v_lshrrev_b32 v31, 16, v31
    v_mul_u32_u24 v33, 20, v31
    v_sub_u32 v30, v30, v33
    v_bfe_u32 v33, v31, 3, 1
    v_lshlrev_b32 v33, 1, v33
    v_xor_b32 v30, v30, v33
    v_and_b32 v33, 31, v31
    v_mul_u32_u24 v33, 3840, v33
    v_lshl_add_u32 v30, v30, 4, v33
    v_lshrrev_b32 v31, 5, v31
    v_mul_u32_u24 v31, 1280, v31
    v_add3_u32 v8, v30, v31, s58
    s_lshl_b32 s56, s56, 4
    s_add_u32 s71, s54, s56
    s_cmp_lt_u32 s50, 4
    s_cselect_b64 s[90:91], -1, 1
    s_waitcnt lgkmcnt(0)
    s_mov_b32 s24, s4
    s_mov_b32 s25, s5
    s_mov_b32 s26, 2621440
    s_mov_b32 s27, 0x20000
    s_mov_b32 s36, s6
    s_mov_b32 s37, s7
    s_mov_b32 s38, 2457600
    s_mov_b32 s39, 0x20000
    s_mov_b32 s40, s22
    s_mov_b32 s41, s23
    s_mov_b32 s42, 33554432
    s_mov_b32 s43, 0x20000
    s_mov_b32 s44, s20
    s_mov_b32 s45, s21
    s_mov_b32 s46, 256
    s_mov_b32 s47, 0x20000
    s_or_b32 s56, s50, s48
    s_cmp_lg_u32 s56, 0
    s_cbranch_scc1 P1_KVZ_DONE
    s_mul_i32 s57, s49, 13440
    s_add_u32 s57, s57, 11698176
    v_lshlrev_b32 v31, 4, v1
    v_mov_b32 v34, 0
    v_mov_b32 v35, 0
    v_mov_b32 v36, 0
    v_mov_b32 v37, 0
    buffer_store_dwordx4 v[34:37], v31, s[40:43], s57 offen sc0 sc1
    s_add_u32 s57, s57, 1024
    buffer_store_dwordx4 v[34:37], v31, s[40:43], s57 offen sc0 sc1
    s_add_u32 s57, s57, 1024
    buffer_store_dwordx4 v[34:37], v31, s[40:43], s57 offen sc0 sc1
    s_add_u32 s57, s57, 1024
    buffer_store_dwordx4 v[34:37], v31, s[40:43], s57 offen sc0 sc1
    s_add_u32 s57, s57, 1024
    buffer_store_dwordx4 v[34:37], v31, s[40:43], s57 offen sc0 sc1
    s_add_u32 s57, s57, 1024
    buffer_store_dwordx4 v[34:37], v31, s[40:43], s57 offen sc0 sc1
    s_add_u32 s57, s57, 1024
    buffer_store_dwordx4 v[34:37], v31, s[40:43], s57 offen sc0 sc1
    s_add_u32 s57, s57, 1024
    buffer_store_dwordx4 v[34:37], v31, s[40:43], s57 offen sc0 sc1
    s_add_u32 s57, s57, 1024
    buffer_store_dwordx4 v[34:37], v31, s[40:43], s57 offen sc0 sc1
    s_add_u32 s57, s57, 1024
    buffer_store_dwordx4 v[34:37], v31, s[40:43], s57 offen sc0 sc1
    s_add_u32 s57, s57, 1024
    buffer_store_dwordx4 v[34:37], v31, s[40:43], s57 offen sc0 sc1
    s_add_u32 s57, s57, 1024
    buffer_store_dwordx4 v[34:37], v31, s[40:43], s57 offen sc0 sc1
    s_add_u32 s57, s57, 1024
    buffer_store_dwordx4 v[34:37], v31, s[40:43], s57 offen sc0 sc1
    s_add_u32 s57, s57, 1024
    s_mov_b64 exec, 0xff
    buffer_store_dwordx4 v[34:37], v31, s[40:43], s57 offen sc0 sc1
    s_add_u32 s57, s57, 1024
    s_cmp_lg_u32 s49, 0
    s_cbranch_scc1 P1_KVZ_D2
    s_memrealtime s[62:63]
    s_waitcnt lgkmcnt(0)
    s_or_b32 s62, s62, 1
    v_mov_b32 v32, s62
    v_mov_b32 v33, s63
    v_mov_b32 v31, 0
    s_mov_b64 exec, 1
    buffer_store_dwordx2 v[32:33], v31, s[44:47], 0 offen offset:16 sc0 sc1
P1_KVZ_D2:
    s_mov_b64 exec, -1
P1_KVZ_DONE:
    s_nop 1
    s_lshl_b32 s59, s80, 1
    s_add_u32 m0, s55, 102400
    s_nop 0
    buffer_load_dwordx4 v4, s[24:27], s59 offen lds
    s_add_u32 m0, s55, 103424
    s_nop 0
    buffer_load_dwordx4 v5, s[24:27], s59 offen lds
    s_mul_i32 s58, s80, 3840
    s_add_u32 m0, s54, 0
    s_nop 0
    buffer_load_dwordx4 v6, s[36:39], s58 offen lds
    s_add_u32 m0, s54, 8192
    s_nop 0
    buffer_load_dwordx4 v7, s[36:39], s58 offen lds
    s_add_u32 m0, s71, 0
    s_mov_b64 exec, s[90:91]
    buffer_load_dwordx4 v8, s[36:39], s58 offen lds
    s_mov_b64 exec, -1
    v_lshrrev_b32 v30, 2, v2
    v_and_b32 v31, 3, v2
    v_lshl_add_u32 v32, v3, 3, v30
    v_and_b32 v33, 1, v3
    v_mul_u32_u24 v32, 320, v32
    v_and_b32 v34, 1, v31
    v_lshl_add_u32 v32, v34, 3, v32
    v_lshrrev_b32 v31, 1, v31
    v_lshlrev_b32 v33, 1, v33
    s_mul_i32 s56, s52, 5
    s_add_u32 s57, s56, 0
    v_add_u32 v34, s57, v31
    v_xor_b32 v34, v34, v33
    v_lshl_add_u32 v34, v34, 4, v32
    v_add_u32 v9, 0, v34
    s_add_u32 s57, s56, 2
    v_add_u32 v34, s57, v31
    v_xor_b32 v34, v34, v33
    v_lshl_add_u32 v34, v34, 4, v32
    v_add_u32 v11, 0, v34
    s_add_u32 s57, s56, 1
    v_add_u32 v34, s57, v31
    v_xor_b32 v34, v34, v33
    v_lshl_add_u32 v34, v34, 4, v32
    v_add_u32 v13, 10240, v34
    s_add_u32 s57, s56, 3
    v_add_u32 v34, s57, v31
    v_xor_b32 v34, v34, v33
    v_lshl_add_u32 v34, v34, 4, v32
    v_add_u32 v15, 10240, v34
    v_lshlrev_b32 v34, 2, v31
    v_sub_u32 v34, 4, v34
    v_add_u32 v34, s56, v34
    v_xor_b32 v34, v34, v33
    v_lshl_add_u32 v34, v34, 4, v32
    v_mul_u32_u24 v35, 10240, v31
    v_add_u32 v17, v34, v35
    v_add_u32 v10, 61440, v9
    v_add_u32 v12, 61440, v11
    v_add_u32 v14, 61440, v13
    v_add_u32 v16, 61440, v15
    v_add_u32 v18, 61440, v17
    v_lshrrev_b32 v30, 1, v2
    v_xor_b32 v30, v30, v3
    v_lshlrev_b32 v30, 4, v30
    v_lshl_add_u32 v30, v2, 7, v30
    v_xor_b32 v31, 64, v30
    s_lshl_b32 s57, s51, 13
    s_add_u32 s57, s57, 102400
    s_xor_b32 s56, s52, 0
    s_lshl_b32 s56, s56, 11
    s_add_u32 s56, s56, s57
    v_add_u32 v19, s56, v30
    v_add_u32 v20, s56, v31
    s_xor_b32 s56, s52, 1
    s_lshl_b32 s56, s56, 11
    s_add_u32 s56, s56, s57
    v_add_u32 v21, s56, v30
    v_add_u32 v22, s56, v31
    s_xor_b32 s56, s52, 2
    s_lshl_b32 s56, s56, 11
    s_add_u32 s56, s56, s57
    v_add_u32 v23, s56, v30
    v_add_u32 v24, s56, v31
    s_xor_b32 s56, s52, 3
    s_lshl_b32 s56, s56, 11
    s_add_u32 s56, s56, s57
    v_add_u32 v25, s56, v30
    v_add_u32 v26, s56, v31
    s_barrier
    s_mul_i32 s58, s80, 3840
    s_add_u32 s58, s58, 122880
    s_add_u32 m0, s54, 20480
    s_nop 0
    buffer_load_dwordx4 v6, s[36:39], s58 offen lds
    s_add_u32 m0, s54, 28672
    s_nop 0
    buffer_load_dwordx4 v7, s[36:39], s58 offen lds
    s_add_u32 m0, s71, 20480
    s_mov_b64 exec, s[90:91]
    buffer_load_dwordx4 v8, s[36:39], s58 offen lds
    s_mov_b64 exec, -1
    v_cmp_gt_u32 s[64:65], 8, v2
    s_mul_i32 s63, s51, 13440
    s_mul_i32 s57, s52, 3360
    s_add_u32 s63, s63, s57
    v_lshlrev_b32 v195, 2, v2
    v_mov_b32 v192, 0
    v_cmp_gt_u32 vcc, 4, v2
    v_add_u32 v204, 64, v195
    v_add_u32 v205, 1664, v195
    v_cndmask_b32 v196, v205, v204, vcc
    v_cndmask_b32 v193, 1, 0, vcc
    v_add_u32 v197, 1728, v195
    v_cndmask_b32 v194, 2, 1, s[64:65]
    v_mul_u32_u24 v204, 320, v3
    v_cmp_gt_u32 vcc, 2, v3
    v_subrev_u32 v201, 640, v204
    s_nop 0
    v_cndmask_b32 v198, 0, 3, vcc
    v_cmp_gt_u32 vcc, 3, v3
    v_add_u32 v205, 640, v204
    s_nop 0
    v_cndmask_b32 v202, 0, v205, vcc
    v_cndmask_b32 v199, 1, 0, vcc
    v_add_u32 v203, 320, v204
    v_mov_b32 v200, 1
    v_mov_b32 v206, 26880
    v_cmp_eq_u32 vcc, v198, v192
    v_add3_u32 v234, v201, v195, s63
    s_nop 0
    v_cndmask_b32 v234, v206, v234, vcc
    v_cmp_eq_u32 vcc, 0, v3
    v_cmp_gt_u32 s[66:67], 2, v192
    v_add_u32 v250, s63, v195
    s_nop 0
    s_and_b64 vcc, vcc, s[66:67]
    v_add_u32 v250, 1600, v250
    v_cndmask_b32 v250, v234, v250, vcc
    v_cmp_eq_u32 vcc, v199, v192
    v_add3_u32 v235, v202, v195, s63
    s_nop 0
    v_cndmask_b32 v235, v206, v235, vcc
    v_cmp_eq_u32 vcc, v198, v193
    v_add3_u32 v236, v201, v196, s63
    s_nop 0
    v_cndmask_b32 v236, v206, v236, vcc
    v_cmp_eq_u32 vcc, 0, v3
    v_cmp_gt_u32 s[66:67], 2, v193
    v_add_u32 v251, s63, v196
    s_nop 0
    s_and_b64 vcc, vcc, s[66:67]
    v_add_u32 v251, 1600, v251
    v_cndmask_b32 v251, v236, v251, vcc
    v_cmp_eq_u32 vcc, v199, v193
    v_add3_u32 v237, v202, v196, s63
    s_nop 0
    v_cndmask_b32 v237, v206, v237, vcc
    v_cmp_eq_u32 vcc, v200, v193
    v_add3_u32 v242, v203, v196, s63
    s_nop 0
    v_cndmask_b32 v242, v206, v242, vcc
    v_cmp_eq_u32 vcc, v199, v194
    v_add3_u32 v243, v202, v197, s63
    s_nop 0
    v_cndmask_b32 v243, v206, v243, vcc
    v_cmp_eq_u32 vcc, v200, v194
    v_add3_u32 v248, v203, v197, s63
    s_nop 0
    v_cndmask_b32 v248, v206, v248, vcc
    v_cmp_eq_u32 vcc, v198, v194
    v_add3_u32 v249, v201, v197, s63
    s_nop 0
    v_cndmask_b32 v249, v206, v249, vcc
    v_cmp_eq_u32 vcc, 0, v3
    v_cmp_gt_u32 s[66:67], 2, v194
    v_add_u32 v252, s63, v197
    s_nop 0
    s_and_b64 vcc, vcc, s[66:67]
    v_add_u32 v252, 1600, v252
    v_cndmask_b32 v252, v249, v252, vcc
    v_mov_b32 v204, 0xff800000
    v_mov_b32 v205, 0x358637bd
    v_cndmask_b32 v28, v204, v205, s[64:65]
    v_cndmask_b32 v29, v204, 0, s[64:65]
    v_mov_b32 v27, 0x3f803f80
    v_mov_b32 v244, 0x3f803f80
    v_mov_b32 v245, 0x3f803f80
    v_mov_b32 v246, 0x3f803f80
    v_mov_b32 v247, 0x3f803f80
    v_mov_b32 v112, 0
    v_mov_b32 v113, 0
    v_mov_b32 v114, 0
    v_mov_b32 v115, 0
    v_mov_b32 v116, 0
    v_mov_b32 v117, 0
    v_mov_b32 v118, 0
    v_mov_b32 v119, 0
    v_mov_b32 v120, 0
    v_mov_b32 v121, 0
    v_mov_b32 v122, 0
    v_mov_b32 v123, 0
    v_mov_b32 v124, 0
    v_mov_b32 v125, 0
    v_mov_b32 v126, 0
    v_mov_b32 v127, 0
    v_mov_b32 v128, 0
    v_mov_b32 v129, 0
    v_mov_b32 v130, 0
    v_mov_b32 v131, 0
    v_mov_b32 v132, 0
    v_mov_b32 v133, 0
    v_mov_b32 v134, 0
    v_mov_b32 v135, 0
    v_mov_b32 v136, 0
    v_mov_b32 v137, 0
    v_mov_b32 v138, 0
    v_mov_b32 v139, 0
    v_mov_b32 v140, 0
    v_mov_b32 v141, 0
    v_mov_b32 v142, 0
    v_mov_b32 v143, 0
    v_mov_b32 v144, 0
    v_mov_b32 v145, 0
    v_mov_b32 v146, 0
    v_mov_b32 v147, 0
    v_mov_b32 v148, 0
    v_mov_b32 v149, 0
    v_mov_b32 v150, 0
    v_mov_b32 v151, 0
    v_mov_b32 v152, 0
    v_mov_b32 v153, 0
    v_mov_b32 v154, 0
    v_mov_b32 v155, 0
    v_mov_b32 v156, 0
    v_mov_b32 v157, 0
    v_mov_b32 v158, 0
    v_mov_b32 v159, 0
    v_mov_b32 v160, 0
    v_mov_b32 v161, 0
    v_mov_b32 v162, 0
    v_mov_b32 v163, 0
    v_mov_b32 v164, 0
    v_mov_b32 v165, 0
    v_mov_b32 v166, 0
    v_mov_b32 v167, 0
    v_mov_b32 v168, 0
    v_mov_b32 v169, 0
    v_mov_b32 v170, 0
    v_mov_b32 v171, 0
    v_mov_b32 v172, 0
    v_mov_b32 v173, 0
    v_mov_b32 v174, 0
    v_mov_b32 v175, 0
    v_mov_b32 v176, 0
    v_mov_b32 v177, 0
    v_mov_b32 v178, 0
    v_mov_b32 v179, 0
    v_mov_b32 v180, 0
    v_mov_b32 v181, 0
    v_mov_b32 v182, 0
    v_mov_b32 v183, 0
    v_mov_b32 v184, 0
    v_mov_b32 v185, 0
    v_mov_b32 v186, 0
    v_mov_b32 v187, 0
    v_mov_b32 v188, 0
    v_mov_b32 v189, 0
    v_mov_b32 v190, 0
    v_mov_b32 v191, 0
    s_cmp_lg_u32 s51, 0
    s_cselect_b64 vcc, -1, 0
    s_waitcnt vmcnt(3)
    s_barrier
    ds_read_b128 v[40:43], v19 offset:0
    ds_read_b64_tr_b16 v[56:57], v9 offset:0
    ds_read_b64_tr_b16 v[58:59], v9 offset:1280
    ds_read_b128 v[44:47], v21 offset:0
    ds_read_b64_tr_b16 v[60:61], v11 offset:0
    ds_read_b64_tr_b16 v[62:63], v11 offset:1280
    ds_read_b128 v[48:51], v23 offset:0
    ds_read_b64_tr_b16 v[64:65], v13 offset:0
    ds_read_b64_tr_b16 v[66:67], v13 offset:1280
    ds_read_b128 v[52:55], v25 offset:0
    ds_read_b64_tr_b16 v[68:69], v15 offset:0
    ds_read_b64_tr_b16 v[70:71], v15 offset:1280
    ds_read_b64_tr_b16 v[72:73], v17 offset:0
    ds_read_b64_tr_b16 v[74:75], v17 offset:1280
    s_lshl_b32 s59, s81, 1
    s_add_u32 m0, s55, 118784
    s_nop 0
    buffer_load_dwordx4 v4, s[24:27], s59 offen lds
    s_add_u32 m0, s55, 119808
    s_nop 0
    buffer_load_dwordx4 v5, s[24:27], s59 offen lds
    s_mul_i32 s58, s81, 3840
    s_add_u32 m0, s54, 40960
    s_nop 0
    buffer_load_dwordx4 v6, s[36:39], s58 offen lds
    s_add_u32 m0, s54, 49152
    s_nop 0
    buffer_load_dwordx4 v7, s[36:39], s58 offen lds
    s_add_u32 m0, s71, 40960
    s_mov_b64 exec, s[90:91]
    buffer_load_dwordx4 v8, s[36:39], s58 offen lds
    s_mov_b64 exec, -1
    s_mul_i32 s58, s81, 3840
    s_add_u32 s58, s58, 122880
    s_add_u32 m0, s54, 61440
    s_nop 0
    buffer_load_dwordx4 v6, s[36:39], s58 offen lds
    s_add_u32 m0, s54, 69632
    s_nop 0
    buffer_load_dwordx4 v7, s[36:39], s58 offen lds
    s_add_u32 m0, s71, 61440
    s_mov_b64 exec, s[90:91]
    buffer_load_dwordx4 v8, s[36:39], s58 offen lds
    s_mov_b64 exec, -1
    s_waitcnt vmcnt(8) lgkmcnt(0)
    s_barrier
    v_mfma_f32_16x16x32_bf16 v[112:115], v[40:43], v[56:59], v[112:115]
    ds_read_b128 v[76:79], v20 offset:0
    ds_read_b64_tr_b16 v[92:93], v9 offset:20480
    v_mfma_f32_16x16x32_bf16 v[116:119], v[44:47], v[56:59], v[116:119]
    ds_read_b64_tr_b16 v[94:95], v9 offset:21760
    v_mfma_f32_16x16x32_bf16 v[120:123], v[48:51], v[56:59], v[120:123]
    ds_read_b128 v[80:83], v22 offset:0
    v_mfma_f32_16x16x32_bf16 v[124:127], v[52:55], v[56:59], v[124:127]
    ds_read_b64_tr_b16 v[96:97], v11 offset:20480
    v_mfma_f32_16x16x32_bf16 v[128:131], v[40:43], v[60:63], v[128:131]
    ds_read_b64_tr_b16 v[98:99], v11 offset:21760
    v_mfma_f32_16x16x32_bf16 v[132:135], v[44:47], v[60:63], v[132:135]
    ds_read_b128 v[84:87], v24 offset:0
    v_mfma_f32_16x16x32_bf16 v[136:139], v[48:51], v[60:63], v[136:139]
    ds_read_b64_tr_b16 v[100:101], v13 offset:20480
    v_mfma_f32_16x16x32_bf16 v[140:143], v[52:55], v[60:63], v[140:143]
    ds_read_b64_tr_b16 v[102:103], v13 offset:21760
    v_mfma_f32_16x16x32_bf16 v[144:147], v[40:43], v[64:67], v[144:147]
    ds_read_b128 v[88:91], v26 offset:0
    v_mfma_f32_16x16x32_bf16 v[148:151], v[44:47], v[64:67], v[148:151]
    ds_read_b64_tr_b16 v[104:105], v15 offset:20480
    v_mfma_f32_16x16x32_bf16 v[152:155], v[48:51], v[64:67], v[152:155]
    ds_read_b64_tr_b16 v[106:107], v15 offset:21760
    ds_read_b64_tr_b16 v[108:109], v17 offset:20480
    v_mfma_f32_16x16x32_bf16 v[156:159], v[52:55], v[64:67], v[156:159]
    ds_read_b64_tr_b16 v[110:111], v17 offset:21760
    v_mfma_f32_16x16x32_bf16 v[160:163], v[40:43], v[68:71], v[160:163]
    s_mul_i32 s58, s82, 3840
    s_add_u32 m0, s54, 81920
    s_nop 0
    buffer_load_dwordx4 v6, s[36:39], s58 offen lds
    v_mfma_f32_16x16x32_bf16 v[164:167], v[44:47], v[68:71], v[164:167]
    s_add_u32 m0, s54, 90112
    s_nop 0
    buffer_load_dwordx4 v7, s[36:39], s58 offen lds
    v_mfma_f32_16x16x32_bf16 v[168:171], v[48:51], v[68:71], v[168:171]
    s_add_u32 m0, s71, 81920
    s_mov_b64 exec, s[90:91]
    buffer_load_dwordx4 v8, s[36:39], s58 offen lds
    s_mov_b64 exec, -1
    v_mfma_f32_16x16x32_bf16 v[172:175], v[52:55], v[68:71], v[172:175]
    s_lshl_b32 s59, s82, 1
    s_add_u32 m0, s55, 135168
    s_nop 0
    buffer_load_dwordx4 v4, s[24:27], s59 offen lds
    v_mfma_f32_16x16x32_bf16 v[176:179], v[40:43], v[72:75], v[176:179]
    s_add_u32 m0, s55, 136192
    s_nop 0
    buffer_load_dwordx4 v5, s[24:27], s59 offen lds
    v_mfma_f32_16x16x32_bf16 v[180:183], v[44:47], v[72:75], v[180:183]
    s_mul_i32 s58, s82, 3840
    s_add_u32 s58, s58, 122880
    s_add_u32 m0, s54, 0
    s_nop 0
    buffer_load_dwordx4 v6, s[36:39], s58 offen lds
    v_mfma_f32_16x16x32_bf16 v[184:187], v[48:51], v[72:75], v[184:187]
    s_add_u32 m0, s54, 8192
    s_nop 0
    buffer_load_dwordx4 v7, s[36:39], s58 offen lds
    v_mfma_f32_16x16x32_bf16 v[188:191], v[52:55], v[72:75], v[188:191]
    s_add_u32 m0, s71, 0
    s_mov_b64 exec, s[90:91]
    buffer_load_dwordx4 v8, s[36:39], s58 offen lds
    s_mov_b64 exec, -1
    s_waitcnt vmcnt(11) lgkmcnt(0)
    s_barrier
    v_mfma_f32_16x16x32_bf16 v[112:115], v[76:79], v[92:95], v[112:115]
    ds_read_b128 v[40:43], v19 offset:16384
    v_mfma_f32_16x16x32_bf16 v[116:119], v[80:83], v[92:95], v[116:119]
    ds_read_b64_tr_b16 v[56:57], v9 offset:40960
    v_mfma_f32_16x16x32_bf16 v[120:123], v[84:87], v[92:95], v[120:123]
    ds_read_b64_tr_b16 v[58:59], v9 offset:42240
    v_mfma_f32_16x16x32_bf16 v[124:127], v[88:91], v[92:95], v[124:127]
    ds_read_b128 v[44:47], v21 offset:16384
    v_mfma_f32_16x16x32_bf16 v[128:131], v[76:79], v[96:99], v[128:131]
    ds_read_b64_tr_b16 v[60:61], v11 offset:40960
    v_mfma_f32_16x16x32_bf16 v[132:135], v[80:83], v[96:99], v[132:135]
    ds_read_b64_tr_b16 v[62:63], v11 offset:42240
    v_mfma_f32_16x16x32_bf16 v[136:139], v[84:87], v[96:99], v[136:139]
    ds_read_b128 v[48:51], v23 offset:16384
    v_mfma_f32_16x16x32_bf16 v[140:143], v[88:91], v[96:99], v[140:143]
    ds_read_b64_tr_b16 v[64:65], v13 offset:40960
    v_mfma_f32_16x16x32_bf16 v[144:147], v[76:79], v[100:103], v[144:147]
    ds_read_b64_tr_b16 v[66:67], v13 offset:42240
    v_mfma_f32_16x16x32_bf16 v[148:151], v[80:83], v[100:103], v[148:151]
    ds_read_b128 v[52:55], v25 offset:16384
    v_mfma_f32_16x16x32_bf16 v[152:155], v[84:87], v[100:103], v[152:155]
    ds_read_b64_tr_b16 v[68:69], v15 offset:40960
    v_mfma_f32_16x16x32_bf16 v[156:159], v[88:91], v[100:103], v[156:159]
    ds_read_b64_tr_b16 v[70:71], v15 offset:42240
    v_mfma_f32_16x16x32_bf16 v[160:163], v[76:79], v[104:107], v[160:163]
    ds_read_b64_tr_b16 v[72:73], v17 offset:40960
    v_mfma_f32_16x16x32_bf16 v[164:167], v[80:83], v[104:107], v[164:167]
    ds_read_b64_tr_b16 v[74:75], v17 offset:42240
    v_mfma_f32_16x16x32_bf16 v[168:171], v[84:87], v[104:107], v[168:171]
    s_mul_i32 s58, s83, 3840
    s_add_u32 m0, s54, 20480
    s_nop 0
    buffer_load_dwordx4 v6, s[36:39], s58 offen lds
    v_mfma_f32_16x16x32_bf16 v[172:175], v[88:91], v[104:107], v[172:175]
    s_add_u32 m0, s54, 28672
    s_nop 0
    buffer_load_dwordx4 v7, s[36:39], s58 offen lds
    v_mfma_f32_16x16x32_bf16 v[176:179], v[76:79], v[108:111], v[176:179]
    s_add_u32 m0, s71, 20480
    s_mov_b64 exec, s[90:91]
    buffer_load_dwordx4 v8, s[36:39], s58 offen lds
    s_mov_b64 exec, -1
    v_mfma_f32_16x16x32_bf16 v[180:183], v[80:83], v[108:111], v[180:183]
    s_lshl_b32 s59, s83, 1
    s_add_u32 m0, s55, 102400
    s_nop 0
    buffer_load_dwordx4 v4, s[24:27], s59 offen lds
    v_mfma_f32_16x16x32_bf16 v[184:187], v[84:87], v[108:111], v[184:187]
    s_add_u32 m0, s55, 103424
    s_nop 0
    buffer_load_dwordx4 v5, s[24:27], s59 offen lds
    v_mfma_f32_16x16x32_bf16 v[188:191], v[88:91], v[108:111], v[188:191]
    s_waitcnt vmcnt(13) lgkmcnt(0)
    s_barrier
    v_mfma_f32_16x16x32_bf16 v[112:115], v[40:43], v[56:59], v[112:115]
    ds_read_b128 v[76:79], v20 offset:16384
    v_mfma_f32_16x16x32_bf16 v[116:119], v[44:47], v[56:59], v[116:119]
    ds_read_b64_tr_b16 v[92:93], v10 offset:0
    v_mfma_f32_16x16x32_bf16 v[120:123], v[48:51], v[56:59], v[120:123]
    ds_read_b64_tr_b16 v[94:95], v10 offset:1280
    v_mfma_f32_16x16x32_bf16 v[124:127], v[52:55], v[56:59], v[124:127]
    ds_read_b128 v[80:83], v22 offset:16384
    v_mfma_f32_16x16x32_bf16 v[128:131], v[40:43], v[60:63], v[128:131]
    ds_read_b64_tr_b16 v[96:97], v12 offset:0
    v_mfma_f32_16x16x32_bf16 v[132:135], v[44:47], v[60:63], v[132:135]
    ds_read_b64_tr_b16 v[98:99], v12 offset:1280
    v_mfma_f32_16x16x32_bf16 v[136:139], v[48:51], v[60:63], v[136:139]
    ds_read_b128 v[84:87], v24 offset:16384
    v_mfma_f32_16x16x32_bf16 v[140:143], v[52:55], v[60:63], v[140:143]
    ds_read_b64_tr_b16 v[100:101], v14 offset:0
    v_mfma_f32_16x16x32_bf16 v[144:147], v[40:43], v[64:67], v[144:147]
    ds_read_b64_tr_b16 v[102:103], v14 offset:1280
    v_mfma_f32_16x16x32_bf16 v[148:151], v[44:47], v[64:67], v[148:151]
    v_mfma_f32_16x16x32_bf16 v[152:155], v[48:51], v[64:67], v[152:155]
    ds_read_b128 v[88:91], v26 offset:16384
    v_mfma_f32_16x16x32_bf16 v[156:159], v[52:55], v[64:67], v[156:159]
    ds_read_b64_tr_b16 v[104:105], v16 offset:0
    v_mfma_f32_16x16x32_bf16 v[160:163], v[40:43], v[68:71], v[160:163]
    ds_read_b64_tr_b16 v[106:107], v16 offset:1280
    v_mfma_f32_16x16x32_bf16 v[164:167], v[44:47], v[68:71], v[164:167]
    ds_read_b64_tr_b16 v[108:109], v18 offset:0
    v_mfma_f32_16x16x32_bf16 v[168:171], v[48:51], v[68:71], v[168:171]
    ds_read_b64_tr_b16 v[110:111], v18 offset:1280
    v_mfma_f32_16x16x32_bf16 v[172:175], v[52:55], v[68:71], v[172:175]
    s_cmp_lg_u32 s50, 7
    s_cbranch_scc1 P1_KV_NL
    v_mov_b32 v30, 0
    buffer_load_dwordx2 v[238:239], v30, s[44:47], 0 offen offset:16 sc0 sc1
P1_KV_NL:
    v_mfma_f32_16x16x32_bf16 v[176:179], v[40:43], v[72:75], v[176:179]
    s_mul_i32 s58, s83, 3840
    s_add_u32 s58, s58, 122880
    s_add_u32 m0, s54, 40960
    s_nop 0
    buffer_load_dwordx4 v6, s[36:39], s58 offen lds
    v_mfma_f32_16x16x32_bf16 v[180:183], v[44:47], v[72:75], v[180:183]
    s_add_u32 m0, s54, 49152
    s_nop 0
    buffer_load_dwordx4 v7, s[36:39], s58 offen lds
    v_mfma_f32_16x16x32_bf16 v[184:187], v[48:51], v[72:75], v[184:187]
    s_add_u32 m0, s71, 40960
    s_mov_b64 exec, s[90:91]
    buffer_load_dwordx4 v8, s[36:39], s58 offen lds
    s_mov_b64 exec, -1
    v_mfma_f32_16x16x32_bf16 v[188:191], v[52:55], v[72:75], v[188:191]
    s_waitcnt vmcnt(11) lgkmcnt(0)
    s_barrier
    v_mfma_f32_16x16x32_bf16 v[112:115], v[76:79], v[92:95], v[112:115]
    ds_read_b128 v[40:43], v19 offset:32768
    v_mfma_f32_16x16x32_bf16 v[116:119], v[80:83], v[92:95], v[116:119]
    ds_read_b64_tr_b16 v[56:57], v10 offset:20480
    v_mfma_f32_16x16x32_bf16 v[120:123], v[84:87], v[92:95], v[120:123]
    ds_read_b64_tr_b16 v[58:59], v10 offset:21760
    v_mfma_f32_16x16x32_bf16 v[124:127], v[88:91], v[92:95], v[124:127]
    ds_read_b128 v[44:47], v21 offset:32768
    v_mfma_f32_16x16x32_bf16 v[128:131], v[76:79], v[96:99], v[128:131]
    ds_read_b64_tr_b16 v[60:61], v12 offset:20480
    v_mfma_f32_16x16x32_bf16 v[132:135], v[80:83], v[96:99], v[132:135]
    ds_read_b64_tr_b16 v[62:63], v12 offset:21760
    v_mfma_f32_16x16x32_bf16 v[136:139], v[84:87], v[96:99], v[136:139]
    ds_read_b128 v[48:51], v23 offset:32768
    v_mfma_f32_16x16x32_bf16 v[140:143], v[88:91], v[96:99], v[140:143]
    ds_read_b64_tr_b16 v[64:65], v14 offset:20480
    v_mfma_f32_16x16x32_bf16 v[144:147], v[76:79], v[100:103], v[144:147]
    ds_read_b64_tr_b16 v[66:67], v14 offset:21760
    v_mfma_f32_16x16x32_bf16 v[148:151], v[80:83], v[100:103], v[148:151]
    ds_read_b128 v[52:55], v25 offset:32768
    v_mfma_f32_16x16x32_bf16 v[152:155], v[84:87], v[100:103], v[152:155]
    ds_read_b64_tr_b16 v[68:69], v16 offset:20480
    v_mfma_f32_16x16x32_bf16 v[156:159], v[88:91], v[100:103], v[156:159]
    ds_read_b64_tr_b16 v[70:71], v16 offset:21760
    v_mfma_f32_16x16x32_bf16 v[160:163], v[76:79], v[104:107], v[160:163]
    ds_read_b64_tr_b16 v[72:73], v18 offset:20480
    v_mfma_f32_16x16x32_bf16 v[164:167], v[80:83], v[104:107], v[164:167]
    ds_read_b64_tr_b16 v[74:75], v18 offset:21760
    v_mfma_f32_16x16x32_bf16 v[168:171], v[84:87], v[104:107], v[168:171]
    s_mul_i32 s58, s84, 3840
    s_add_u32 m0, s54, 61440
    s_nop 0
    buffer_load_dwordx4 v6, s[36:39], s58 offen lds
    v_mfma_f32_16x16x32_bf16 v[172:175], v[88:91], v[104:107], v[172:175]
    s_add_u32 m0, s54, 69632
    s_nop 0
    buffer_load_dwordx4 v7, s[36:39], s58 offen lds
    v_mfma_f32_16x16x32_bf16 v[176:179], v[76:79], v[108:111], v[176:179]
    s_add_u32 m0, s71, 61440
    s_mov_b64 exec, s[90:91]
    buffer_load_dwordx4 v8, s[36:39], s58 offen lds
    s_mov_b64 exec, -1
    v_mfma_f32_16x16x32_bf16 v[180:183], v[80:83], v[108:111], v[180:183]
    s_lshl_b32 s59, s84, 1
    s_add_u32 m0, s55, 118784
    s_nop 0
    buffer_load_dwordx4 v4, s[24:27], s59 offen lds
    v_mfma_f32_16x16x32_bf16 v[184:187], v[84:87], v[108:111], v[184:187]
    s_add_u32 m0, s55, 119808
    s_nop 0
    buffer_load_dwordx4 v5, s[24:27], s59 offen lds
    v_mfma_f32_16x16x32_bf16 v[188:191], v[88:91], v[108:111], v[188:191]
    s_waitcnt vmcnt(13) lgkmcnt(0)
    s_barrier
    v_mfma_f32_16x16x32_bf16 v[112:115], v[40:43], v[56:59], v[112:115]
    ds_read_b128 v[76:79], v20 offset:32768
    v_mfma_f32_16x16x32_bf16 v[116:119], v[44:47], v[56:59], v[116:119]
    ds_read_b64_tr_b16 v[92:93], v9 offset:0
    v_mfma_f32_16x16x32_bf16 v[120:123], v[48:51], v[56:59], v[120:123]
    ds_read_b64_tr_b16 v[94:95], v9 offset:1280
    v_mfma_f32_16x16x32_bf16 v[124:127], v[52:55], v[56:59], v[124:127]
    ds_read_b128 v[80:83], v22 offset:32768
    v_mfma_f32_16x16x32_bf16 v[128:131], v[40:43], v[60:63], v[128:131]
    ds_read_b64_tr_b16 v[96:97], v11 offset:0
    v_mfma_f32_16x16x32_bf16 v[132:135], v[44:47], v[60:63], v[132:135]
    ds_read_b64_tr_b16 v[98:99], v11 offset:1280
    v_mfma_f32_16x16x32_bf16 v[136:139], v[48:51], v[60:63], v[136:139]
    v_mfma_f32_16x16x32_bf16 v[140:143], v[52:55], v[60:63], v[140:143]
    ds_read_b128 v[84:87], v24 offset:32768
    v_mfma_f32_16x16x32_bf16 v[144:147], v[40:43], v[64:67], v[144:147]
    ds_read_b64_tr_b16 v[100:101], v13 offset:0
    v_mfma_f32_16x16x32_bf16 v[148:151], v[44:47], v[64:67], v[148:151]
    ds_read_b64_tr_b16 v[102:103], v13 offset:1280
    v_mfma_f32_16x16x32_bf16 v[152:155], v[48:51], v[64:67], v[152:155]
    ds_read_b128 v[88:91], v26 offset:32768
    v_mfma_f32_16x16x32_bf16 v[156:159], v[52:55], v[64:67], v[156:159]
    ds_read_b64_tr_b16 v[104:105], v15 offset:0
    v_mfma_f32_16x16x32_bf16 v[160:163], v[40:43], v[68:71], v[160:163]
    ds_read_b64_tr_b16 v[106:107], v15 offset:1280
    v_mfma_f32_16x16x32_bf16 v[164:167], v[44:47], v[68:71], v[164:167]
    v_mfma_f32_16x16x32_bf16 v[168:171], v[48:51], v[68:71], v[168:171]
    ds_read_b64_tr_b16 v[108:109], v17 offset:0
    v_mfma_f32_16x16x32_bf16 v[172:175], v[52:55], v[68:71], v[172:175]
    ds_read_b64_tr_b16 v[110:111], v17 offset:1280
    v_mfma_f32_16x16x32_bf16 v[176:179], v[40:43], v[72:75], v[176:179]
    s_mul_i32 s58, s84, 3840
    s_add_u32 s58, s58, 122880
    s_add_u32 m0, s54, 81920
    s_nop 0
    buffer_load_dwordx4 v6, s[36:39], s58 offen lds
    v_mfma_f32_16x16x32_bf16 v[180:183], v[44:47], v[72:75], v[180:183]
    s_add_u32 m0, s54, 90112
    s_nop 0
    buffer_load_dwordx4 v7, s[36:39], s58 offen lds
    v_mfma_f32_16x16x32_bf16 v[184:187], v[48:51], v[72:75], v[184:187]
    s_add_u32 m0, s71, 81920
    s_mov_b64 exec, s[90:91]
    buffer_load_dwordx4 v8, s[36:39], s58 offen lds
    s_mov_b64 exec, -1
    v_mfma_f32_16x16x32_bf16 v[188:191], v[52:55], v[72:75], v[188:191]
    s_waitcnt vmcnt(11) lgkmcnt(0)
    s_barrier
    v_mfma_f32_16x16x32_bf16 v[112:115], v[76:79], v[92:95], v[112:115]
    ds_read_b128 v[40:43], v19 offset:0
    v_mfma_f32_16x16x32_bf16 v[116:119], v[80:83], v[92:95], v[116:119]
    ds_read_b64_tr_b16 v[56:57], v9 offset:20480
    v_mfma_f32_16x16x32_bf16 v[120:123], v[84:87], v[92:95], v[120:123]
    ds_read_b64_tr_b16 v[58:59], v9 offset:21760
    v_mfma_f32_16x16x32_bf16 v[124:127], v[88:91], v[92:95], v[124:127]
    ds_read_b128 v[44:47], v21 offset:0
    v_mfma_f32_16x16x32_bf16 v[128:131], v[76:79], v[96:99], v[128:131]
    ds_read_b64_tr_b16 v[60:61], v11 offset:20480
    v_mfma_f32_16x16x32_bf16 v[132:135], v[80:83], v[96:99], v[132:135]
    ds_read_b64_tr_b16 v[62:63], v11 offset:21760
    v_mfma_f32_16x16x32_bf16 v[136:139], v[84:87], v[96:99], v[136:139]
    ds_read_b128 v[48:51], v23 offset:0
    v_mfma_f32_16x16x32_bf16 v[140:143], v[88:91], v[96:99], v[140:143]
    ds_read_b64_tr_b16 v[64:65], v13 offset:20480
    v_mfma_f32_16x16x32_bf16 v[144:147], v[76:79], v[100:103], v[144:147]
    ds_read_b64_tr_b16 v[66:67], v13 offset:21760
    v_mfma_f32_16x16x32_bf16 v[148:151], v[80:83], v[100:103], v[148:151]
    ds_read_b128 v[52:55], v25 offset:0
    v_mfma_f32_16x16x32_bf16 v[152:155], v[84:87], v[100:103], v[152:155]
    ds_read_b64_tr_b16 v[68:69], v15 offset:20480
    v_mfma_f32_16x16x32_bf16 v[156:159], v[88:91], v[100:103], v[156:159]
    ds_read_b64_tr_b16 v[70:71], v15 offset:21760
    v_mfma_f32_16x16x32_bf16 v[160:163], v[76:79], v[104:107], v[160:163]
    ds_read_b64_tr_b16 v[72:73], v17 offset:20480
    v_mfma_f32_16x16x32_bf16 v[164:167], v[80:83], v[104:107], v[164:167]
    ds_read_b64_tr_b16 v[74:75], v17 offset:21760
    v_mfma_f32_16x16x32_bf16 v[168:171], v[84:87], v[104:107], v[168:171]
    s_mul_i32 s58, s85, 3840
    s_add_u32 m0, s54, 0
    s_nop 0
    buffer_load_dwordx4 v6, s[36:39], s58 offen lds
    v_mfma_f32_16x16x32_bf16 v[172:175], v[88:91], v[104:107], v[172:175]
    s_add_u32 m0, s54, 8192
    s_nop 0
    buffer_load_dwordx4 v7, s[36:39], s58 offen lds
    v_mfma_f32_16x16x32_bf16 v[176:179], v[76:79], v[108:111], v[176:179]
    s_add_u32 m0, s71, 0
    s_mov_b64 exec, s[90:91]
    buffer_load_dwordx4 v8, s[36:39], s58 offen lds
    s_mov_b64 exec, -1
    v_mfma_f32_16x16x32_bf16 v[180:183], v[80:83], v[108:111], v[180:183]
    s_lshl_b32 s59, s85, 1
    s_add_u32 m0, s55, 135168
    s_nop 0
    buffer_load_dwordx4 v4, s[24:27], s59 offen lds
    v_mfma_f32_16x16x32_bf16 v[184:187], v[84:87], v[108:111], v[184:187]
    s_add_u32 m0, s55, 136192
    s_nop 0
    buffer_load_dwordx4 v5, s[24:27], s59 offen lds
    v_mfma_f32_16x16x32_bf16 v[188:191], v[88:91], v[108:111], v[188:191]
    s_waitcnt vmcnt(13) lgkmcnt(0)
    s_barrier
    s_cmp_lg_u32 s50, 7
    s_cbranch_scc1 P1_KV_NC_DONE
P1_KV_NC:
    v_readfirstlane_b32 s61, v238
    s_nop 1
    s_cmp_lg_u32 s61, 0
    s_cbranch_scc1 P1_KV_NC_OK
    s_add_u32 s3, s3, 1
    s_cmp_gt_u32 s3, 0x200000
    s_cbranch_scc1 K_END
    s_sleep 2
    v_mov_b32 v30, 0
    buffer_load_dwordx2 v[238:239], v30, s[44:47], 0 offen offset:16 sc0 sc1
    s_waitcnt vmcnt(0)
    s_branch P1_KV_NC
P1_KV_NC_OK:
    v_mov_b32 v30, 162048
    v_mov_b32 v31, 0
    ds_write_b64 v30, v[238:239]
    s_cmp_lg_u32 s48, 0
    s_cbranch_scc1 P1_KV_NC_DONE
    s_lshl_b32 s61, s49, 7
    s_add_u32 s61, s61, 13102080
    s_mov_b64 exec, 1
    buffer_store_dwordx2 v[238:239], v31, s[40:43], s61 offen sc0 sc1
    s_mov_b64 exec, -1
P1_KV_NC_DONE:
    v_mfma_f32_16x16x32_bf16 v[112:115], v[40:43], v[56:59], v[112:115]
    ds_read_b128 v[76:79], v20 offset:0
    v_mfma_f32_16x16x32_bf16 v[116:119], v[44:47], v[56:59], v[116:119]
    ds_read_b64_tr_b16 v[92:93], v9 offset:40960
    v_mfma_f32_16x16x32_bf16 v[120:123], v[48:51], v[56:59], v[120:123]
    ds_read_b64_tr_b16 v[94:95], v9 offset:42240
    v_mfma_f32_16x16x32_bf16 v[124:127], v[52:55], v[56:59], v[124:127]
    ds_read_b128 v[80:83], v22 offset:0
    v_mfma_f32_16x16x32_bf16 v[128:131], v[40:43], v[60:63], v[128:131]
    ds_read_b64_tr_b16 v[96:97], v11 offset:40960
    v_mfma_f32_16x16x32_bf16 v[132:135], v[44:47], v[60:63], v[132:135]
    ds_read_b64_tr_b16 v[98:99], v11 offset:42240
    v_mfma_f32_16x16x32_bf16 v[136:139], v[48:51], v[60:63], v[136:139]
    ds_read_b128 v[84:87], v24 offset:0
    v_mfma_f32_16x16x32_bf16 v[140:143], v[52:55], v[60:63], v[140:143]
    ds_read_b64_tr_b16 v[100:101], v13 offset:40960
    v_mfma_f32_16x16x32_bf16 v[144:147], v[40:43], v[64:67], v[144:147]
    ds_read_b64_tr_b16 v[102:103], v13 offset:42240
    v_mfma_f32_16x16x32_bf16 v[148:151], v[44:47], v[64:67], v[148:151]
    ds_read_b128 v[88:91], v26 offset:0
    v_mfma_f32_16x16x32_bf16 v[152:155], v[48:51], v[64:67], v[152:155]
    ds_read_b64_tr_b16 v[104:105], v15 offset:40960
    v_mfma_f32_16x16x32_bf16 v[156:159], v[52:55], v[64:67], v[156:159]
    ds_read_b64_tr_b16 v[106:107], v15 offset:42240
    v_mfma_f32_16x16x32_bf16 v[160:163], v[40:43], v[68:71], v[160:163]
    ds_read_b64_tr_b16 v[108:109], v17 offset:40960
    v_mfma_f32_16x16x32_bf16 v[164:167], v[44:47], v[68:71], v[164:167]
    ds_read_b64_tr_b16 v[110:111], v17 offset:42240
    v_mfma_f32_16x16x32_bf16 v[168:171], v[48:51], v[68:71], v[168:171]
    s_mul_i32 s58, s85, 3840
    s_add_u32 s58, s58, 122880
    s_add_u32 m0, s54, 20480
    s_nop 0
    buffer_load_dwordx4 v6, s[36:39], s58 offen lds
    v_mfma_f32_16x16x32_bf16 v[172:175], v[52:55], v[68:71], v[172:175]
    s_add_u32 m0, s54, 28672
    s_nop 0
    buffer_load_dwordx4 v7, s[36:39], s58 offen lds
    v_mfma_f32_16x16x32_bf16 v[176:179], v[40:43], v[72:75], v[176:179]
    s_add_u32 m0, s71, 20480
    s_mov_b64 exec, s[90:91]
    buffer_load_dwordx4 v8, s[36:39], s58 offen lds
    s_mov_b64 exec, -1
    v_mfma_f32_16x16x32_bf16 v[180:183], v[44:47], v[72:75], v[180:183]
    v_mfma_f32_16x16x32_bf16 v[192:195], v[244:247], v[40:43], 0
    v_mfma_f32_16x16x32_bf16 v[184:187], v[48:51], v[72:75], v[184:187]
    v_mfma_f32_16x16x32_bf16 v[196:199], v[40:43], v[40:43], 0
    v_mfma_f32_16x16x32_bf16 v[188:191], v[52:55], v[72:75], v[188:191]
    s_cbranch_vccnz P1_KV_cs6
    v_mfma_f32_16x16x32_bf16 v[200:203], v[244:247], v[56:59], 0
    v_mfma_f32_16x16x32_bf16 v[204:207], v[244:247], v[60:63], 0
    v_mfma_f32_16x16x32_bf16 v[208:211], v[244:247], v[64:67], 0
    v_mfma_f32_16x16x32_bf16 v[212:215], v[244:247], v[68:71], 0
    v_mfma_f32_16x16x32_bf16 v[216:219], v[244:247], v[72:75], 0
P1_KV_cs6:
    s_waitcnt vmcnt(11) lgkmcnt(0)
    s_barrier
    v_mfma_f32_16x16x32_bf16 v[112:115], v[76:79], v[92:95], v[112:115]
    ds_read_b128 v[40:43], v19 offset:16384
    ds_read_b64_tr_b16 v[56:57], v10 offset:0
    v_mfma_f32_16x16x32_bf16 v[116:119], v[80:83], v[92:95], v[116:119]
    ds_read_b64_tr_b16 v[58:59], v10 offset:1280
    v_mfma_f32_16x16x32_bf16 v[120:123], v[84:87], v[92:95], v[120:123]
    ds_read_b128 v[44:47], v21 offset:16384
    v_mfma_f32_16x16x32_bf16 v[124:127], v[88:91], v[92:95], v[124:127]
    ds_read_b64_tr_b16 v[60:61], v12 offset:0
    v_mfma_f32_16x16x32_bf16 v[128:131], v[76:79], v[96:99], v[128:131]
    ds_read_b64_tr_b16 v[62:63], v12 offset:1280
    v_mfma_f32_16x16x32_bf16 v[132:135], v[80:83], v[96:99], v[132:135]
    ds_read_b128 v[48:51], v23 offset:16384
    v_mfma_f32_16x16x32_bf16 v[136:139], v[84:87], v[96:99], v[136:139]
    ds_read_b64_tr_b16 v[64:65], v14 offset:0
    v_mfma_f32_16x16x32_bf16 v[140:143], v[88:91], v[96:99], v[140:143]
    ds_read_b64_tr_b16 v[66:67], v14 offset:1280
    v_mfma_f32_16x16x32_bf16 v[144:147], v[76:79], v[100:103], v[144:147]
    ds_read_b128 v[52:55], v25 offset:16384
    v_mfma_f32_16x16x32_bf16 v[148:151], v[80:83], v[100:103], v[148:151]
    ds_read_b64_tr_b16 v[68:69], v16 offset:0
    v_mfma_f32_16x16x32_bf16 v[152:155], v[84:87], v[100:103], v[152:155]
    ds_read_b64_tr_b16 v[70:71], v16 offset:1280
    ds_read_b64_tr_b16 v[72:73], v18 offset:0
    v_mfma_f32_16x16x32_bf16 v[156:159], v[88:91], v[100:103], v[156:159]
    ds_read_b64_tr_b16 v[74:75], v18 offset:1280
    v_mfma_f32_16x16x32_bf16 v[160:163], v[76:79], v[104:107], v[160:163]
    v_mov_b32 v35, 162048
    ds_read_b64 v[238:239], v35
    v_mfma_f32_16x16x32_bf16 v[164:167], v[80:83], v[104:107], v[164:167]
    s_mul_i32 s58, s86, 3840
    s_add_u32 m0, s54, 40960
    s_nop 0
    buffer_load_dwordx4 v6, s[36:39], s58 offen lds
    v_mfma_f32_16x16x32_bf16 v[168:171], v[84:87], v[104:107], v[168:171]
    s_add_u32 m0, s54, 49152
    s_nop 0
    buffer_load_dwordx4 v7, s[36:39], s58 offen lds
    v_mfma_f32_16x16x32_bf16 v[172:175], v[88:91], v[104:107], v[172:175]
    s_add_u32 m0, s71, 40960
    s_mov_b64 exec, s[90:91]
    buffer_load_dwordx4 v8, s[36:39], s58 offen lds
    s_mov_b64 exec, -1
    v_mfma_f32_16x16x32_bf16 v[176:179], v[76:79], v[108:111], v[176:179]
    s_lshl_b32 s59, s86, 1
    s_add_u32 m0, s55, 102400
    s_nop 0
    buffer_load_dwordx4 v4, s[24:27], s59 offen lds
    v_mfma_f32_16x16x32_bf16 v[180:183], v[80:83], v[108:111], v[180:183]
    s_add_u32 m0, s55, 103424
    s_nop 0
    buffer_load_dwordx4 v5, s[24:27], s59 offen lds
    v_mfma_f32_16x16x32_bf16 v[184:187], v[84:87], v[108:111], v[184:187]
    v_mfma_f32_16x16x32_bf16 v[192:195], v[244:247], v[76:79], v[192:195]
    v_mfma_f32_16x16x32_bf16 v[188:191], v[88:91], v[108:111], v[188:191]
    v_mfma_f32_16x16x32_bf16 v[196:199], v[76:79], v[76:79], v[196:199]
    s_cbranch_vccz P1_KV_cs7
    v_mfma_f32_16x16x32_bf16 v[200:203], v[244:247], v[92:95], 0
    v_mfma_f32_16x16x32_bf16 v[204:207], v[244:247], v[96:99], 0
    v_mfma_f32_16x16x32_bf16 v[208:211], v[244:247], v[100:103], 0
    v_mfma_f32_16x16x32_bf16 v[212:215], v[244:247], v[104:107], 0
    v_mfma_f32_16x16x32_bf16 v[216:219], v[244:247], v[108:111], 0
P1_KV_cs7:
    s_waitcnt vmcnt(13) lgkmcnt(0)
    s_barrier
    v_mfma_f32_16x16x32_bf16 v[112:115], v[40:43], v[56:59], v[112:115]
    ds_read_b128 v[76:79], v20 offset:16384
    ds_read_b64_tr_b16 v[92:93], v10 offset:20480
    v_mfma_f32_16x16x32_bf16 v[116:119], v[44:47], v[56:59], v[116:119]
    ds_read_b64_tr_b16 v[94:95], v10 offset:21760
    v_mfma_f32_16x16x32_bf16 v[120:123], v[48:51], v[56:59], v[120:123]
    ds_read_b128 v[80:83], v22 offset:16384
    v_mfma_f32_16x16x32_bf16 v[124:127], v[52:55], v[56:59], v[124:127]
    ds_read_b64_tr_b16 v[96:97], v12 offset:20480
    v_mfma_f32_16x16x32_bf16 v[128:131], v[40:43], v[60:63], v[128:131]
    ds_read_b64_tr_b16 v[98:99], v12 offset:21760
    v_mfma_f32_16x16x32_bf16 v[132:135], v[44:47], v[60:63], v[132:135]
    ds_read_b128 v[84:87], v24 offset:16384
    v_mfma_f32_16x16x32_bf16 v[136:139], v[48:51], v[60:63], v[136:139]
    ds_read_b64_tr_b16 v[100:101], v14 offset:20480
    v_mfma_f32_16x16x32_bf16 v[140:143], v[52:55], v[60:63], v[140:143]
    ds_read_b64_tr_b16 v[102:103], v14 offset:21760
    v_mfma_f32_16x16x32_bf16 v[144:147], v[40:43], v[64:67], v[144:147]
    ds_read_b128 v[88:91], v26 offset:16384
    v_mfma_f32_16x16x32_bf16 v[148:151], v[44:47], v[64:67], v[148:151]
    ds_read_b64_tr_b16 v[104:105], v16 offset:20480
    v_mfma_f32_16x16x32_bf16 v[152:155], v[48:51], v[64:67], v[152:155]
    ds_read_b64_tr_b16 v[106:107], v16 offset:21760
    ds_read_b64_tr_b16 v[108:109], v18 offset:20480
    v_mfma_f32_16x16x32_bf16 v[156:159], v[52:55], v[64:67], v[156:159]
    ds_read_b64_tr_b16 v[110:111], v18 offset:21760
    v_mfma_f32_16x16x32_bf16 v[160:163], v[40:43], v[68:71], v[160:163]
    v_and_b32 v32, 3, v2
    v_cmp_eq_u32 s[62:63], 1, v32
    v_cmp_eq_u32 s[64:65], 2, v32
    v_cmp_eq_u32 s[66:67], 3, v32
    v_lshrrev_b32 v32, 2, v2
    v_cndmask_b32 v193, v196, v197, s[62:63]
    v_cndmask_b32 v193, v193, v198, s[64:65]
    v_cndmask_b32 v193, v193, v199, s[66:67]
    v_cmp_eq_u32 s[62:63], v32, v3
    v_mfma_f32_16x16x32_bf16 v[164:167], v[44:47], v[68:71], v[164:167]
    s_lshl_b32 s61, s48, 4
    s_add_u32 s61, s61, s49
    s_lshl_b32 s61, s61, 10
    s_lshl_b32 s64, s50, 7
    s_add_u32 s61, s61, s64
    s_add_u32 s61, s61, 11763712
    v_lshlrev_b32 v30, 3, v2
    s_mov_b64 exec, s[62:63]
    buffer_store_dwordx2 v[192:193], v30, s[40:43], s61 offen sc0 sc1
    s_mov_b64 exec, -1
    v_mfma_f32_16x16x32_bf16 v[168:171], v[48:51], v[68:71], v[168:171]
    v_cmp_eq_u32 s[62:63], 1, v3
    v_cmp_eq_u32 s[64:65], 2, v3
    v_cmp_eq_u32 s[66:67], 3, v3
    s_lshl_b32 s61, s49, 2
    s_add_u32 s61, s61, s52
    s_lshl_b32 s61, s61, 4
    s_add_u32 s61, s61, s48
    s_lshl_b32 s61, s61, 1
    s_add_u32 s61, s61, s51
    s_lshl_b32 s61, s61, 9
    s_add_u32 s61, s61, 12025856
    v_cndmask_b32 v31, v200, v204, s[62:63]
    v_cndmask_b32 v31, v31, v208, s[64:65]
    v_cndmask_b32 v31, v31, v212, s[66:67]
    v_lshlrev_b32 v30, 2, v1
    buffer_store_dword v31, v30, s[40:43], s61 offen sc0 sc1
    v_mfma_f32_16x16x32_bf16 v[172:175], v[52:55], v[68:71], v[172:175]
    s_mov_b32 exec_hi, 0
    buffer_store_dword v216, v30, s[40:43], s61 offen offset:256 sc0 sc1
    s_mov_b64 exec, -1
    v_mfma_f32_16x16x32_bf16 v[176:179], v[40:43], v[72:75], v[176:179]
    v_readfirstlane_b32 s92, v238
    v_readfirstlane_b32 s93, v239
    v_mfma_f32_16x16x32_bf16 v[180:183], v[44:47], v[72:75], v[180:183]
    s_mul_i32 s58, s86, 3840
    s_add_u32 s58, s58, 122880
    s_add_u32 m0, s54, 61440
    s_nop 0
    buffer_load_dwordx4 v6, s[36:39], s58 offen lds
    v_mfma_f32_16x16x32_bf16 v[184:187], v[48:51], v[72:75], v[184:187]
    s_add_u32 m0, s54, 69632
    s_nop 0
    buffer_load_dwordx4 v7, s[36:39], s58 offen lds
    v_mfma_f32_16x16x32_bf16 v[188:191], v[52:55], v[72:75], v[188:191]
    s_add_u32 m0, s71, 61440
    s_mov_b64 exec, s[90:91]
    buffer_load_dwordx4 v8, s[36:39], s58 offen lds
    s_mov_b64 exec, -1
    s_waitcnt vmcnt(14) lgkmcnt(0)
    s_barrier
    v_mfma_f32_16x16x32_bf16 v[112:115], v[76:79], v[92:95], v[112:115]
    ds_read_b128 v[40:43], v19 offset:32768
    v_mfma_f32_16x16x32_bf16 v[116:119], v[80:83], v[92:95], v[116:119]
    ds_read_b64_tr_b16 v[56:57], v9 offset:0
    v_mfma_f32_16x16x32_bf16 v[120:123], v[84:87], v[92:95], v[120:123]
    ds_read_b64_tr_b16 v[58:59], v9 offset:1280
    v_mfma_f32_16x16x32_bf16 v[124:127], v[88:91], v[92:95], v[124:127]
    ds_read_b128 v[44:47], v21 offset:32768
    v_mfma_f32_16x16x32_bf16 v[128:131], v[76:79], v[96:99], v[128:131]
    ds_read_b64_tr_b16 v[60:61], v11 offset:0
    v_mfma_f32_16x16x32_bf16 v[132:135], v[80:83], v[96:99], v[132:135]
    ds_read_b64_tr_b16 v[62:63], v11 offset:1280
    v_mfma_f32_16x16x32_bf16 v[136:139], v[84:87], v[96:99], v[136:139]
    ds_read_b128 v[48:51], v23 offset:32768
    v_mfma_f32_16x16x32_bf16 v[140:143], v[88:91], v[96:99], v[140:143]
    ds_read_b64_tr_b16 v[64:65], v13 offset:0
    v_mfma_f32_16x16x32_bf16 v[144:147], v[76:79], v[100:103], v[144:147]
    ds_read_b64_tr_b16 v[66:67], v13 offset:1280
    v_mfma_f32_16x16x32_bf16 v[148:151], v[80:83], v[100:103], v[148:151]
    ds_read_b128 v[52:55], v25 offset:32768
    v_mfma_f32_16x16x32_bf16 v[152:155], v[84:87], v[100:103], v[152:155]
    ds_read_b64_tr_b16 v[68:69], v15 offset:0
    v_mfma_f32_16x16x32_bf16 v[156:159], v[88:91], v[100:103], v[156:159]
    ds_read_b64_tr_b16 v[70:71], v15 offset:1280
    v_mfma_f32_16x16x32_bf16 v[160:163], v[76:79], v[104:107], v[160:163]
    ds_read_b64_tr_b16 v[72:73], v17 offset:0
    v_mfma_f32_16x16x32_bf16 v[164:167], v[80:83], v[104:107], v[164:167]
    ds_read_b64_tr_b16 v[74:75], v17 offset:1280
    v_mfma_f32_16x16x32_bf16 v[168:171], v[84:87], v[104:107], v[168:171]
    s_mul_i32 s58, s87, 3840
    s_add_u32 m0, s54, 81920
    s_nop 0
    buffer_load_dwordx4 v6, s[36:39], s58 offen lds
    v_mfma_f32_16x16x32_bf16 v[172:175], v[88:91], v[104:107], v[172:175]
    s_add_u32 m0, s54, 90112
    s_nop 0
    buffer_load_dwordx4 v7, s[36:39], s58 offen lds
    v_mfma_f32_16x16x32_bf16 v[176:179], v[76:79], v[108:111], v[176:179]
    s_add_u32 m0, s71, 81920
    s_mov_b64 exec, s[90:91]
    buffer_load_dwordx4 v8, s[36:39], s58 offen lds
    s_mov_b64 exec, -1
    v_mfma_f32_16x16x32_bf16 v[180:183], v[80:83], v[108:111], v[180:183]
    s_lshl_b32 s59, s87, 1
    s_add_u32 m0, s55, 118784
    s_nop 0
    buffer_load_dwordx4 v4, s[24:27], s59 offen lds
    v_mfma_f32_16x16x32_bf16 v[184:187], v[84:87], v[108:111], v[184:187]
    s_add_u32 m0, s55, 119808
    s_nop 0
    buffer_load_dwordx4 v5, s[24:27], s59 offen lds
    v_mfma_f32_16x16x32_bf16 v[188:191], v[88:91], v[108:111], v[188:191]
    s_waitcnt vmcnt(8) lgkmcnt(0)
    s_barrier
    s_cmp_lg_u32 s50, 7
    s_cbranch_scc1 P1_KV_SIG
    s_lshl_b32 s61, s48, 7
    s_lshl_b32 s62, s49, 3
    s_add_u32 s61, s61, s62
    s_add_u32 s61, s61, 13097984
    v_mov_b32 v31, 0
    v_mov_b32 v32, s92
    v_mov_b32 v33, s93
    s_mov_b64 exec, 1
    buffer_store_dwordx2 v[32:33], v31, s[40:43], s61 offen sc0 sc1
    s_lshl_b32 s61, s49, 7
    s_lshl_b32 s62, s48, 3
    s_add_u32 s61, s61, s62
    s_add_u32 s61, s61, 13100032
    buffer_store_dwordx2 v[32:33], v31, s[40:43], s61 offen sc0 sc1
    s_mov_b64 exec, -1
P1_KV_SIG:
    v_mfma_f32_16x16x32_bf16 v[112:115], v[40:43], v[56:59], v[112:115]
    ds_read_b128 v[76:79], v20 offset:32768
    v_mfma_f32_16x16x32_bf16 v[116:119], v[44:47], v[56:59], v[116:119]
    ds_read_b64_tr_b16 v[92:93], v9 offset:20480
    v_mfma_f32_16x16x32_bf16 v[120:123], v[48:51], v[56:59], v[120:123]
    ds_read_b64_tr_b16 v[94:95], v9 offset:21760
    v_mfma_f32_16x16x32_bf16 v[124:127], v[52:55], v[56:59], v[124:127]
    ds_read_b128 v[80:83], v22 offset:32768
    v_mfma_f32_16x16x32_bf16 v[128:131], v[40:43], v[60:63], v[128:131]
    ds_read_b64_tr_b16 v[96:97], v11 offset:20480
    v_mfma_f32_16x16x32_bf16 v[132:135], v[44:47], v[60:63], v[132:135]
    ds_read_b64_tr_b16 v[98:99], v11 offset:21760
    v_mfma_f32_16x16x32_bf16 v[136:139], v[48:51], v[60:63], v[136:139]
    v_mfma_f32_16x16x32_bf16 v[140:143], v[52:55], v[60:63], v[140:143]
    ds_read_b128 v[84:87], v24 offset:32768
    v_mfma_f32_16x16x32_bf16 v[144:147], v[40:43], v[64:67], v[144:147]
    ds_read_b64_tr_b16 v[100:101], v13 offset:20480
    v_mfma_f32_16x16x32_bf16 v[148:151], v[44:47], v[64:67], v[148:151]
    ds_read_b64_tr_b16 v[102:103], v13 offset:21760
    v_mfma_f32_16x16x32_bf16 v[152:155], v[48:51], v[64:67], v[152:155]
    ds_read_b128 v[88:91], v26 offset:32768
    v_mfma_f32_16x16x32_bf16 v[156:159], v[52:55], v[64:67], v[156:159]
    ds_read_b64_tr_b16 v[104:105], v15 offset:20480
    v_mfma_f32_16x16x32_bf16 v[160:163], v[40:43], v[68:71], v[160:163]
    ds_read_b64_tr_b16 v[106:107], v15 offset:21760
    v_mfma_f32_16x16x32_bf16 v[164:167], v[44:47], v[68:71], v[164:167]
    v_mfma_f32_16x16x32_bf16 v[168:171], v[48:51], v[68:71], v[168:171]
    ds_read_b64_tr_b16 v[108:109], v17 offset:20480
    v_mfma_f32_16x16x32_bf16 v[172:175], v[52:55], v[68:71], v[172:175]
    ds_read_b64_tr_b16 v[110:111], v17 offset:21760
    v_mfma_f32_16x16x32_bf16 v[176:179], v[40:43], v[72:75], v[176:179]
    s_mul_i32 s58, s87, 3840
    s_add_u32 s58, s58, 122880
    s_add_u32 m0, s54, 0
    s_nop 0
    buffer_load_dwordx4 v6, s[36:39], s58 offen lds
    v_mfma_f32_16x16x32_bf16 v[180:183], v[44:47], v[72:75], v[180:183]
    s_add_u32 m0, s54, 8192
    s_nop 0
    buffer_load_dwordx4 v7, s[36:39], s58 offen lds
    v_mfma_f32_16x16x32_bf16 v[184:187], v[48:51], v[72:75], v[184:187]
    s_add_u32 m0, s71, 0
    s_mov_b64 exec, s[90:91]
    buffer_load_dwordx4 v8, s[36:39], s58 offen lds
    s_mov_b64 exec, -1
    v_mfma_f32_16x16x32_bf16 v[188:191], v[52:55], v[72:75], v[188:191]
    s_waitcnt vmcnt(14) lgkmcnt(0)
    s_barrier
    v_mfma_f32_16x16x32_bf16 v[112:115], v[76:79], v[92:95], v[112:115]
    ds_read_b128 v[40:43], v19 offset:0
    v_mfma_f32_16x16x32_bf16 v[116:119], v[80:83], v[92:95], v[116:119]
    ds_read_b64_tr_b16 v[56:57], v9 offset:40960
    v_mfma_f32_16x16x32_bf16 v[120:123], v[84:87], v[92:95], v[120:123]
    ds_read_b64_tr_b16 v[58:59], v9 offset:42240
    v_mfma_f32_16x16x32_bf16 v[124:127], v[88:91], v[92:95], v[124:127]
    ds_read_b128 v[44:47], v21 offset:0
    v_mfma_f32_16x16x32_bf16 v[128:131], v[76:79], v[96:99], v[128:131]
    ds_read_b64_tr_b16 v[60:61], v11 offset:40960
    v_mfma_f32_16x16x32_bf16 v[132:135], v[80:83], v[96:99], v[132:135]
    ds_read_b64_tr_b16 v[62:63], v11 offset:42240
    v_mfma_f32_16x16x32_bf16 v[136:139], v[84:87], v[96:99], v[136:139]
    ds_read_b128 v[48:51], v23 offset:0
    v_mfma_f32_16x16x32_bf16 v[140:143], v[88:91], v[96:99], v[140:143]
    ds_read_b64_tr_b16 v[64:65], v13 offset:40960
    v_mfma_f32_16x16x32_bf16 v[144:147], v[76:79], v[100:103], v[144:147]
    ds_read_b64_tr_b16 v[66:67], v13 offset:42240
    v_mfma_f32_16x16x32_bf16 v[148:151], v[80:83], v[100:103], v[148:151]
    ds_read_b128 v[52:55], v25 offset:0
    v_mfma_f32_16x16x32_bf16 v[152:155], v[84:87], v[100:103], v[152:155]
    ds_read_b64_tr_b16 v[68:69], v15 offset:40960
    v_mfma_f32_16x16x32_bf16 v[156:159], v[88:91], v[100:103], v[156:159]
    ds_read_b64_tr_b16 v[70:71], v15 offset:42240
    v_mfma_f32_16x16x32_bf16 v[160:163], v[76:79], v[104:107], v[160:163]
    ds_read_b64_tr_b16 v[72:73], v17 offset:40960
    v_mfma_f32_16x16x32_bf16 v[164:167], v[80:83], v[104:107], v[164:167]
    ds_read_b64_tr_b16 v[74:75], v17 offset:42240
    v_mfma_f32_16x16x32_bf16 v[168:171], v[84:87], v[104:107], v[168:171]
    s_and_b32 s61, s2, 1
    s_lshl_b32 s61, s61, 2
    s_lshr_b32 s62, s2, 6
    s_add_u32 s61, s61, s62
    s_lshr_b32 s94, s61, 1
    s_lshl_b32 s94, s94, 9
    s_mul_i32 s62, s52, 96
    s_add_u32 s94, s94, s62
    s_add_u32 s94, s94, 13090816
    s_lshl_b32 s61, s61, 7
    s_lshl_b32 s62, s52, 3
    s_add_u32 s61, s61, s62
    s_add_u32 s61, s61, 13092864
    s_cmp_lg_u32 s51, 0
    s_cselect_b32 s94, s61, s94
    s_cselect_b32 s96, 1, 0xfff
    s_mov_b32 s97, 0
    v_lshlrev_b32 v240, 3, v1
    s_mov_b64 exec, s[96:97]
    buffer_load_dwordx2 v[238:239], v240, s[40:43], s94 offen sc0 sc1
    s_mov_b64 exec, -1
    v_mfma_f32_16x16x32_bf16 v[172:175], v[88:91], v[104:107], v[172:175]
    s_mul_i32 s58, s88, 3840
    s_add_u32 m0, s54, 20480
    s_nop 0
    buffer_load_dwordx4 v6, s[36:39], s58 offen lds
    v_mfma_f32_16x16x32_bf16 v[176:179], v[76:79], v[108:111], v[176:179]
    s_add_u32 m0, s54, 28672
    s_nop 0
    buffer_load_dwordx4 v7, s[36:39], s58 offen lds
    v_mfma_f32_16x16x32_bf16 v[180:183], v[80:83], v[108:111], v[180:183]
    s_add_u32 m0, s71, 20480
    s_mov_b64 exec, s[90:91]
    buffer_load_dwordx4 v8, s[36:39], s58 offen lds
    s_mov_b64 exec, -1
    v_mfma_f32_16x16x32_bf16 v[184:187], v[84:87], v[108:111], v[184:187]
    s_lshl_b32 s59, s88, 1
    s_add_u32 m0, s55, 135168
    s_nop 0
    buffer_load_dwordx4 v4, s[24:27], s59 offen lds
    v_mfma_f32_16x16x32_bf16 v[188:191], v[88:91], v[108:111], v[188:191]
    s_add_u32 m0, s55, 136192
    s_nop 0
    buffer_load_dwordx4 v5, s[24:27], s59 offen lds
    s_waitcnt vmcnt(14) lgkmcnt(0)
    s_barrier
    v_mfma_f32_16x16x32_bf16 v[112:115], v[40:43], v[56:59], v[112:115]
    ds_read_b128 v[76:79], v20 offset:0
    v_mfma_f32_16x16x32_bf16 v[116:119], v[44:47], v[56:59], v[116:119]
    ds_read_b64_tr_b16 v[92:93], v10 offset:0
    v_mfma_f32_16x16x32_bf16 v[120:123], v[48:51], v[56:59], v[120:123]
    ds_read_b64_tr_b16 v[94:95], v10 offset:1280
    v_mfma_f32_16x16x32_bf16 v[124:127], v[52:55], v[56:59], v[124:127]
    ds_read_b128 v[80:83], v22 offset:0
    v_mfma_f32_16x16x32_bf16 v[128:131], v[40:43], v[60:63], v[128:131]
    ds_read_b64_tr_b16 v[96:97], v12 offset:0
    v_mfma_f32_16x16x32_bf16 v[132:135], v[44:47], v[60:63], v[132:135]
    ds_read_b64_tr_b16 v[98:99], v12 offset:1280
    v_mfma_f32_16x16x32_bf16 v[136:139], v[48:51], v[60:63], v[136:139]
    ds_read_b128 v[84:87], v24 offset:0
    v_mfma_f32_16x16x32_bf16 v[140:143], v[52:55], v[60:63], v[140:143]
    ds_read_b64_tr_b16 v[100:101], v14 offset:0
    v_mfma_f32_16x16x32_bf16 v[144:147], v[40:43], v[64:67], v[144:147]
    ds_read_b64_tr_b16 v[102:103], v14 offset:1280
    v_mfma_f32_16x16x32_bf16 v[148:151], v[44:47], v[64:67], v[148:151]
    v_mfma_f32_16x16x32_bf16 v[152:155], v[48:51], v[64:67], v[152:155]
    ds_read_b128 v[88:91], v26 offset:0
    v_mfma_f32_16x16x32_bf16 v[156:159], v[52:55], v[64:67], v[156:159]
    ds_read_b64_tr_b16 v[104:105], v16 offset:0
    v_mfma_f32_16x16x32_bf16 v[160:163], v[40:43], v[68:71], v[160:163]
    ds_read_b64_tr_b16 v[106:107], v16 offset:1280
    v_mfma_f32_16x16x32_bf16 v[164:167], v[44:47], v[68:71], v[164:167]
    ds_read_b64_tr_b16 v[108:109], v18 offset:0
    v_mfma_f32_16x16x32_bf16 v[168:171], v[48:51], v[68:71], v[168:171]
    ds_read_b64_tr_b16 v[110:111], v18 offset:1280
    v_mfma_f32_16x16x32_bf16 v[172:175], v[52:55], v[68:71], v[172:175]
    s_lshl_b32 s68, s48, 7
    s_add_u32 s68, s68, 13097984
    s_lshl_b32 s61, s49, 7
    s_add_u32 s62, s61, 13100032
    s_add_u32 s61, s61, 13102080
    s_cmp_lt_u32 s50, 2
    s_cselect_b32 s68, s68, s62
    s_cmp_ge_u32 s50, 6
    s_cselect_b32 s68, s61, s68
    s_cselect_b32 s98, 1, 0x3ff
    s_mov_b32 s99, 0
    s_mov_b64 exec, s[98:99]
    buffer_load_dwordx2 v[232:233], v240, s[40:43], s68 offen sc0 sc1
    s_mov_b64 exec, -1
    v_mfma_f32_16x16x32_bf16 v[176:179], v[40:43], v[72:75], v[176:179]
    s_mul_i32 s58, s88, 3840
    s_add_u32 s58, s58, 122880
    s_add_u32 m0, s54, 40960
    s_nop 0
    buffer_load_dwordx4 v6, s[36:39], s58 offen lds
    v_mfma_f32_16x16x32_bf16 v[180:183], v[44:47], v[72:75], v[180:183]
    s_add_u32 m0, s54, 49152
    s_nop 0
    buffer_load_dwordx4 v7, s[36:39], s58 offen lds
    v_mfma_f32_16x16x32_bf16 v[184:187], v[48:51], v[72:75], v[184:187]
    s_add_u32 m0, s71, 40960
    s_mov_b64 exec, s[90:91]
    buffer_load_dwordx4 v8, s[36:39], s58 offen lds
    s_mov_b64 exec, -1
    v_mfma_f32_16x16x32_bf16 v[188:191], v[52:55], v[72:75], v[188:191]
    s_waitcnt vmcnt(13) lgkmcnt(0)
    s_barrier
    v_mfma_f32_16x16x32_bf16 v[112:115], v[76:79], v[92:95], v[112:115]
    ds_read_b128 v[40:43], v19 offset:16384
    v_mfma_f32_16x16x32_bf16 v[116:119], v[80:83], v[92:95], v[116:119]
    ds_read_b64_tr_b16 v[56:57], v10 offset:20480
    v_mfma_f32_16x16x32_bf16 v[120:123], v[84:87], v[92:95], v[120:123]
    ds_read_b64_tr_b16 v[58:59], v10 offset:21760
    v_mfma_f32_16x16x32_bf16 v[124:127], v[88:91], v[92:95], v[124:127]
    ds_read_b128 v[44:47], v21 offset:16384
    v_mfma_f32_16x16x32_bf16 v[128:131], v[76:79], v[96:99], v[128:131]
    ds_read_b64_tr_b16 v[60:61], v12 offset:20480
    v_mfma_f32_16x16x32_bf16 v[132:135], v[80:83], v[96:99], v[132:135]
    ds_read_b64_tr_b16 v[62:63], v12 offset:21760
    v_mfma_f32_16x16x32_bf16 v[136:139], v[84:87], v[96:99], v[136:139]
    ds_read_b128 v[48:51], v23 offset:16384
    v_mfma_f32_16x16x32_bf16 v[140:143], v[88:91], v[96:99], v[140:143]
    ds_read_b64_tr_b16 v[64:65], v14 offset:20480
    v_mfma_f32_16x16x32_bf16 v[144:147], v[76:79], v[100:103], v[144:147]
    ds_read_b64_tr_b16 v[66:67], v14 offset:21760
    v_mfma_f32_16x16x32_bf16 v[148:151], v[80:83], v[100:103], v[148:151]
    ds_read_b128 v[52:55], v25 offset:16384
    v_mfma_f32_16x16x32_bf16 v[152:155], v[84:87], v[100:103], v[152:155]
    ds_read_b64_tr_b16 v[68:69], v16 offset:20480
    v_mfma_f32_16x16x32_bf16 v[156:159], v[88:91], v[100:103], v[156:159]
    ds_read_b64_tr_b16 v[70:71], v16 offset:21760
    v_mfma_f32_16x16x32_bf16 v[160:163], v[76:79], v[104:107], v[160:163]
    ds_read_b64_tr_b16 v[72:73], v18 offset:20480
    v_mfma_f32_16x16x32_bf16 v[164:167], v[80:83], v[104:107], v[164:167]
    ds_read_b64_tr_b16 v[74:75], v18 offset:21760
    v_mfma_f32_16x16x32_bf16 v[168:171], v[84:87], v[104:107], v[168:171]
    s_mul_i32 s58, s89, 3840
    s_add_u32 m0, s54, 61440
    s_nop 0
    buffer_load_dwordx4 v6, s[36:39], s58 offen lds
    v_mfma_f32_16x16x32_bf16 v[172:175], v[88:91], v[104:107], v[172:175]
    s_add_u32 m0, s54, 69632
    s_nop 0
    buffer_load_dwordx4 v7, s[36:39], s58 offen lds
    v_mfma_f32_16x16x32_bf16 v[176:179], v[76:79], v[108:111], v[176:179]
    s_add_u32 m0, s71, 61440
    s_mov_b64 exec, s[90:91]
    buffer_load_dwordx4 v8, s[36:39], s58 offen lds
    s_mov_b64 exec, -1
    v_mfma_f32_16x16x32_bf16 v[180:183], v[80:83], v[108:111], v[180:183]
    s_lshl_b32 s59, s89, 1
    s_add_u32 m0, s55, 102400
    s_nop 0
    buffer_load_dwordx4 v4, s[24:27], s59 offen lds
    v_mfma_f32_16x16x32_bf16 v[184:187], v[84:87], v[108:111], v[184:187]
    s_add_u32 m0, s55, 103424
    s_nop 0
    buffer_load_dwordx4 v5, s[24:27], s59 offen lds
    v_mfma_f32_16x16x32_bf16 v[188:191], v[88:91], v[108:111], v[188:191]
    s_waitcnt vmcnt(8) lgkmcnt(0)
    s_barrier
    v_mfma_f32_16x16x32_bf16 v[112:115], v[40:43], v[56:59], v[112:115]
    ds_read_b128 v[76:79], v20 offset:16384
    v_mfma_f32_16x16x32_bf16 v[116:119], v[44:47], v[56:59], v[116:119]
    ds_read_b64_tr_b16 v[92:93], v9 offset:0
    v_mfma_f32_16x16x32_bf16 v[120:123], v[48:51], v[56:59], v[120:123]
    ds_read_b64_tr_b16 v[94:95], v9 offset:1280
    v_mfma_f32_16x16x32_bf16 v[124:127], v[52:55], v[56:59], v[124:127]
    ds_read_b128 v[80:83], v22 offset:16384
    v_mfma_f32_16x16x32_bf16 v[128:131], v[40:43], v[60:63], v[128:131]
    ds_read_b64_tr_b16 v[96:97], v11 offset:0
    v_mfma_f32_16x16x32_bf16 v[132:135], v[44:47], v[60:63], v[132:135]
    ds_read_b64_tr_b16 v[98:99], v11 offset:1280
    v_mfma_f32_16x16x32_bf16 v[136:139], v[48:51], v[60:63], v[136:139]
    v_mfma_f32_16x16x32_bf16 v[140:143], v[52:55], v[60:63], v[140:143]
    ds_read_b128 v[84:87], v24 offset:16384
    s_mov_b64 exec, s[98:99]
P1_KV_CHK:
    v_cmp_ne_u64 s[62:63], s[92:93], v[232:233]
    s_nop 1
    s_cmp_eq_u64 s[62:63], 0
    s_cbranch_scc1 P1_KV_OK
    s_add_u32 s3, s3, 1
    s_cmp_gt_u32 s3, 0x200000
    s_cbranch_scc1 K_END
    s_sleep 2
    buffer_load_dwordx2 v[232:233], v240, s[40:43], s68 offen sc0 sc1
    s_waitcnt vmcnt(0)
    s_branch P1_KV_CHK
P1_KV_OK:
    s_mov_b64 exec, -1
    s_sub_u32 s61, s50, 2
    s_cmp_lt_u32 s61, 4
    s_cbranch_scc1 P1_KV_CI_COL
P1_KV_CI_ROW:
    s_lshl_b32 s61, s48, 14
    s_add_u32 s61, s61, 11763712
    v_lshlrev_b32 v30, 3, v0
    buffer_load_dwordx2 v[192:193], v30, s[40:43], s61 offen offset:0 sc0 sc1
    buffer_load_dwordx2 v[194:195], v30, s[40:43], s61 offen offset:1024 sc0 sc1
    buffer_load_dwordx2 v[196:197], v30, s[40:43], s61 offen offset:2048 sc0 sc1
    buffer_load_dwordx2 v[198:199], v30, s[40:43], s61 offen offset:3072 sc0 sc1
    s_add_u32 s61, s61, 4096
    buffer_load_dwordx2 v[200:201], v30, s[40:43], s61 offen offset:0 sc0 sc1
    buffer_load_dwordx2 v[202:203], v30, s[40:43], s61 offen offset:1024 sc0 sc1
    buffer_load_dwordx2 v[204:205], v30, s[40:43], s61 offen offset:2048 sc0 sc1
    buffer_load_dwordx2 v[206:207], v30, s[40:43], s61 offen offset:3072 sc0 sc1
    s_add_u32 s61, s61, 4096
    buffer_load_dwordx2 v[208:209], v30, s[40:43], s61 offen offset:0 sc0 sc1
    buffer_load_dwordx2 v[210:211], v30, s[40:43], s61 offen offset:1024 sc0 sc1
    s_branch P1_KV_CI_DONE
P1_KV_CI_COL:
    s_lshl_b32 s61, s49, 2
    s_add_u32 s61, s61, s50
    s_sub_u32 s61, s61, 2
    s_lshl_b32 s61, s61, 14
    s_add_u32 s61, s61, 12025856
    v_lshlrev_b32 v30, 4, v1
    v_and_b32 v31, 31, v1
    v_cmp_gt_u32 s[62:63], 20, v31
    v_mov_b32 v31, 0x40000000
    s_nop 0
    v_cndmask_b32 v30, v31, v30, s[62:63]
    buffer_load_dwordx4 v[192:195], v30, s[40:43], s61 offen offset:0 sc0 sc1
    buffer_load_dwordx4 v[196:199], v30, s[40:43], s61 offen offset:1024 sc0 sc1
    buffer_load_dwordx4 v[200:203], v30, s[40:43], s61 offen offset:2048 sc0 sc1
    buffer_load_dwordx4 v[204:207], v30, s[40:43], s61 offen offset:3072 sc0 sc1
    s_add_u32 s61, s61, 4096
    buffer_load_dwordx4 v[208:211], v30, s[40:43], s61 offen offset:0 sc0 sc1
    buffer_load_dwordx4 v[212:215], v30, s[40:43], s61 offen offset:1024 sc0 sc1
    buffer_load_dwordx4 v[216:219], v30, s[40:43], s61 offen offset:2048 sc0 sc1
    buffer_load_dwordx4 v[220:223], v30, s[40:43], s61 offen offset:3072 sc0 sc1
    s_add_u32 s61, s61, 4096
    buffer_load_dwordx4 v[224:227], v30, s[40:43], s61 offen offset:0 sc0 sc1
    buffer_load_dwordx4 v[228:231], v30, s[40:43], s61 offen offset:1024 sc0 sc1
P1_KV_CI_DONE:
    v_mfma_f32_16x16x32_bf16 v[144:147], v[40:43], v[64:67], v[144:147]
    ds_read_b64_tr_b16 v[100:101], v13 offset:0
    v_mfma_f32_16x16x32_bf16 v[148:151], v[44:47], v[64:67], v[148:151]
    ds_read_b64_tr_b16 v[102:103], v13 offset:1280
    v_mfma_f32_16x16x32_bf16 v[152:155], v[48:51], v[64:67], v[152:155]
    ds_read_b128 v[88:91], v26 offset:16384
    v_mfma_f32_16x16x32_bf16 v[156:159], v[52:55], v[64:67], v[156:159]
    ds_read_b64_tr_b16 v[104:105], v15 offset:0
    v_mfma_f32_16x16x32_bf16 v[160:163], v[40:43], v[68:71], v[160:163]
    ds_read_b64_tr_b16 v[106:107], v15 offset:1280
    v_mfma_f32_16x16x32_bf16 v[164:167], v[44:47], v[68:71], v[164:167]
    v_mfma_f32_16x16x32_bf16 v[168:171], v[48:51], v[68:71], v[168:171]
    ds_read_b64_tr_b16 v[108:109], v17 offset:0
    v_mfma_f32_16x16x32_bf16 v[172:175], v[52:55], v[68:71], v[172:175]
    ds_read_b64_tr_b16 v[110:111], v17 offset:1280
    v_mfma_f32_16x16x32_bf16 v[176:179], v[40:43], v[72:75], v[176:179]
    s_mul_i32 s58, s89, 3840
    s_add_u32 s58, s58, 122880
    s_add_u32 m0, s54, 81920
    s_nop 0
    buffer_load_dwordx4 v6, s[36:39], s58 offen lds
    v_mfma_f32_16x16x32_bf16 v[180:183], v[44:47], v[72:75], v[180:183]
    s_add_u32 m0, s54, 90112
    s_nop 0
    buffer_load_dwordx4 v7, s[36:39], s58 offen lds
    v_mfma_f32_16x16x32_bf16 v[184:187], v[48:51], v[72:75], v[184:187]
    s_add_u32 m0, s71, 81920
    s_mov_b64 exec, s[90:91]
    buffer_load_dwordx4 v8, s[36:39], s58 offen lds
    s_mov_b64 exec, -1
    v_mfma_f32_16x16x32_bf16 v[188:191], v[52:55], v[72:75], v[188:191]
    s_waitcnt vmcnt(22) lgkmcnt(0)
    s_barrier
    v_mfma_f32_16x16x32_bf16 v[112:115], v[76:79], v[92:95], v[112:115]
    ds_read_b128 v[40:43], v19 offset:32768
    v_mfma_f32_16x16x32_bf16 v[116:119], v[80:83], v[92:95], v[116:119]
    ds_read_b64_tr_b16 v[56:57], v9 offset:20480
    v_mfma_f32_16x16x32_bf16 v[120:123], v[84:87], v[92:95], v[120:123]
    ds_read_b64_tr_b16 v[58:59], v9 offset:21760
    v_mfma_f32_16x16x32_bf16 v[124:127], v[88:91], v[92:95], v[124:127]
    v_mfma_f32_16x16x32_bf16 v[128:131], v[76:79], v[96:99], v[128:131]
    ds_read_b128 v[44:47], v21 offset:32768
    v_mfma_f32_16x16x32_bf16 v[132:135], v[80:83], v[96:99], v[132:135]
    ds_read_b64_tr_b16 v[60:61], v11 offset:20480
    v_mfma_f32_16x16x32_bf16 v[136:139], v[84:87], v[96:99], v[136:139]
    v_mfma_f32_16x16x32_bf16 v[140:143], v[88:91], v[96:99], v[140:143]
    ds_read_b64_tr_b16 v[62:63], v11 offset:21760
    s_mov_b64 exec, s[96:97]
P1_KV_WF:
    v_cmp_ne_u64 s[62:63], s[92:93], v[238:239]
    s_nop 1
    s_cmp_eq_u64 s[62:63], 0
    s_cbranch_scc1 P1_KV_WF_OK
    s_add_u32 s3, s3, 1
    s_cmp_gt_u32 s3, 0x200000
    s_cbranch_scc1 K_END
    s_sleep 4
    buffer_load_dwordx2 v[238:239], v240, s[40:43], s94 offen sc0 sc1
    s_waitcnt vmcnt(0)
    s_branch P1_KV_WF
P1_KV_WF_OK:
    s_mov_b64 exec, -1
    v_mfma_f32_16x16x32_bf16 v[144:147], v[76:79], v[100:103], v[144:147]
    ds_read_b128 v[48:51], v23 offset:32768
    v_mfma_f32_16x16x32_bf16 v[148:151], v[80:83], v[100:103], v[148:151]
    v_mfma_f32_16x16x32_bf16 v[152:155], v[84:87], v[100:103], v[152:155]
    ds_read_b64_tr_b16 v[64:65], v13 offset:20480
    v_mfma_f32_16x16x32_bf16 v[156:159], v[88:91], v[100:103], v[156:159]
    ds_read_b64_tr_b16 v[66:67], v13 offset:21760
    v_mfma_f32_16x16x32_bf16 v[160:163], v[76:79], v[104:107], v[160:163]
    ds_read_b128 v[52:55], v25 offset:32768
    v_mfma_f32_16x16x32_bf16 v[164:167], v[80:83], v[104:107], v[164:167]
    v_mfma_f32_16x16x32_bf16 v[168:171], v[84:87], v[104:107], v[168:171]
    ds_read_b64_tr_b16 v[68:69], v15 offset:20480
    v_mfma_f32_16x16x32_bf16 v[172:175], v[88:91], v[104:107], v[172:175]
    ds_read_b64_tr_b16 v[70:71], v15 offset:21760
    v_mfma_f32_16x16x32_bf16 v[176:179], v[76:79], v[108:111], v[176:179]
    v_mfma_f32_16x16x32_bf16 v[180:183], v[80:83], v[108:111], v[180:183]
    ds_read_b64_tr_b16 v[72:73], v17 offset:20480
    v_mfma_f32_16x16x32_bf16 v[184:187], v[84:87], v[108:111], v[184:187]
    ds_read_b64_tr_b16 v[74:75], v17 offset:21760
    v_mfma_f32_16x16x32_bf16 v[188:191], v[88:91], v[108:111], v[188:191]
    s_waitcnt vmcnt(18) lgkmcnt(0)
    s_barrier
    v_mfma_f32_16x16x32_bf16 v[112:115], v[40:43], v[56:59], v[112:115]
    ds_read_b128 v[76:79], v20 offset:32768
    v_mfma_f32_16x16x32_bf16 v[116:119], v[44:47], v[56:59], v[116:119]
    ds_read_b64_tr_b16 v[92:93], v9 offset:40960
    v_mfma_f32_16x16x32_bf16 v[120:123], v[48:51], v[56:59], v[120:123]
    ds_read_b64_tr_b16 v[94:95], v9 offset:42240
    v_mfma_f32_16x16x32_bf16 v[124:127], v[52:55], v[56:59], v[124:127]
    v_mfma_f32_16x16x32_bf16 v[128:131], v[40:43], v[60:63], v[128:131]
    ds_read_b128 v[80:83], v22 offset:32768
    v_mfma_f32_16x16x32_bf16 v[132:135], v[44:47], v[60:63], v[132:135]
    ds_read_b64_tr_b16 v[96:97], v11 offset:40960
    v_mfma_f32_16x16x32_bf16 v[136:139], v[48:51], v[60:63], v[136:139]
    v_mfma_f32_16x16x32_bf16 v[140:143], v[52:55], v[60:63], v[140:143]
    ds_read_b64_tr_b16 v[98:99], v11 offset:42240
    v_mfma_f32_16x16x32_bf16 v[144:147], v[40:43], v[64:67], v[144:147]
    ds_read_b128 v[84:87], v24 offset:32768
    v_mfma_f32_16x16x32_bf16 v[148:151], v[44:47], v[64:67], v[148:151]
    v_mfma_f32_16x16x32_bf16 v[152:155], v[48:51], v[64:67], v[152:155]
    ds_read_b64_tr_b16 v[100:101], v13 offset:40960
    v_mfma_f32_16x16x32_bf16 v[156:159], v[52:55], v[64:67], v[156:159]
    ds_read_b64_tr_b16 v[102:103], v13 offset:42240
    v_mfma_f32_16x16x32_bf16 v[160:163], v[40:43], v[68:71], v[160:163]
    ds_read_b128 v[88:91], v26 offset:32768
    v_mfma_f32_16x16x32_bf16 v[164:167], v[44:47], v[68:71], v[164:167]
    v_mfma_f32_16x16x32_bf16 v[168:171], v[48:51], v[68:71], v[168:171]
    ds_read_b64_tr_b16 v[104:105], v15 offset:40960
    v_mfma_f32_16x16x32_bf16 v[172:175], v[52:55], v[68:71], v[172:175]
    ds_read_b64_tr_b16 v[106:107], v15 offset:42240
    v_mfma_f32_16x16x32_bf16 v[176:179], v[40:43], v[72:75], v[176:179]
    v_mfma_f32_16x16x32_bf16 v[180:183], v[44:47], v[72:75], v[180:183]
    ds_read_b64_tr_b16 v[108:109], v17 offset:40960
    v_mfma_f32_16x16x32_bf16 v[184:187], v[48:51], v[72:75], v[184:187]
    ds_read_b64_tr_b16 v[110:111], v17 offset:42240
    v_mfma_f32_16x16x32_bf16 v[188:191], v[52:55], v[72:75], v[188:191]
    s_waitcnt vmcnt(3)
    s_cmp_ge_u32 s50, 6
    s_cbranch_scc1 P1_KV_CF_DONE
    s_cmp_ge_u32 s50, 2
    s_cbranch_scc1 P1_KV_CF_COL
    v_add_f32 v192, v192, v202
    v_add_f32 v193, v193, v203
    v_add_f32 v194, v194, v204
    v_add_f32 v195, v195, v205
    v_add_f32 v196, v196, v206
    v_add_f32 v197, v197, v207
    v_add_f32 v198, v198, v208
    v_add_f32 v199, v199, v209
    v_add_f32 v200, v200, v210
    v_add_f32 v201, v201, v211
    v_add_f32 v192, v192, v194
    v_add_f32 v193, v193, v195
    v_add_f32 v196, v196, v198
    v_add_f32 v197, v197, v199
    v_add_f32 v192, v192, v200
    v_add_f32 v193, v193, v201
    v_add_f32 v192, v192, v196
    v_add_f32 v193, v193, v197
    v_mul_f32 v192, 0x3acccccd, v192
    v_mul_f32 v193, 0x3acccccd, v193
    v_fma_f32 v193, -v192, v192, v193
    v_max_f32 v193, 0, v193
    v_cvt_pk_bf16_f32 v192, v192, v192
    v_lshlrev_b32 v192, 16, v192
    v_cvt_pk_bf16_f32 v193, v193, v193
    v_lshlrev_b32 v193, 16, v193
    v_add_f32 v193, 0x3727c5ac, v193
    v_cvt_pk_bf16_f32 v193, v193, v193
    v_lshlrev_b32 v193, 16, v193
    v_sqrt_f32 v193, v193
    s_nop 0
    v_cvt_pk_bf16_f32 v193, v193, v193
    v_lshlrev_b32 v193, 16, v193
    v_mov_b32 v30, 159744
    v_lshl_add_u32 v30, v0, 3, v30
    ds_write_b64 v30, v[192:193]
    s_branch P1_KV_CF_DONE
P1_KV_CF_COL:
    v_add_f32 v192, v192, v212
    v_add_f32 v193, v193, v213
    v_add_f32 v194, v194, v214
    v_add_f32 v195, v195, v215
    v_add_f32 v196, v196, v216
    v_add_f32 v197, v197, v217
    v_add_f32 v198, v198, v218
    v_add_f32 v199, v199, v219
    v_add_f32 v200, v200, v220
    v_add_f32 v201, v201, v221
    v_add_f32 v202, v202, v222
    v_add_f32 v203, v203, v223
    v_add_f32 v204, v204, v224
    v_add_f32 v205, v205, v225
    v_add_f32 v206, v206, v226
    v_add_f32 v207, v207, v227
    v_add_f32 v208, v208, v228
    v_add_f32 v209, v209, v229
    v_add_f32 v210, v210, v230
    v_add_f32 v211, v211, v231
    v_add_f32 v192, v192, v200
    v_add_f32 v193, v193, v201
    v_add_f32 v194, v194, v202
    v_add_f32 v195, v195, v203
    v_add_f32 v196, v196, v204
    v_add_f32 v197, v197, v205
    v_add_f32 v198, v198, v206
    v_add_f32 v199, v199, v207
    v_add_f32 v192, v192, v196
    v_add_f32 v193, v193, v197
    v_add_f32 v194, v194, v198
    v_add_f32 v195, v195, v199
    v_add_f32 v192, v192, v208
    v_add_f32 v193, v193, v209
    v_add_f32 v194, v194, v210
    v_add_f32 v195, v195, v211
    v_mov_b32 v196, v192
    v_mov_b32 v197, v193
    v_mov_b32 v198, v194
    v_mov_b32 v199, v195
    v_permlane32_swap_b32 v192, v196
    v_permlane32_swap_b32 v193, v197
    v_permlane32_swap_b32 v194, v198
    v_permlane32_swap_b32 v195, v199
    v_add_f32 v192, v192, v196
    v_add_f32 v193, v193, v197
    v_add_f32 v194, v194, v198
    v_add_f32 v195, v195, v199
    s_sub_u32 s56, s50, 2
    s_mul_i32 s56, s56, 320
    s_add_u32 s56, s56, 160768
    v_lshl_add_u32 v30, v1, 4, s56
    s_mov_b64 exec, 0xfffff
    ds_write_b128 v30, v[192:195]
    s_mov_b64 exec, -1
P1_KV_CF_DONE:
    s_waitcnt vmcnt(13) lgkmcnt(0)
    s_barrier
    v_mfma_f32_16x16x32_bf16 v[112:115], v[76:79], v[92:95], v[112:115]
    ds_read_b128 v[40:43], v19 offset:0
    ds_read_b64_tr_b16 v[56:57], v10 offset:0
    v_mfma_f32_16x16x32_bf16 v[116:119], v[80:83], v[92:95], v[116:119]
    ds_read_b64_tr_b16 v[58:59], v10 offset:1280
    v_mfma_f32_16x16x32_bf16 v[120:123], v[84:87], v[92:95], v[120:123]
    ds_read_b128 v[44:47], v21 offset:0
    v_mfma_f32_16x16x32_bf16 v[124:127], v[88:91], v[92:95], v[124:127]
    ds_read_b64_tr_b16 v[60:61], v12 offset:0
    v_mfma_f32_16x16x32_bf16 v[128:131], v[76:79], v[96:99], v[128:131]
    ds_read_b64_tr_b16 v[62:63], v12 offset:1280
    v_mfma_f32_16x16x32_bf16 v[132:135], v[80:83], v[96:99], v[132:135]
    ds_read_b128 v[48:51], v23 offset:0
    ds_read_b64_tr_b16 v[64:65], v14 offset:0
    v_mfma_f32_16x16x32_bf16 v[136:139], v[84:87], v[96:99], v[136:139]
    ds_read_b64_tr_b16 v[66:67], v14 offset:1280
    v_mfma_f32_16x16x32_bf16 v[140:143], v[88:91], v[96:99], v[140:143]
    ds_read_b128 v[52:55], v25 offset:0
    v_mfma_f32_16x16x32_bf16 v[144:147], v[76:79], v[100:103], v[144:147]
    ds_read_b64_tr_b16 v[68:69], v16 offset:0
    v_mfma_f32_16x16x32_bf16 v[148:151], v[80:83], v[100:103], v[148:151]
    ds_read_b64_tr_b16 v[70:71], v16 offset:1280
    v_mfma_f32_16x16x32_bf16 v[152:155], v[84:87], v[100:103], v[152:155]
    ds_read_b64_tr_b16 v[72:73], v18 offset:0
    ds_read_b64_tr_b16 v[74:75], v18 offset:1280
    v_mfma_f32_16x16x32_bf16 v[156:159], v[88:91], v[100:103], v[156:159]
    s_xor_b32 s56, s52, 0
    s_lshl_b32 s57, s51, 2
    s_add_u32 s56, s56, s57
    s_lshl_b32 s56, s56, 7
    s_add_u32 s56, s56, 159744
    v_lshl_add_u32 v224, v3, 5, s56
    ds_read_b128 v[192:195], v224
    ds_read_b128 v[196:199], v224 offset:16
    v_mfma_f32_16x16x32_bf16 v[160:163], v[76:79], v[104:107], v[160:163]
    s_xor_b32 s56, s52, 1
    s_lshl_b32 s57, s51, 2
    s_add_u32 s56, s56, s57
    s_lshl_b32 s56, s56, 7
    s_add_u32 s56, s56, 159744
    v_lshl_add_u32 v225, v3, 5, s56
    ds_read_b128 v[200:203], v225
    ds_read_b128 v[204:207], v225 offset:16
    v_mfma_f32_16x16x32_bf16 v[164:167], v[80:83], v[104:107], v[164:167]
    s_xor_b32 s56, s52, 2
    s_lshl_b32 s57, s51, 2
    s_add_u32 s56, s56, s57
    s_lshl_b32 s56, s56, 7
    s_add_u32 s56, s56, 159744
    v_lshl_add_u32 v226, v3, 5, s56
    ds_read_b128 v[208:211], v226
    ds_read_b128 v[212:215], v226 offset:16
    v_mfma_f32_16x16x32_bf16 v[168:171], v[84:87], v[104:107], v[168:171]
    s_xor_b32 s56, s52, 3
    s_lshl_b32 s57, s51, 2
    s_add_u32 s56, s56, s57
    s_lshl_b32 s56, s56, 7
    s_add_u32 s56, s56, 159744
    v_lshl_add_u32 v227, v3, 5, s56
    ds_read_b128 v[216:219], v227
    ds_read_b128 v[220:223], v227 offset:16
    v_mfma_f32_16x16x32_bf16 v[172:175], v[88:91], v[104:107], v[172:175]
    s_mul_i32 s56, s52, 320
    s_add_u32 s56, s56, 160768
    v_lshl_add_u32 v228, v2, 2, s56
    ds_read_b32 v30, v228 offset:0
    v_mfma_f32_16x16x32_bf16 v[176:179], v[76:79], v[108:111], v[176:179]
    ds_read_b32 v31, v228 offset:64
    v_mfma_f32_16x16x32_bf16 v[180:183], v[80:83], v[108:111], v[180:183]
    ds_read_b32 v32, v228 offset:128
    v_mfma_f32_16x16x32_bf16 v[184:187], v[84:87], v[108:111], v[184:187]
    ds_read_b32 v33, v228 offset:192
    v_mfma_f32_16x16x32_bf16 v[188:191], v[88:91], v[108:111], v[188:191]
    ds_read_b32 v34, v228 offset:256
    s_waitcnt vmcnt(0) lgkmcnt(0)
    s_barrier
    v_mfma_f32_16x16x32_bf16 v[112:115], v[40:43], v[56:59], v[112:115]
    ds_read_b128 v[76:79], v20 offset:0
    ds_read_b64_tr_b16 v[92:93], v10 offset:20480
    v_mfma_f32_16x16x32_bf16 v[116:119], v[44:47], v[56:59], v[116:119]
    ds_read_b64_tr_b16 v[94:95], v10 offset:21760
    v_mfma_f32_16x16x32_bf16 v[120:123], v[48:51], v[56:59], v[120:123]
    ds_read_b128 v[80:83], v22 offset:0
    ds_read_b64_tr_b16 v[96:97], v12 offset:20480
    v_mfma_f32_16x16x32_bf16 v[124:127], v[52:55], v[56:59], v[124:127]
    ds_read_b64_tr_b16 v[98:99], v12 offset:21760
    v_mfma_f32_16x16x32_bf16 v[128:131], v[40:43], v[60:63], v[128:131]
    ds_read_b128 v[84:87], v24 offset:0
    ds_read_b64_tr_b16 v[100:101], v14 offset:20480
    v_mfma_f32_16x16x32_bf16 v[132:135], v[44:47], v[60:63], v[132:135]
    ds_read_b64_tr_b16 v[102:103], v14 offset:21760
    v_mfma_f32_16x16x32_bf16 v[136:139], v[48:51], v[60:63], v[136:139]
    ds_read_b128 v[88:91], v26 offset:0
    ds_read_b64_tr_b16 v[104:105], v16 offset:20480
    v_mfma_f32_16x16x32_bf16 v[140:143], v[52:55], v[60:63], v[140:143]
    ds_read_b64_tr_b16 v[106:107], v16 offset:21760
    v_mfma_f32_16x16x32_bf16 v[144:147], v[40:43], v[64:67], v[144:147]
    ds_read_b64_tr_b16 v[108:109], v18 offset:20480
    ds_read_b64_tr_b16 v[110:111], v18 offset:21760
    v_mfma_f32_16x16x32_bf16 v[148:151], v[44:47], v[64:67], v[148:151]
    v_rcp_f32 v193, v193
    v_mfma_f32_16x16x32_bf16 v[152:155], v[48:51], v[64:67], v[152:155]
    v_rcp_f32 v195, v195
    v_rcp_f32 v197, v197
    v_mfma_f32_16x16x32_bf16 v[156:159], v[52:55], v[64:67], v[156:159]
    v_rcp_f32 v199, v199
    v_mfma_f32_16x16x32_bf16 v[160:163], v[40:43], v[68:71], v[160:163]
    v_rcp_f32 v201, v201
    v_rcp_f32 v203, v203
    v_mfma_f32_16x16x32_bf16 v[164:167], v[44:47], v[68:71], v[164:167]
    v_rcp_f32 v205, v205
    v_mfma_f32_16x16x32_bf16 v[168:171], v[48:51], v[68:71], v[168:171]
    v_rcp_f32 v207, v207
    v_rcp_f32 v209, v209
    v_mfma_f32_16x16x32_bf16 v[172:175], v[52:55], v[68:71], v[172:175]
    v_rcp_f32 v211, v211
    v_mfma_f32_16x16x32_bf16 v[176:179], v[40:43], v[72:75], v[176:179]
    v_rcp_f32 v213, v213
    v_rcp_f32 v215, v215
    v_mfma_f32_16x16x32_bf16 v[180:183], v[44:47], v[72:75], v[180:183]
    v_rcp_f32 v217, v217
    v_mfma_f32_16x16x32_bf16 v[184:187], v[48:51], v[72:75], v[184:187]
    v_rcp_f32 v219, v219
    v_rcp_f32 v221, v221
    v_mfma_f32_16x16x32_bf16 v[188:191], v[52:55], v[72:75], v[188:191]
    v_rcp_f32 v223, v223
    s_waitcnt lgkmcnt(0)
    s_barrier
    v_mfma_f32_16x16x32_bf16 v[112:115], v[76:79], v[92:95], v[112:115]
    s_and_b32 s61, s2, 1
    s_lshl_b32 s61, s61, 2
    s_lshr_b32 s62, s2, 6
    s_add_u32 s61, s61, s62
    s_mul_i32 s61, s61, 48
    s_mul_i32 s62, s52, 12
    s_add_u32 s61, s61, s62
    s_mul_i32 s61, s61, 5120
    s_mul_i32 s62, s51, 10240
    s_add_u32 s61, s61, s62
    s_add_u32 s61, s61, 8912896
    s_mul_i32 s63, s52, 20480
    s_add_u32 s63, s63, s62
    s_add_u32 s63, s63, 77824
    v_lshlrev_b32 v241, 4, v1
    v_mfma_f32_16x16x32_bf16 v[116:119], v[80:83], v[92:95], v[116:119]
    s_add_u32 m0, s63, 0
    s_nop 0
    buffer_load_dwordx4 v241, s[40:43], s61 offen sc0 sc1 lds
    s_add_u32 s61, s61, 1024
    v_mfma_f32_16x16x32_bf16 v[120:123], v[84:87], v[92:95], v[120:123]
    v_mfma_f32_16x16x32_bf16 v[124:127], v[88:91], v[92:95], v[124:127]
    s_add_u32 m0, s63, 1024
    s_nop 0
    buffer_load_dwordx4 v241, s[40:43], s61 offen sc0 sc1 lds
    s_add_u32 s61, s61, 1024
    v_mfma_f32_16x16x32_bf16 v[128:131], v[76:79], v[96:99], v[128:131]
    v_mfma_f32_16x16x32_bf16 v[132:135], v[80:83], v[96:99], v[132:135]
    s_add_u32 m0, s63, 2048
    s_nop 0
    buffer_load_dwordx4 v241, s[40:43], s61 offen sc0 sc1 lds
    s_add_u32 s61, s61, 1024
    v_mfma_f32_16x16x32_bf16 v[136:139], v[84:87], v[96:99], v[136:139]
    v_mfma_f32_16x16x32_bf16 v[140:143], v[88:91], v[96:99], v[140:143]
    s_add_u32 m0, s63, 3072
    s_nop 0
    buffer_load_dwordx4 v241, s[40:43], s61 offen sc0 sc1 lds
    s_add_u32 s61, s61, 1024
    v_mfma_f32_16x16x32_bf16 v[144:147], v[76:79], v[100:103], v[144:147]
    v_mfma_f32_16x16x32_bf16 v[148:151], v[80:83], v[100:103], v[148:151]
    s_add_u32 m0, s63, 4096
    s_nop 0
    buffer_load_dwordx4 v241, s[40:43], s61 offen sc0 sc1 lds
    s_add_u32 s61, s61, 1024
    v_mfma_f32_16x16x32_bf16 v[152:155], v[84:87], v[100:103], v[152:155]
    s_add_u32 m0, s63, 5120
    s_nop 0
    buffer_load_dwordx4 v241, s[40:43], s61 offen sc0 sc1 lds
    s_add_u32 s61, s61, 1024
    v_mfma_f32_16x16x32_bf16 v[156:159], v[88:91], v[100:103], v[156:159]
    v_mfma_f32_16x16x32_bf16 v[160:163], v[76:79], v[104:107], v[160:163]
    s_add_u32 m0, s63, 6144
    s_nop 0
    buffer_load_dwordx4 v241, s[40:43], s61 offen sc0 sc1 lds
    s_add_u32 s61, s61, 1024
    v_mfma_f32_16x16x32_bf16 v[164:167], v[80:83], v[104:107], v[164:167]
    v_mfma_f32_16x16x32_bf16 v[168:171], v[84:87], v[104:107], v[168:171]
    s_add_u32 m0, s63, 7168
    s_nop 0
    buffer_load_dwordx4 v241, s[40:43], s61 offen sc0 sc1 lds
    s_add_u32 s61, s61, 1024
    v_mfma_f32_16x16x32_bf16 v[172:175], v[88:91], v[104:107], v[172:175]
    v_mfma_f32_16x16x32_bf16 v[176:179], v[76:79], v[108:111], v[176:179]
    s_add_u32 m0, s63, 8192
    s_nop 0
    buffer_load_dwordx4 v241, s[40:43], s61 offen sc0 sc1 lds
    s_add_u32 s61, s61, 1024
    v_mfma_f32_16x16x32_bf16 v[180:183], v[80:83], v[108:111], v[180:183]
    v_mfma_f32_16x16x32_bf16 v[184:187], v[84:87], v[108:111], v[184:187]
    s_add_u32 m0, s63, 9216
    s_nop 0
    buffer_load_dwordx4 v241, s[40:43], s61 offen sc0 sc1 lds
    s_add_u32 s61, s61, 1024
    v_mfma_f32_16x16x32_bf16 v[188:191], v[88:91], v[108:111], v[188:191]
    s_mov_b32 s69, 0x3fb8aa3b
    s_mov_b32 s70, 0x358637bd
    v_cmp_gt_u32 s[64:65], 8, v2
    v_fma_f32 v112, -v192, v30, v112
    v_fma_f32 v113, -v194, v30, v113
    v_fma_f32 v114, -v196, v30, v114
    v_fma_f32 v115, -v198, v30, v115
    v_fma_f32 v116, -v200, v30, v116
    v_fma_f32 v117, -v202, v30, v117
    v_fma_f32 v118, -v204, v30, v118
    v_fma_f32 v119, -v206, v30, v119
    v_mul_f32 v112, v112, v193
    v_mul_f32 v113, v113, v195
    v_mul_f32 v114, v114, v197
    v_mul_f32 v115, v115, v199
    v_mul_f32 v116, v116, v201
    v_mul_f32 v117, v117, v203
    v_mul_f32 v118, v118, v205
    v_mul_f32 v119, v119, v207
    v_mul_f32 v224, s69, v112
    v_mul_f32 v225, s69, v113
    v_mul_f32 v226, s69, v114
    v_mul_f32 v227, s69, v115
    v_mul_f32 v228, s69, v116
    v_mul_f32 v229, s69, v117
    v_mul_f32 v230, s69, v118
    v_mul_f32 v231, s69, v119
    v_exp_f32 v224, v224 clamp
    v_max_f32 v112, s70, v112
    v_exp_f32 v225, v225 clamp
    v_max_f32 v113, s70, v113
    v_exp_f32 v226, v226 clamp
    v_max_f32 v114, s70, v114
    v_exp_f32 v227, v227 clamp
    v_max_f32 v115, s70, v115
    v_exp_f32 v228, v228 clamp
    v_max_f32 v116, s70, v116
    v_exp_f32 v229, v229 clamp
    v_max_f32 v117, s70, v117
    v_exp_f32 v230, v230 clamp
    v_max_f32 v118, s70, v118
    v_exp_f32 v231, v231 clamp
    v_max_f32 v119, s70, v119
    v_add_f32 v112, v112, v224
    v_add_f32 v113, v113, v225
    v_add_f32 v114, v114, v226
    v_add_f32 v115, v115, v227
    v_add_f32 v116, v116, v228
    v_add_f32 v117, v117, v229
    v_add_f32 v118, v118, v230
    v_add_f32 v119, v119, v231
    v_cvt_pk_bf16_f32 v40, v112, v113
    v_cvt_pk_bf16_f32 v41, v114, v115
    v_cvt_pk_bf16_f32 v42, v116, v117
    v_cvt_pk_bf16_f32 v43, v118, v119
    v_fma_f32 v128, -v192, v31, v128
    v_fma_f32 v129, -v194, v31, v129
    v_fma_f32 v130, -v196, v31, v130
    v_fma_f32 v131, -v198, v31, v131
    v_fma_f32 v132, -v200, v31, v132
    v_fma_f32 v133, -v202, v31, v133
    v_fma_f32 v134, -v204, v31, v134
    v_fma_f32 v135, -v206, v31, v135
    v_mul_f32 v128, v128, v193
    v_mul_f32 v129, v129, v195
    v_mul_f32 v130, v130, v197
    v_mul_f32 v131, v131, v199
    v_mul_f32 v132, v132, v201
    v_mul_f32 v133, v133, v203
    v_mul_f32 v134, v134, v205
    v_mul_f32 v135, v135, v207
    v_mul_f32 v224, s69, v128
    v_mul_f32 v225, s69, v129
    v_mul_f32 v226, s69, v130
    v_mul_f32 v227, s69, v131
    v_mul_f32 v228, s69, v132
    v_mul_f32 v229, s69, v133
    v_mul_f32 v230, s69, v134
    v_mul_f32 v231, s69, v135
    v_exp_f32 v224, v224 clamp
    v_max_f32 v128, s70, v128
    v_exp_f32 v225, v225 clamp
    v_max_f32 v129, s70, v129
    v_exp_f32 v226, v226 clamp
    v_max_f32 v130, s70, v130
    v_exp_f32 v227, v227 clamp
    v_max_f32 v131, s70, v131
    v_exp_f32 v228, v228 clamp
    v_max_f32 v132, s70, v132
    v_exp_f32 v229, v229 clamp
    v_max_f32 v133, s70, v133
    v_exp_f32 v230, v230 clamp
    v_max_f32 v134, s70, v134
    v_exp_f32 v231, v231 clamp
    v_max_f32 v135, s70, v135
    v_add_f32 v128, v128, v224
    v_add_f32 v129, v129, v225
    v_add_f32 v130, v130, v226
    v_add_f32 v131, v131, v227
    v_add_f32 v132, v132, v228
    v_add_f32 v133, v133, v229
    v_add_f32 v134, v134, v230
    v_add_f32 v135, v135, v231
    v_cvt_pk_bf16_f32 v48, v128, v129
    v_cvt_pk_bf16_f32 v49, v130, v131
    v_cvt_pk_bf16_f32 v50, v132, v133
    v_cvt_pk_bf16_f32 v51, v134, v135
    v_fma_f32 v144, -v192, v32, v144
    v_fma_f32 v145, -v194, v32, v145
    v_fma_f32 v146, -v196, v32, v146
    v_fma_f32 v147, -v198, v32, v147
    v_fma_f32 v148, -v200, v32, v148
    v_fma_f32 v149, -v202, v32, v149
    v_fma_f32 v150, -v204, v32, v150
    v_fma_f32 v151, -v206, v32, v151
    v_mul_f32 v144, v144, v193
    v_mul_f32 v145, v145, v195
    v_mul_f32 v146, v146, v197
    v_mul_f32 v147, v147, v199
    v_mul_f32 v148, v148, v201
    v_mul_f32 v149, v149, v203
    v_mul_f32 v150, v150, v205
    v_mul_f32 v151, v151, v207
    v_cvt_pk_bf16_f32 v56, v144, v145
    v_cvt_pk_bf16_f32 v57, v146, v147
    v_cvt_pk_bf16_f32 v58, v148, v149
    v_cvt_pk_bf16_f32 v59, v150, v151
    v_fma_f32 v160, -v192, v33, v160
    v_fma_f32 v161, -v194, v33, v161
    v_fma_f32 v162, -v196, v33, v162
    v_fma_f32 v163, -v198, v33, v163
    v_fma_f32 v164, -v200, v33, v164
    v_fma_f32 v165, -v202, v33, v165
    v_fma_f32 v166, -v204, v33, v166
    v_fma_f32 v167, -v206, v33, v167
    v_mul_f32 v160, v160, v193
    v_mul_f32 v161, v161, v195
    v_mul_f32 v162, v162, v197
    v_mul_f32 v163, v163, v199
    v_mul_f32 v164, v164, v201
    v_mul_f32 v165, v165, v203
    v_mul_f32 v166, v166, v205
    v_mul_f32 v167, v167, v207
    v_cvt_pk_bf16_f32 v64, v160, v161
    v_cvt_pk_bf16_f32 v65, v162, v163
    v_cvt_pk_bf16_f32 v66, v164, v165
    v_cvt_pk_bf16_f32 v67, v166, v167
    v_fma_f32 v176, -v192, v34, v176
    v_fma_f32 v177, -v194, v34, v177
    v_fma_f32 v178, -v196, v34, v178
    v_fma_f32 v179, -v198, v34, v179
    v_fma_f32 v180, -v200, v34, v180
    v_fma_f32 v181, -v202, v34, v181
    v_fma_f32 v182, -v204, v34, v182
    v_fma_f32 v183, -v206, v34, v183
    v_mul_f32 v176, v176, v193
    v_mul_f32 v177, v177, v195
    v_mul_f32 v178, v178, v197
    v_mul_f32 v179, v179, v199
    v_mul_f32 v180, v180, v201
    v_mul_f32 v181, v181, v203
    v_mul_f32 v182, v182, v205
    v_mul_f32 v183, v183, v207
    v_fma_f32 v224, v176, s69, v29
    v_fma_f32 v225, v177, s69, v29
    v_fma_f32 v226, v178, s69, v29
    v_fma_f32 v227, v179, s69, v29
    v_fma_f32 v228, v180, s69, v29
    v_fma_f32 v229, v181, s69, v29
    v_fma_f32 v230, v182, s69, v29
    v_fma_f32 v231, v183, s69, v29
    v_exp_f32 v224, v224 clamp
    v_max_f32 v176, v28, v176
    v_exp_f32 v225, v225 clamp
    v_max_f32 v177, v28, v177
    v_exp_f32 v226, v226 clamp
    v_max_f32 v178, v28, v178
    v_exp_f32 v227, v227 clamp
    v_max_f32 v179, v28, v179
    v_exp_f32 v228, v228 clamp
    v_max_f32 v180, v28, v180
    v_exp_f32 v229, v229 clamp
    v_max_f32 v181, v28, v181
    v_exp_f32 v230, v230 clamp
    v_max_f32 v182, v28, v182
    v_exp_f32 v231, v231 clamp
    v_max_f32 v183, v28, v183
    v_add_f32 v176, v176, v224
    v_add_f32 v177, v177, v225
    v_add_f32 v178, v178, v226
    v_add_f32 v179, v179, v227
    v_add_f32 v180, v180, v228
    v_add_f32 v181, v181, v229
    v_add_f32 v182, v182, v230
    v_add_f32 v183, v183, v231
    v_cvt_pk_bf16_f32 v72, v176, v177
    v_cvt_pk_bf16_f32 v73, v178, v179
    v_cvt_pk_bf16_f32 v74, v180, v181
    v_cvt_pk_bf16_f32 v75, v182, v183
    v_cndmask_b32 v80, v72, v27, s[64:65]
    v_cndmask_b32 v81, v73, v27, s[64:65]
    v_cndmask_b32 v82, v74, v27, s[64:65]
    v_cndmask_b32 v83, v75, v27, s[64:65]
    s_nop 1
    v_mfma_f32_16x16x32_bf16 v[88:91], v[80:83], v[40:43], 0
    v_mfma_f32_16x16x32_bf16 v[92:95], v[56:59], v[40:43], 0
    v_mfma_f32_16x16x32_bf16 v[96:99], v[80:83], v[48:51], 0
    v_mfma_f32_16x16x32_bf16 v[100:103], v[56:59], v[48:51], 0
    v_mfma_f32_16x16x32_bf16 v[104:107], v[64:67], v[48:51], 0
    v_mfma_f32_16x16x32_bf16 v[108:111], v[56:59], v[72:75], 0
    v_mfma_f32_16x16x32_bf16 v[112:115], v[64:67], v[72:75], 0
    v_mfma_f32_16x16x32_bf16 v[116:119], v[80:83], v[72:75], 0
    v_fma_f32 v120, -v208, v30, v120
    v_fma_f32 v121, -v210, v30, v121
    v_fma_f32 v122, -v212, v30, v122
    v_fma_f32 v123, -v214, v30, v123
    v_fma_f32 v124, -v216, v30, v124
    v_fma_f32 v125, -v218, v30, v125
    v_fma_f32 v126, -v220, v30, v126
    v_fma_f32 v127, -v222, v30, v127
    v_mul_f32 v120, v120, v209
    v_mul_f32 v121, v121, v211
    v_mul_f32 v122, v122, v213
    v_mul_f32 v123, v123, v215
    v_mul_f32 v124, v124, v217
    v_mul_f32 v125, v125, v219
    v_mul_f32 v126, v126, v221
    v_mul_f32 v127, v127, v223
    v_mul_f32 v224, s69, v120
    v_mul_f32 v225, s69, v121
    v_mul_f32 v226, s69, v122
    v_mul_f32 v227, s69, v123
    v_mul_f32 v228, s69, v124
    v_mul_f32 v229, s69, v125
    v_mul_f32 v230, s69, v126
    v_mul_f32 v231, s69, v127
    v_exp_f32 v224, v224 clamp
    v_max_f32 v120, s70, v120
    v_exp_f32 v225, v225 clamp
    v_max_f32 v121, s70, v121
    v_exp_f32 v226, v226 clamp
    v_max_f32 v122, s70, v122
    v_exp_f32 v227, v227 clamp
    v_max_f32 v123, s70, v123
    v_exp_f32 v228, v228 clamp
    v_max_f32 v124, s70, v124
    v_exp_f32 v229, v229 clamp
    v_max_f32 v125, s70, v125
    v_exp_f32 v230, v230 clamp
    v_max_f32 v126, s70, v126
    v_exp_f32 v231, v231 clamp
    v_max_f32 v127, s70, v127
    v_add_f32 v120, v120, v224
    v_add_f32 v121, v121, v225
    v_add_f32 v122, v122, v226
    v_add_f32 v123, v123, v227
    v_add_f32 v124, v124, v228
    v_add_f32 v125, v125, v229
    v_add_f32 v126, v126, v230
    v_add_f32 v127, v127, v231
    v_cvt_pk_bf16_f32 v44, v120, v121
    v_cvt_pk_bf16_f32 v45, v122, v123
    v_cvt_pk_bf16_f32 v46, v124, v125
    v_cvt_pk_bf16_f32 v47, v126, v127
    v_fma_f32 v136, -v208, v31, v136
    v_fma_f32 v137, -v210, v31, v137
    v_fma_f32 v138, -v212, v31, v138
    v_fma_f32 v139, -v214, v31, v139
    v_fma_f32 v140, -v216, v31, v140
    v_fma_f32 v141, -v218, v31, v141
    v_fma_f32 v142, -v220, v31, v142
    v_fma_f32 v143, -v222, v31, v143
    v_mul_f32 v136, v136, v209
    v_mul_f32 v137, v137, v211
    v_mul_f32 v138, v138, v213
    v_mul_f32 v139, v139, v215
    v_mul_f32 v140, v140, v217
    v_mul_f32 v141, v141, v219
    v_mul_f32 v142, v142, v221
    v_mul_f32 v143, v143, v223
    v_mul_f32 v224, s69, v136
    v_mul_f32 v225, s69, v137
    v_mul_f32 v226, s69, v138
    v_mul_f32 v227, s69, v139
    v_mul_f32 v228, s69, v140
    v_mul_f32 v229, s69, v141
    v_mul_f32 v230, s69, v142
    v_mul_f32 v231, s69, v143
    v_exp_f32 v224, v224 clamp
    v_max_f32 v136, s70, v136
    v_exp_f32 v225, v225 clamp
    v_max_f32 v137, s70, v137
    v_exp_f32 v226, v226 clamp
    v_max_f32 v138, s70, v138
    v_exp_f32 v227, v227 clamp
    v_max_f32 v139, s70, v139
    v_exp_f32 v228, v228 clamp
    v_max_f32 v140, s70, v140
    v_exp_f32 v229, v229 clamp
    v_max_f32 v141, s70, v141
    v_exp_f32 v230, v230 clamp
    v_max_f32 v142, s70, v142
    v_exp_f32 v231, v231 clamp
    v_max_f32 v143, s70, v143
    v_add_f32 v136, v136, v224
    v_add_f32 v137, v137, v225
    v_add_f32 v138, v138, v226
    v_add_f32 v139, v139, v227
    v_add_f32 v140, v140, v228
    v_add_f32 v141, v141, v229
    v_add_f32 v142, v142, v230
    v_add_f32 v143, v143, v231
    v_cvt_pk_bf16_f32 v52, v136, v137
    v_cvt_pk_bf16_f32 v53, v138, v139
    v_cvt_pk_bf16_f32 v54, v140, v141
    v_cvt_pk_bf16_f32 v55, v142, v143
    v_fma_f32 v152, -v208, v32, v152
    v_fma_f32 v153, -v210, v32, v153
    v_fma_f32 v154, -v212, v32, v154
    v_fma_f32 v155, -v214, v32, v155
    v_fma_f32 v156, -v216, v32, v156
    v_fma_f32 v157, -v218, v32, v157
    v_fma_f32 v158, -v220, v32, v158
    v_fma_f32 v159, -v222, v32, v159
    v_mul_f32 v152, v152, v209
    v_mul_f32 v153, v153, v211
    v_mul_f32 v154, v154, v213
    v_mul_f32 v155, v155, v215
    v_mul_f32 v156, v156, v217
    v_mul_f32 v157, v157, v219
    v_mul_f32 v158, v158, v221
    v_mul_f32 v159, v159, v223
    v_cvt_pk_bf16_f32 v60, v152, v153
    v_cvt_pk_bf16_f32 v61, v154, v155
    v_cvt_pk_bf16_f32 v62, v156, v157
    v_cvt_pk_bf16_f32 v63, v158, v159
    v_fma_f32 v168, -v208, v33, v168
    v_fma_f32 v169, -v210, v33, v169
    v_fma_f32 v170, -v212, v33, v170
    v_fma_f32 v171, -v214, v33, v171
    v_fma_f32 v172, -v216, v33, v172
    v_fma_f32 v173, -v218, v33, v173
    v_fma_f32 v174, -v220, v33, v174
    v_fma_f32 v175, -v222, v33, v175
    v_mul_f32 v168, v168, v209
    v_mul_f32 v169, v169, v211
    v_mul_f32 v170, v170, v213
    v_mul_f32 v171, v171, v215
    v_mul_f32 v172, v172, v217
    v_mul_f32 v173, v173, v219
    v_mul_f32 v174, v174, v221
    v_mul_f32 v175, v175, v223
    v_cvt_pk_bf16_f32 v68, v168, v169
    v_cvt_pk_bf16_f32 v69, v170, v171
    v_cvt_pk_bf16_f32 v70, v172, v173
    v_cvt_pk_bf16_f32 v71, v174, v175
    v_fma_f32 v184, -v208, v34, v184
    v_fma_f32 v185, -v210, v34, v185
    v_fma_f32 v186, -v212, v34, v186
    v_fma_f32 v187, -v214, v34, v187
    v_fma_f32 v188, -v216, v34, v188
    v_fma_f32 v189, -v218, v34, v189
    v_fma_f32 v190, -v220, v34, v190
    v_fma_f32 v191, -v222, v34, v191
    v_mul_f32 v184, v184, v209
    v_mul_f32 v185, v185, v211
    v_mul_f32 v186, v186, v213
    v_mul_f32 v187, v187, v215
    v_mul_f32 v188, v188, v217
    v_mul_f32 v189, v189, v219
    v_mul_f32 v190, v190, v221
    v_mul_f32 v191, v191, v223
    v_fma_f32 v224, v184, s69, v29
    v_fma_f32 v225, v185, s69, v29
    v_fma_f32 v226, v186, s69, v29
    v_fma_f32 v227, v187, s69, v29
    v_fma_f32 v228, v188, s69, v29
    v_fma_f32 v229, v189, s69, v29
    v_fma_f32 v230, v190, s69, v29
    v_fma_f32 v231, v191, s69, v29
    v_exp_f32 v224, v224 clamp
    v_max_f32 v184, v28, v184
    v_exp_f32 v225, v225 clamp
    v_max_f32 v185, v28, v185
    v_exp_f32 v226, v226 clamp
    v_max_f32 v186, v28, v186
    v_exp_f32 v227, v227 clamp
    v_max_f32 v187, v28, v187
    v_exp_f32 v228, v228 clamp
    v_max_f32 v188, v28, v188
    v_exp_f32 v229, v229 clamp
    v_max_f32 v189, v28, v189
    v_exp_f32 v230, v230 clamp
    v_max_f32 v190, v28, v190
    v_exp_f32 v231, v231 clamp
    v_max_f32 v191, v28, v191
    v_add_f32 v184, v184, v224
    v_add_f32 v185, v185, v225
    v_add_f32 v186, v186, v226
    v_add_f32 v187, v187, v227
    v_add_f32 v188, v188, v228
    v_add_f32 v189, v189, v229
    v_add_f32 v190, v190, v230
    v_add_f32 v191, v191, v231
    v_cvt_pk_bf16_f32 v76, v184, v185
    v_cvt_pk_bf16_f32 v77, v186, v187
    v_cvt_pk_bf16_f32 v78, v188, v189
    v_cvt_pk_bf16_f32 v79, v190, v191
    v_cndmask_b32 v84, v76, v27, s[64:65]
    v_cndmask_b32 v85, v77, v27, s[64:65]
    v_cndmask_b32 v86, v78, v27, s[64:65]
    v_cndmask_b32 v87, v79, v27, s[64:65]
    s_nop 1
    v_mfma_f32_16x16x32_bf16 v[88:91], v[84:87], v[44:47], v[88:91]
    v_mfma_f32_16x16x32_bf16 v[92:95], v[60:63], v[44:47], v[92:95]
    v_mfma_f32_16x16x32_bf16 v[96:99], v[84:87], v[52:55], v[96:99]
    v_mfma_f32_16x16x32_bf16 v[100:103], v[60:63], v[52:55], v[100:103]
    v_mfma_f32_16x16x32_bf16 v[104:107], v[68:71], v[52:55], v[104:107]
    v_mfma_f32_16x16x32_bf16 v[108:111], v[60:63], v[76:79], v[108:111]
    v_mfma_f32_16x16x32_bf16 v[112:115], v[68:71], v[76:79], v[112:115]
    v_mfma_f32_16x16x32_bf16 v[116:119], v[84:87], v[76:79], v[116:119]
    v_lshlrev_b32 v224, 2, v0
    s_mul_i32 s57, s49, 13440
    s_add_u32 s57, s57, 11698176
    v_cmp_gt_u32 vcc, 288, v0
    ds_write_b32 v250, v88
    ds_write_b32 v234, v89 offset:80
    ds_write_b32 v234, v90 offset:160
    ds_write_b32 v234, v91 offset:240
    ds_write_b32 v235, v92
    ds_write_b32 v235, v93 offset:80
    ds_write_b32 v235, v94 offset:160
    ds_write_b32 v235, v95 offset:240
    ds_write_b32 v251, v96
    ds_write_b32 v236, v97 offset:80
    ds_write_b32 v236, v98 offset:160
    ds_write_b32 v236, v99 offset:240
    ds_write_b32 v237, v100
    ds_write_b32 v237, v101 offset:80
    ds_write_b32 v237, v102 offset:160
    ds_write_b32 v237, v103 offset:240
    ds_write_b32 v242, v104
    ds_write_b32 v242, v105 offset:80
    ds_write_b32 v242, v106 offset:160
    ds_write_b32 v242, v107 offset:240
    ds_write_b32 v243, v108
    ds_write_b32 v243, v109 offset:80
    ds_write_b32 v243, v110 offset:160
    ds_write_b32 v243, v111 offset:240
    ds_write_b32 v248, v112
    ds_write_b32 v248, v113 offset:80
    ds_write_b32 v248, v114 offset:160
    ds_write_b32 v248, v115 offset:240
    ds_write_b32 v252, v116
    ds_write_b32 v249, v117 offset:80
    ds_write_b32 v249, v118 offset:160
    ds_write_b32 v249, v119 offset:240
    s_waitcnt lgkmcnt(0)
    s_barrier
    ds_read_b32 v40, v224 offset:0
    ds_read_b32 v48, v224 offset:13440
    ds_read_b32 v41, v224 offset:2048
    ds_read_b32 v49, v224 offset:15488
    ds_read_b32 v42, v224 offset:4096
    ds_read_b32 v50, v224 offset:17536
    ds_read_b32 v43, v224 offset:6144
    ds_read_b32 v51, v224 offset:19584
    ds_read_b32 v44, v224 offset:8192
    ds_read_b32 v52, v224 offset:21632
    ds_read_b32 v45, v224 offset:10240
    ds_read_b32 v53, v224 offset:23680
    ds_read_b32 v46, v224 offset:12288
    ds_read_b32 v54, v224 offset:25728
    s_waitcnt lgkmcnt(12)
    v_add_f32 v40, v40, v48
    buffer_atomic_add_f32 v40, v224, s[40:43], s57 offen
    s_add_u32 s57, s57, 2048
    s_waitcnt lgkmcnt(10)
    v_add_f32 v41, v41, v49
    buffer_atomic_add_f32 v41, v224, s[40:43], s57 offen
    s_add_u32 s57, s57, 2048
    s_waitcnt lgkmcnt(8)
    v_add_f32 v42, v42, v50
    buffer_atomic_add_f32 v42, v224, s[40:43], s57 offen
    s_add_u32 s57, s57, 2048
    s_waitcnt lgkmcnt(6)
    v_add_f32 v43, v43, v51
    buffer_atomic_add_f32 v43, v224, s[40:43], s57 offen
    s_add_u32 s57, s57, 2048
    s_waitcnt lgkmcnt(4)
    v_add_f32 v44, v44, v52
    buffer_atomic_add_f32 v44, v224, s[40:43], s57 offen
    s_add_u32 s57, s57, 2048
    s_waitcnt lgkmcnt(2)
    v_add_f32 v45, v45, v53
    buffer_atomic_add_f32 v45, v224, s[40:43], s57 offen
    s_add_u32 s57, s57, 2048
    s_waitcnt lgkmcnt(0)
    v_add_f32 v46, v46, v54
    s_and_saveexec_b64 s[62:63], vcc
    s_cbranch_execz P1_KV_ATM_DONE
    buffer_atomic_add_f32 v46, v224, s[40:43], s57 offen
    s_add_u32 s57, s57, 2048
P1_KV_ATM_DONE:
    s_mov_b64 exec, -1
    s_lshl_b32 s71, s49, 7
    s_lshl_b32 s70, s48, 3
    s_add_u32 s71, s71, s70
    s_add_u32 s71, s71, 13093888
    s_mov_b32 s70, 0xff
P2_START:
    s_nop 4
    s_and_b32 s56, s2, 7
    s_lshr_b32 s57, s2, 3
    s_lshr_b32 s32, s56, 1
    s_lshl_b32 s32, s32, 3
    s_and_b32 s58, s57, 7
    s_add_u32 s32, s32, s58
    s_and_b32 s33, s56, 1
    s_lshl_b32 s33, s33, 2
    s_lshr_b32 s58, s57, 3
    s_add_u32 s33, s33, s58
    v_lshlrev_b32 v4, 4, v1
    v_lshlrev_b32 v9, 3, v1
    s_and_b32 s34, s50, 3
    s_mul_i32 s61, s34, 3
    s_mul_i32 s62, s34, 5
    s_lshr_b32 s62, s62, 1
    s_cmp_ge_u32 s50, 4
    s_cselect_b32 s61, s62, s61
    s_lshl_b32 s61, s61, 5
    s_lshl_b32 s62, s32, 9
    s_add_u32 s61, s61, s62
    s_add_u32 s61, s61, 13074432
    s_lshl_b32 s62, s56, 2
    s_add_u32 s62, s62, s34
    s_lshl_b32 s62, s62, 7
    s_add_u32 s62, s62, 13093888
    s_mov_b32 s48, s92
    s_mov_b32 s49, s93
    v_mov_b32 v12, s92
    v_mov_b32 v13, s93
    v_lshlrev_b32 v11, 9, v1
    v_mov_b32 v14, 0
    v_lshlrev_b32 v10, 2, v2
    v_add_u32 v10, 159744, v10
    ds_write_b32 v10, v14
    s_lshl_b32 s56, s34, 2
    s_add_u32 s56, s56, 159744
    v_mov_b32 v10, s56
    v_mov_b32 v14, 1
    s_waitcnt lgkmcnt(0)
    s_cmp_ge_u32 s50, 4
    s_cbranch_scc1 P2_S
    s_mul_i32 s56, s33, 48
    s_mul_i32 s57, s34, 12
    s_add_u32 s56, s56, s57
    s_mul_i32 s56, s56, 5120
    s_add_u32 s52, s56, 8912896
    v_add_u32 v5, 4096, v4
    s_waitcnt vmcnt(0)
    s_cmp_lg_u32 s70, 0
    s_cbranch_scc1 P2_KVFD
    s_mov_b64 exec, 1
    buffer_store_dwordx2 v[12:13], v11, s[40:43], s71 offen sc0 sc1
    s_mov_b64 exec, -1
    s_barrier
    s_branch P2_FDD
P2_KVFD:
    s_barrier
    s_cmp_lg_u32 s50, 0
    s_cbranch_scc1 P2_FDD
    s_mov_b64 exec, 0xff
    buffer_store_dwordx2 v[12:13], v11, s[40:43], s71 offen sc0 sc1
    s_mov_b64 exec, -1
P2_FDD:
    v_add_u32 v6, 8192, v4
    s_lshl_b32 s56, s32, 2
    s_add_u32 s56, s56, 0
    s_mul_i32 s57, s56, 48
    s_mul_i32 s58, s34, 12
    s_add_u32 s57, s57, s58
    s_lshl_b32 s36, s57, 10
    s_lshl_b32 s56, s32, 2
    s_add_u32 s56, s56, 1
    s_mul_i32 s57, s56, 48
    s_mul_i32 s58, s34, 12
    s_add_u32 s57, s57, s58
    s_lshl_b32 s37, s57, 10
    s_lshl_b32 s56, s32, 2
    s_add_u32 s56, s56, 2
    s_mul_i32 s57, s56, 48
    s_mul_i32 s58, s34, 12
    s_add_u32 s57, s57, s58
    s_lshl_b32 s38, s57, 10
    s_lshl_b32 s56, s32, 2
    s_add_u32 s56, s56, 3
    s_mul_i32 s57, s56, 48
    s_mul_i32 s58, s34, 12
    s_add_u32 s57, s57, s58
    s_lshl_b32 s39, s57, 10
    s_mul_i32 s56, s34, 20480
    s_add_u32 s56, s56, 77824
    v_add_u32 v7, s56, v4
    s_mov_b64 exec, 0xfff
    buffer_load_dwordx2 v[16:17], v9, s[40:43], s61 offen sc0 sc1
    s_mov_b64 exec, -1
    v_mov_b32 v160, 0
    v_mov_b32 v161, 0
    v_mov_b32 v162, 0
    v_mov_b32 v163, 0
    v_mov_b32 v164, 0
    v_mov_b32 v165, 0
    v_mov_b32 v166, 0
    v_mov_b32 v167, 0
    v_mov_b32 v168, 0
    v_mov_b32 v169, 0
    v_mov_b32 v170, 0
    v_mov_b32 v171, 0
    v_mov_b32 v172, 0
    v_mov_b32 v173, 0
    v_mov_b32 v174, 0
    v_mov_b32 v175, 0
    v_mov_b32 v176, 0
    v_mov_b32 v177, 0
    v_mov_b32 v178, 0
    v_mov_b32 v179, 0
    v_mov_b32 v180, 0
    v_mov_b32 v181, 0
    v_mov_b32 v182, 0
    v_mov_b32 v183, 0
    v_mov_b32 v184, 0
    v_mov_b32 v185, 0
    v_mov_b32 v186, 0
    v_mov_b32 v187, 0
    v_mov_b32 v188, 0
    v_mov_b32 v189, 0
    v_mov_b32 v190, 0
    v_mov_b32 v191, 0
    v_mov_b32 v192, 0
    v_mov_b32 v193, 0
    v_mov_b32 v194, 0
    v_mov_b32 v195, 0
    v_mov_b32 v196, 0
    v_mov_b32 v197, 0
    v_mov_b32 v198, 0
    v_mov_b32 v199, 0
    v_mov_b32 v200, 0
    v_mov_b32 v201, 0
    v_mov_b32 v202, 0
    v_mov_b32 v203, 0
    v_mov_b32 v204, 0
    v_mov_b32 v205, 0
    v_mov_b32 v206, 0
    v_mov_b32 v207, 0
    v_mov_b32 v208, 0
    v_mov_b32 v209, 0
    v_mov_b32 v210, 0
    v_mov_b32 v211, 0
    v_mov_b32 v212, 0
    v_mov_b32 v213, 0
    v_mov_b32 v214, 0
    v_mov_b32 v215, 0
    v_mov_b32 v216, 0
    v_mov_b32 v217, 0
    v_mov_b32 v218, 0
    v_mov_b32 v219, 0
    v_mov_b32 v220, 0
    v_mov_b32 v221, 0
    v_mov_b32 v222, 0
    v_mov_b32 v223, 0
    v_mov_b32 v224, 0
    v_mov_b32 v225, 0
    v_mov_b32 v226, 0
    v_mov_b32 v227, 0
    v_mov_b32 v228, 0
    v_mov_b32 v229, 0
    v_mov_b32 v230, 0
    v_mov_b32 v231, 0
    v_mov_b32 v232, 0
    v_mov_b32 v233, 0
    v_mov_b32 v234, 0
    v_mov_b32 v235, 0
    v_mov_b32 v236, 0
    v_mov_b32 v237, 0
    v_mov_b32 v238, 0
    v_mov_b32 v239, 0
    s_mov_b32 s60, 0
    s_waitcnt vmcnt(0)
    s_mov_b64 exec, 0xfff
    v_cmp_ne_u64 vcc, s[48:49], v[16:17]
    s_mov_b64 exec, -1
    s_nop 0
    s_cmp_eq_u64 vcc, 0
    s_cbranch_scc1 P2_D_FAST
    s_add_u32 s57, s52, 20480
    buffer_load_dwordx4 v[20:23], v4, s[40:43], s57 offen offset:0 sc0 sc1
    s_add_u32 s57, s52, 20480
    buffer_load_dwordx4 v[24:27], v4, s[40:43], s57 offen offset:1024 sc0 sc1
    s_add_u32 s57, s52, 20480
    buffer_load_dwordx4 v[28:31], v4, s[40:43], s57 offen offset:2048 sc0 sc1
    s_add_u32 s57, s52, 20480
    buffer_load_dwordx4 v[32:35], v4, s[40:43], s57 offen offset:3072 sc0 sc1
    s_add_u32 s57, s52, 24576
    buffer_load_dwordx4 v[36:39], v4, s[40:43], s57 offen offset:0 sc0 sc1
    s_mov_b32 s60, 1
    s_mov_b64 exec, 0xfff
    buffer_load_dwordx2 v[16:17], v9, s[40:43], s61 offen sc0 sc1
    s_mov_b64 exec, -1
    s_waitcnt vmcnt(0)
    s_mov_b64 exec, 0xfff
    v_cmp_ne_u64 vcc, s[48:49], v[16:17]
    s_mov_b64 exec, -1
    s_nop 0
    s_cmp_eq_u64 vcc, 0
    s_cbranch_scc1 P2_D_FAST
    s_add_u32 s57, s52, 24576
    buffer_load_dwordx4 v[40:43], v4, s[40:43], s57 offen offset:1024 sc0 sc1
    s_add_u32 s57, s52, 24576
    buffer_load_dwordx4 v[44:47], v4, s[40:43], s57 offen offset:2048 sc0 sc1
    s_add_u32 s57, s52, 24576
    buffer_load_dwordx4 v[48:51], v4, s[40:43], s57 offen offset:3072 sc0 sc1
    s_add_u32 s57, s52, 28672
    buffer_load_dwordx4 v[52:55], v4, s[40:43], s57 offen offset:0 sc0 sc1
    s_add_u32 s57, s52, 28672
    buffer_load_dwordx4 v[56:59], v4, s[40:43], s57 offen offset:1024 sc0 sc1
    s_mov_b32 s60, 2
    s_mov_b64 exec, 0xfff
    buffer_load_dwordx2 v[16:17], v9, s[40:43], s61 offen sc0 sc1
    s_mov_b64 exec, -1
    s_waitcnt vmcnt(0)
    s_mov_b64 exec, 0xfff
    v_cmp_ne_u64 vcc, s[48:49], v[16:17]
    s_mov_b64 exec, -1
    s_nop 0
    s_cmp_eq_u64 vcc, 0
    s_cbranch_scc1 P2_D_FAST
    s_add_u32 s57, s52, 28672
    buffer_load_dwordx4 v[60:63], v4, s[40:43], s57 offen offset:2048 sc0 sc1
    s_add_u32 s57, s52, 28672
    buffer_load_dwordx4 v[64:67], v4, s[40:43], s57 offen offset:3072 sc0 sc1
    s_add_u32 s57, s52, 32768
    buffer_load_dwordx4 v[68:71], v4, s[40:43], s57 offen offset:0 sc0 sc1
    s_add_u32 s57, s52, 32768
    buffer_load_dwordx4 v[72:75], v4, s[40:43], s57 offen offset:1024 sc0 sc1
    s_add_u32 s57, s52, 32768
    buffer_load_dwordx4 v[76:79], v4, s[40:43], s57 offen offset:2048 sc0 sc1
    s_mov_b32 s60, 3
    s_mov_b64 exec, 4095
    s_branch P2_POLLHD_l
P2_POLLHD:
    s_add_u32 s3, s3, 1
    s_cmp_gt_u32 s3, 0x200000
    s_cbranch_scc1 K_END
    s_sleep 6
P2_POLLHD_l:
    buffer_load_dwordx2 v[16:17], v9, s[40:43], s61 offen sc0 sc1
P2_POLLHD_w:
    s_waitcnt vmcnt(0)
    v_cmp_ne_u64 vcc, s[48:49], v[16:17]
    s_nop 1
    s_cmp_lg_u64 vcc, 0
    s_cbranch_scc1 P2_POLLHD
    s_mov_b64 exec, -1
P2_D_FAST:
    buffer_load_dwordx4 v[80:83], v4, s[40:43], s36 offen offset:0 sc0 sc1
    buffer_load_dwordx4 v[84:87], v4, s[40:43], s37 offen offset:0 sc0 sc1
    buffer_load_dwordx4 v[88:91], v4, s[40:43], s38 offen offset:0 sc0 sc1
    buffer_load_dwordx4 v[92:95], v4, s[40:43], s39 offen offset:0 sc0 sc1
    buffer_load_dwordx4 v[96:99], v4, s[40:43], s36 offen offset:1024 sc0 sc1
    buffer_load_dwordx4 v[100:103], v4, s[40:43], s37 offen offset:1024 sc0 sc1
    buffer_load_dwordx4 v[104:107], v4, s[40:43], s38 offen offset:1024 sc0 sc1
    buffer_load_dwordx4 v[108:111], v4, s[40:43], s39 offen offset:1024 sc0 sc1
    buffer_load_dwordx4 v[112:115], v4, s[40:43], s36 offen offset:2048 sc0 sc1
    buffer_load_dwordx4 v[116:119], v4, s[40:43], s37 offen offset:2048 sc0 sc1
    buffer_load_dwordx4 v[120:123], v4, s[40:43], s38 offen offset:2048 sc0 sc1
    buffer_load_dwordx4 v[124:127], v4, s[40:43], s39 offen offset:2048 sc0 sc1
    ds_read_b128 v[244:247], v7 offset:0
    ds_read_b128 v[248:251], v7 offset:1024
    s_waitcnt vmcnt(8)
    ds_read_b128 v[252:255], v7 offset:2048
    s_waitcnt lgkmcnt(2)
    v_mfma_f32_16x16x32_bf16 v[160:163], v[244:247], v[80:83], v[160:163]
    v_mfma_f32_16x16x32_bf16 v[180:183], v[244:247], v[84:87], v[180:183]
    v_mfma_f32_16x16x32_bf16 v[200:203], v[244:247], v[88:91], v[200:203]
    v_mfma_f32_16x16x32_bf16 v[220:223], v[244:247], v[92:95], v[220:223]
    buffer_load_dwordx4 v[128:131], v4, s[40:43], s36 offen offset:3072 sc0 sc1
    buffer_load_dwordx4 v[132:135], v4, s[40:43], s37 offen offset:3072 sc0 sc1
    ds_read_b128 v[244:247], v7 offset:3072
    s_waitcnt lgkmcnt(2)
    v_mfma_f32_16x16x32_bf16 v[164:167], v[248:251], v[80:83], v[164:167]
    v_mfma_f32_16x16x32_bf16 v[184:187], v[248:251], v[84:87], v[184:187]
    v_mfma_f32_16x16x32_bf16 v[204:207], v[248:251], v[88:91], v[204:207]
    v_mfma_f32_16x16x32_bf16 v[224:227], v[248:251], v[92:95], v[224:227]
    buffer_load_dwordx4 v[136:139], v4, s[40:43], s38 offen offset:3072 sc0 sc1
    buffer_load_dwordx4 v[140:143], v4, s[40:43], s39 offen offset:3072 sc0 sc1
    ds_read_b128 v[248:251], v7 offset:4096
    s_waitcnt lgkmcnt(2)
    v_mfma_f32_16x16x32_bf16 v[168:171], v[252:255], v[80:83], v[168:171]
    v_mfma_f32_16x16x32_bf16 v[188:191], v[252:255], v[84:87], v[188:191]
    v_mfma_f32_16x16x32_bf16 v[208:211], v[252:255], v[88:91], v[208:211]
    v_mfma_f32_16x16x32_bf16 v[228:231], v[252:255], v[92:95], v[228:231]
    s_cmp_gt_u32 s60, 0
    s_cbranch_scc1 P2_D_SK0
    s_add_u32 s57, s52, 20480
    buffer_load_dwordx4 v[20:23], v4, s[40:43], s57 offen offset:0 sc0 sc1
    s_add_u32 s57, s52, 20480
    buffer_load_dwordx4 v[24:27], v4, s[40:43], s57 offen offset:1024 sc0 sc1
    s_add_u32 s57, s52, 20480
    buffer_load_dwordx4 v[28:31], v4, s[40:43], s57 offen offset:2048 sc0 sc1
    s_add_u32 s57, s52, 20480
    buffer_load_dwordx4 v[32:35], v4, s[40:43], s57 offen offset:3072 sc0 sc1
    s_add_u32 s57, s52, 24576
    buffer_load_dwordx4 v[36:39], v4, s[40:43], s57 offen offset:0 sc0 sc1
P2_D_SK0:
    s_cmp_gt_u32 s60, 1
    s_cbranch_scc1 P2_D_SK1
    s_add_u32 s57, s52, 24576
    buffer_load_dwordx4 v[40:43], v4, s[40:43], s57 offen offset:1024 sc0 sc1
    s_add_u32 s57, s52, 24576
    buffer_load_dwordx4 v[44:47], v4, s[40:43], s57 offen offset:2048 sc0 sc1
    s_add_u32 s57, s52, 24576
    buffer_load_dwordx4 v[48:51], v4, s[40:43], s57 offen offset:3072 sc0 sc1
    s_add_u32 s57, s52, 28672
    buffer_load_dwordx4 v[52:55], v4, s[40:43], s57 offen offset:0 sc0 sc1
    s_add_u32 s57, s52, 28672
    buffer_load_dwordx4 v[56:59], v4, s[40:43], s57 offen offset:1024 sc0 sc1
P2_D_SK1:
    s_cmp_gt_u32 s60, 2
    s_cbranch_scc1 P2_D_SK2
    s_add_u32 s57, s52, 28672
    buffer_load_dwordx4 v[60:63], v4, s[40:43], s57 offen offset:2048 sc0 sc1
    s_add_u32 s57, s52, 28672
    buffer_load_dwordx4 v[64:67], v4, s[40:43], s57 offen offset:3072 sc0 sc1
    s_add_u32 s57, s52, 32768
    buffer_load_dwordx4 v[68:71], v4, s[40:43], s57 offen offset:0 sc0 sc1
    s_add_u32 s57, s52, 32768
    buffer_load_dwordx4 v[72:75], v4, s[40:43], s57 offen offset:1024 sc0 sc1
    s_add_u32 s57, s52, 32768
    buffer_load_dwordx4 v[76:79], v4, s[40:43], s57 offen offset:2048 sc0 sc1
P2_D_SK2:
    buffer_load_dwordx4 v[144:147], v5, s[40:43], s36 offen offset:0 sc0 sc1
    buffer_load_dwordx4 v[148:151], v5, s[40:43], s37 offen offset:0 sc0 sc1
    ds_read_b128 v[252:255], v7 offset:5120
    s_waitcnt lgkmcnt(2)
    v_mfma_f32_16x16x32_bf16 v[172:175], v[244:247], v[80:83], v[172:175]
    v_mfma_f32_16x16x32_bf16 v[192:195], v[244:247], v[84:87], v[192:195]
    v_mfma_f32_16x16x32_bf16 v[212:215], v[244:247], v[88:91], v[212:215]
    v_mfma_f32_16x16x32_bf16 v[232:235], v[244:247], v[92:95], v[232:235]
    buffer_load_dwordx4 v[152:155], v5, s[40:43], s38 offen offset:0 sc0 sc1
    buffer_load_dwordx4 v[156:159], v5, s[40:43], s39 offen offset:0 sc0 sc1
    ds_read_b128 v[244:247], v7 offset:6144
    s_waitcnt lgkmcnt(2)
    v_mfma_f32_16x16x32_bf16 v[176:179], v[248:251], v[80:83], v[176:179]
    v_mfma_f32_16x16x32_bf16 v[196:199], v[248:251], v[84:87], v[196:199]
    v_mfma_f32_16x16x32_bf16 v[216:219], v[248:251], v[88:91], v[216:219]
    v_mfma_f32_16x16x32_bf16 v[236:239], v[248:251], v[92:95], v[236:239]
    buffer_load_dwordx4 v[240:243], v5, s[40:43], s36 offen offset:1024 sc0 sc1
    buffer_load_dwordx4 v[16:19], v5, s[40:43], s37 offen offset:1024 sc0 sc1
    buffer_load_dwordx4 v[80:83], v5, s[40:43], s38 offen offset:1024 sc0 sc1
    buffer_load_dwordx4 v[84:87], v5, s[40:43], s39 offen offset:1024 sc0 sc1
    s_waitcnt vmcnt(16)
    ds_read_b128 v[248:251], v7 offset:7168
    s_waitcnt lgkmcnt(2)
    v_mfma_f32_16x16x32_bf16 v[160:163], v[252:255], v[96:99], v[160:163]
    v_mfma_f32_16x16x32_bf16 v[180:183], v[252:255], v[100:103], v[180:183]
    v_mfma_f32_16x16x32_bf16 v[200:203], v[252:255], v[104:107], v[200:203]
    v_mfma_f32_16x16x32_bf16 v[220:223], v[252:255], v[108:111], v[220:223]
    buffer_load_dwordx4 v[88:91], v5, s[40:43], s36 offen offset:2048 sc0 sc1
    buffer_load_dwordx4 v[92:95], v5, s[40:43], s37 offen offset:2048 sc0 sc1
    ds_read_b128 v[252:255], v7 offset:8192
    s_waitcnt lgkmcnt(2)
    v_mfma_f32_16x16x32_bf16 v[164:167], v[244:247], v[96:99], v[164:167]
    v_mfma_f32_16x16x32_bf16 v[184:187], v[244:247], v[100:103], v[184:187]
    v_mfma_f32_16x16x32_bf16 v[204:207], v[244:247], v[104:107], v[204:207]
    v_mfma_f32_16x16x32_bf16 v[224:227], v[244:247], v[108:111], v[224:227]
    ds_read_b128 v[244:247], v7 offset:9216
    s_waitcnt lgkmcnt(2)
    v_mfma_f32_16x16x32_bf16 v[168:171], v[248:251], v[96:99], v[168:171]
    v_mfma_f32_16x16x32_bf16 v[188:191], v[248:251], v[100:103], v[188:191]
    v_mfma_f32_16x16x32_bf16 v[208:211], v[248:251], v[104:107], v[208:211]
    v_mfma_f32_16x16x32_bf16 v[228:231], v[248:251], v[108:111], v[228:231]
    ds_read_b128 v[248:251], v7 offset:10240
    s_waitcnt lgkmcnt(2)
    v_mfma_f32_16x16x32_bf16 v[172:175], v[252:255], v[96:99], v[172:175]
    v_mfma_f32_16x16x32_bf16 v[192:195], v[252:255], v[100:103], v[192:195]
    v_mfma_f32_16x16x32_bf16 v[212:215], v[252:255], v[104:107], v[212:215]
    v_mfma_f32_16x16x32_bf16 v[232:235], v[252:255], v[108:111], v[232:235]
    ds_read_b128 v[252:255], v7 offset:11264
    s_waitcnt lgkmcnt(2)
    v_mfma_f32_16x16x32_bf16 v[176:179], v[244:247], v[96:99], v[176:179]
    v_mfma_f32_16x16x32_bf16 v[196:199], v[244:247], v[100:103], v[196:199]
    v_mfma_f32_16x16x32_bf16 v[216:219], v[244:247], v[104:107], v[216:219]
    v_mfma_f32_16x16x32_bf16 v[236:239], v[244:247], v[108:111], v[236:239]
    buffer_load_dwordx4 v[96:99], v5, s[40:43], s38 offen offset:2048 sc0 sc1
    buffer_load_dwordx4 v[100:103], v5, s[40:43], s39 offen offset:2048 sc0 sc1
    s_waitcnt vmcnt(16)
    ds_read_b128 v[244:247], v7 offset:12288
    s_waitcnt lgkmcnt(2)
    v_mfma_f32_16x16x32_bf16 v[160:163], v[248:251], v[112:115], v[160:163]
    v_mfma_f32_16x16x32_bf16 v[180:183], v[248:251], v[116:119], v[180:183]
    v_mfma_f32_16x16x32_bf16 v[200:203], v[248:251], v[120:123], v[200:203]
    v_mfma_f32_16x16x32_bf16 v[220:223], v[248:251], v[124:127], v[220:223]
    buffer_load_dwordx4 v[104:107], v5, s[40:43], s36 offen offset:3072 sc0 sc1
    buffer_load_dwordx4 v[108:111], v5, s[40:43], s37 offen offset:3072 sc0 sc1
    ds_read_b128 v[248:251], v7 offset:13312
    s_waitcnt lgkmcnt(2)
    v_mfma_f32_16x16x32_bf16 v[164:167], v[252:255], v[112:115], v[164:167]
    v_mfma_f32_16x16x32_bf16 v[184:187], v[252:255], v[116:119], v[184:187]
    v_mfma_f32_16x16x32_bf16 v[204:207], v[252:255], v[120:123], v[204:207]
    v_mfma_f32_16x16x32_bf16 v[224:227], v[252:255], v[124:127], v[224:227]
    ds_read_b128 v[252:255], v7 offset:14336
    s_waitcnt lgkmcnt(2)
    v_mfma_f32_16x16x32_bf16 v[168:171], v[244:247], v[112:115], v[168:171]
    v_mfma_f32_16x16x32_bf16 v[188:191], v[244:247], v[116:119], v[188:191]
    v_mfma_f32_16x16x32_bf16 v[208:211], v[244:247], v[120:123], v[208:211]
    v_mfma_f32_16x16x32_bf16 v[228:231], v[244:247], v[124:127], v[228:231]
    ds_read_b128 v[244:247], v7 offset:15360
    s_waitcnt lgkmcnt(2)
    v_mfma_f32_16x16x32_bf16 v[172:175], v[248:251], v[112:115], v[172:175]
    v_mfma_f32_16x16x32_bf16 v[192:195], v[248:251], v[116:119], v[192:195]
    v_mfma_f32_16x16x32_bf16 v[212:215], v[248:251], v[120:123], v[212:215]
    v_mfma_f32_16x16x32_bf16 v[232:235], v[248:251], v[124:127], v[232:235]
    ds_read_b128 v[248:251], v7 offset:16384
    s_waitcnt lgkmcnt(2)
    v_mfma_f32_16x16x32_bf16 v[176:179], v[252:255], v[112:115], v[176:179]
    v_mfma_f32_16x16x32_bf16 v[196:199], v[252:255], v[116:119], v[196:199]
    v_mfma_f32_16x16x32_bf16 v[216:219], v[252:255], v[120:123], v[216:219]
    v_mfma_f32_16x16x32_bf16 v[236:239], v[252:255], v[124:127], v[236:239]
    buffer_load_dwordx4 v[112:115], v5, s[40:43], s38 offen offset:3072 sc0 sc1
    buffer_load_dwordx4 v[116:119], v5, s[40:43], s39 offen offset:3072 sc0 sc1
    s_waitcnt vmcnt(16)
    ds_read_b128 v[252:255], v7 offset:17408
    s_waitcnt lgkmcnt(2)
    v_mfma_f32_16x16x32_bf16 v[160:163], v[244:247], v[128:131], v[160:163]
    v_mfma_f32_16x16x32_bf16 v[180:183], v[244:247], v[132:135], v[180:183]
    v_mfma_f32_16x16x32_bf16 v[200:203], v[244:247], v[136:139], v[200:203]
    v_mfma_f32_16x16x32_bf16 v[220:223], v[244:247], v[140:143], v[220:223]
    s_add_u32 s57, s52, 32768
    buffer_load_dwordx4 v[120:123], v4, s[40:43], s57 offen offset:3072 sc0 sc1
    s_add_u32 s57, s52, 36864
    buffer_load_dwordx4 v[124:127], v4, s[40:43], s57 offen offset:0 sc0 sc1
    ds_read_b128 v[244:247], v7 offset:18432
    s_waitcnt lgkmcnt(2)
    v_mfma_f32_16x16x32_bf16 v[164:167], v[248:251], v[128:131], v[164:167]
    v_mfma_f32_16x16x32_bf16 v[184:187], v[248:251], v[132:135], v[184:187]
    v_mfma_f32_16x16x32_bf16 v[204:207], v[248:251], v[136:139], v[204:207]
    v_mfma_f32_16x16x32_bf16 v[224:227], v[248:251], v[140:143], v[224:227]
    ds_read_b128 v[248:251], v7 offset:19456
    s_waitcnt lgkmcnt(2)
    v_mfma_f32_16x16x32_bf16 v[168:171], v[252:255], v[128:131], v[168:171]
    v_mfma_f32_16x16x32_bf16 v[188:191], v[252:255], v[132:135], v[188:191]
    v_mfma_f32_16x16x32_bf16 v[208:211], v[252:255], v[136:139], v[208:211]
    v_mfma_f32_16x16x32_bf16 v[228:231], v[252:255], v[140:143], v[228:231]
    s_waitcnt lgkmcnt(1)
    v_mfma_f32_16x16x32_bf16 v[172:175], v[244:247], v[128:131], v[172:175]
    v_mfma_f32_16x16x32_bf16 v[192:195], v[244:247], v[132:135], v[192:195]
    v_mfma_f32_16x16x32_bf16 v[212:215], v[244:247], v[136:139], v[212:215]
    v_mfma_f32_16x16x32_bf16 v[232:235], v[244:247], v[140:143], v[232:235]
    s_waitcnt lgkmcnt(0)
    v_mfma_f32_16x16x32_bf16 v[176:179], v[248:251], v[128:131], v[176:179]
    v_mfma_f32_16x16x32_bf16 v[196:199], v[248:251], v[132:135], v[196:199]
    v_mfma_f32_16x16x32_bf16 v[216:219], v[248:251], v[136:139], v[216:219]
    v_mfma_f32_16x16x32_bf16 v[236:239], v[248:251], v[140:143], v[236:239]
    s_add_u32 s57, s52, 36864
    buffer_load_dwordx4 v[128:131], v4, s[40:43], s57 offen offset:1024 sc0 sc1
    s_add_u32 s57, s52, 36864
    buffer_load_dwordx4 v[132:135], v4, s[40:43], s57 offen offset:2048 sc0 sc1
    ds_write_b32 v10, v14
    s_waitcnt vmcnt(16)
    v_mfma_f32_16x16x32_bf16 v[160:163], v[20:23], v[144:147], v[160:163]
    v_mfma_f32_16x16x32_bf16 v[180:183], v[20:23], v[148:151], v[180:183]
    v_mfma_f32_16x16x32_bf16 v[200:203], v[20:23], v[152:155], v[200:203]
    v_mfma_f32_16x16x32_bf16 v[220:223], v[20:23], v[156:159], v[220:223]
    s_add_u32 s57, s52, 36864
    buffer_load_dwordx4 v[136:139], v4, s[40:43], s57 offen offset:3072 sc0 sc1
    buffer_load_dwordx4 v[140:143], v6, s[40:43], s36 offen offset:0 sc0 sc1
    v_mfma_f32_16x16x32_bf16 v[164:167], v[24:27], v[144:147], v[164:167]
    v_mfma_f32_16x16x32_bf16 v[184:187], v[24:27], v[148:151], v[184:187]
    v_mfma_f32_16x16x32_bf16 v[204:207], v[24:27], v[152:155], v[204:207]
    v_mfma_f32_16x16x32_bf16 v[224:227], v[24:27], v[156:159], v[224:227]
    buffer_load_dwordx4 v[20:23], v6, s[40:43], s37 offen offset:0 sc0 sc1
    buffer_load_dwordx4 v[24:27], v6, s[40:43], s38 offen offset:0 sc0 sc1
    v_mfma_f32_16x16x32_bf16 v[168:171], v[28:31], v[144:147], v[168:171]
    v_mfma_f32_16x16x32_bf16 v[188:191], v[28:31], v[148:151], v[188:191]
    v_mfma_f32_16x16x32_bf16 v[208:211], v[28:31], v[152:155], v[208:211]
    v_mfma_f32_16x16x32_bf16 v[228:231], v[28:31], v[156:159], v[228:231]
    buffer_load_dwordx4 v[28:31], v6, s[40:43], s39 offen offset:0 sc0 sc1
    v_mfma_f32_16x16x32_bf16 v[172:175], v[32:35], v[144:147], v[172:175]
    v_mfma_f32_16x16x32_bf16 v[192:195], v[32:35], v[148:151], v[192:195]
    v_mfma_f32_16x16x32_bf16 v[212:215], v[32:35], v[152:155], v[212:215]
    v_mfma_f32_16x16x32_bf16 v[232:235], v[32:35], v[156:159], v[232:235]
    s_add_u32 s57, s52, 40960
    buffer_load_dwordx4 v[32:35], v4, s[40:43], s57 offen offset:0 sc0 sc1
    v_mfma_f32_16x16x32_bf16 v[176:179], v[36:39], v[144:147], v[176:179]
    v_mfma_f32_16x16x32_bf16 v[196:199], v[36:39], v[148:151], v[196:199]
    v_mfma_f32_16x16x32_bf16 v[216:219], v[36:39], v[152:155], v[216:219]
    v_mfma_f32_16x16x32_bf16 v[236:239], v[36:39], v[156:159], v[236:239]
    s_add_u32 s57, s52, 40960
    buffer_load_dwordx4 v[36:39], v4, s[40:43], s57 offen offset:1024 sc0 sc1
    s_add_u32 s57, s52, 40960
    buffer_load_dwordx4 v[144:147], v4, s[40:43], s57 offen offset:2048 sc0 sc1
    s_add_u32 s57, s52, 40960
    buffer_load_dwordx4 v[148:151], v4, s[40:43], s57 offen offset:3072 sc0 sc1
    s_waitcnt vmcnt(21)
    v_mfma_f32_16x16x32_bf16 v[160:163], v[40:43], v[240:243], v[160:163]
    v_mfma_f32_16x16x32_bf16 v[180:183], v[40:43], v[16:19], v[180:183]
    v_mfma_f32_16x16x32_bf16 v[200:203], v[40:43], v[80:83], v[200:203]
    v_mfma_f32_16x16x32_bf16 v[220:223], v[40:43], v[84:87], v[220:223]
    s_add_u32 s57, s52, 45056
    buffer_load_dwordx4 v[152:155], v4, s[40:43], s57 offen offset:0 sc0 sc1
    buffer_load_dwordx4 v[156:159], v6, s[40:43], s36 offen offset:1024 sc0 sc1
    v_mfma_f32_16x16x32_bf16 v[164:167], v[44:47], v[240:243], v[164:167]
    v_mfma_f32_16x16x32_bf16 v[184:187], v[44:47], v[16:19], v[184:187]
    v_mfma_f32_16x16x32_bf16 v[204:207], v[44:47], v[80:83], v[204:207]
    v_mfma_f32_16x16x32_bf16 v[224:227], v[44:47], v[84:87], v[224:227]
    buffer_load_dwordx4 v[40:43], v6, s[40:43], s37 offen offset:1024 sc0 sc1
    buffer_load_dwordx4 v[44:47], v6, s[40:43], s38 offen offset:1024 sc0 sc1
    v_mfma_f32_16x16x32_bf16 v[168:171], v[48:51], v[240:243], v[168:171]
    v_mfma_f32_16x16x32_bf16 v[188:191], v[48:51], v[16:19], v[188:191]
    v_mfma_f32_16x16x32_bf16 v[208:211], v[48:51], v[80:83], v[208:211]
    v_mfma_f32_16x16x32_bf16 v[228:231], v[48:51], v[84:87], v[228:231]
    buffer_load_dwordx4 v[48:51], v6, s[40:43], s39 offen offset:1024 sc0 sc1
    v_mfma_f32_16x16x32_bf16 v[172:175], v[52:55], v[240:243], v[172:175]
    v_mfma_f32_16x16x32_bf16 v[192:195], v[52:55], v[16:19], v[192:195]
    v_mfma_f32_16x16x32_bf16 v[212:215], v[52:55], v[80:83], v[212:215]
    v_mfma_f32_16x16x32_bf16 v[232:235], v[52:55], v[84:87], v[232:235]
    s_add_u32 s57, s52, 45056
    buffer_load_dwordx4 v[52:55], v4, s[40:43], s57 offen offset:1024 sc0 sc1
    v_mfma_f32_16x16x32_bf16 v[176:179], v[56:59], v[240:243], v[176:179]
    v_mfma_f32_16x16x32_bf16 v[196:199], v[56:59], v[16:19], v[196:199]
    v_mfma_f32_16x16x32_bf16 v[216:219], v[56:59], v[80:83], v[216:219]
    v_mfma_f32_16x16x32_bf16 v[236:239], v[56:59], v[84:87], v[236:239]
    s_add_u32 s57, s52, 45056
    buffer_load_dwordx4 v[56:59], v4, s[40:43], s57 offen offset:2048 sc0 sc1
    s_add_u32 s57, s52, 45056
    buffer_load_dwordx4 v[240:243], v4, s[40:43], s57 offen offset:3072 sc0 sc1
    s_add_u32 s57, s52, 49152
    buffer_load_dwordx4 v[16:19], v4, s[40:43], s57 offen offset:0 sc0 sc1
    s_waitcnt vmcnt(26)
    v_mfma_f32_16x16x32_bf16 v[160:163], v[60:63], v[88:91], v[160:163]
    v_mfma_f32_16x16x32_bf16 v[180:183], v[60:63], v[92:95], v[180:183]
    v_mfma_f32_16x16x32_bf16 v[200:203], v[60:63], v[96:99], v[200:203]
    v_mfma_f32_16x16x32_bf16 v[220:223], v[60:63], v[100:103], v[220:223]
    s_add_u32 s57, s52, 49152
    buffer_load_dwordx4 v[80:83], v4, s[40:43], s57 offen offset:1024 sc0 sc1
    buffer_load_dwordx4 v[84:87], v6, s[40:43], s36 offen offset:2048 sc0 sc1
    v_mfma_f32_16x16x32_bf16 v[164:167], v[64:67], v[88:91], v[164:167]
    v_mfma_f32_16x16x32_bf16 v[184:187], v[64:67], v[92:95], v[184:187]
    v_mfma_f32_16x16x32_bf16 v[204:207], v[64:67], v[96:99], v[204:207]
    v_mfma_f32_16x16x32_bf16 v[224:227], v[64:67], v[100:103], v[224:227]
    buffer_load_dwordx4 v[60:63], v6, s[40:43], s37 offen offset:2048 sc0 sc1
    buffer_load_dwordx4 v[64:67], v6, s[40:43], s38 offen offset:2048 sc0 sc1
    v_mfma_f32_16x16x32_bf16 v[168:171], v[68:71], v[88:91], v[168:171]
    v_mfma_f32_16x16x32_bf16 v[188:191], v[68:71], v[92:95], v[188:191]
    v_mfma_f32_16x16x32_bf16 v[208:211], v[68:71], v[96:99], v[208:211]
    v_mfma_f32_16x16x32_bf16 v[228:231], v[68:71], v[100:103], v[228:231]
    buffer_load_dwordx4 v[68:71], v6, s[40:43], s39 offen offset:2048 sc0 sc1
    v_mfma_f32_16x16x32_bf16 v[172:175], v[72:75], v[88:91], v[172:175]
    v_mfma_f32_16x16x32_bf16 v[192:195], v[72:75], v[92:95], v[192:195]
    v_mfma_f32_16x16x32_bf16 v[212:215], v[72:75], v[96:99], v[212:215]
    v_mfma_f32_16x16x32_bf16 v[232:235], v[72:75], v[100:103], v[232:235]
    s_add_u32 s57, s52, 49152
    buffer_load_dwordx4 v[72:75], v4, s[40:43], s57 offen offset:2048 sc0 sc1
    v_mfma_f32_16x16x32_bf16 v[176:179], v[76:79], v[88:91], v[176:179]
    v_mfma_f32_16x16x32_bf16 v[196:199], v[76:79], v[92:95], v[196:199]
    v_mfma_f32_16x16x32_bf16 v[216:219], v[76:79], v[96:99], v[216:219]
    v_mfma_f32_16x16x32_bf16 v[236:239], v[76:79], v[100:103], v[236:239]
    s_add_u32 s57, s52, 49152
    buffer_load_dwordx4 v[76:79], v4, s[40:43], s57 offen offset:3072 sc0 sc1
    s_add_u32 s57, s52, 53248
    buffer_load_dwordx4 v[88:91], v4, s[40:43], s57 offen offset:0 sc0 sc1
    s_add_u32 s57, s52, 53248
    buffer_load_dwordx4 v[92:95], v4, s[40:43], s57 offen offset:1024 sc0 sc1
    s_waitcnt vmcnt(26)
    v_mfma_f32_16x16x32_bf16 v[160:163], v[120:123], v[104:107], v[160:163]
    v_mfma_f32_16x16x32_bf16 v[180:183], v[120:123], v[108:111], v[180:183]
    v_mfma_f32_16x16x32_bf16 v[200:203], v[120:123], v[112:115], v[200:203]
    v_mfma_f32_16x16x32_bf16 v[220:223], v[120:123], v[116:119], v[220:223]
    s_add_u32 s57, s52, 53248
    buffer_load_dwordx4 v[96:99], v4, s[40:43], s57 offen offset:2048 sc0 sc1
    buffer_load_dwordx4 v[100:103], v6, s[40:43], s36 offen offset:3072 sc0 sc1
    v_mfma_f32_16x16x32_bf16 v[164:167], v[124:127], v[104:107], v[164:167]
    v_mfma_f32_16x16x32_bf16 v[184:187], v[124:127], v[108:111], v[184:187]
    v_mfma_f32_16x16x32_bf16 v[204:207], v[124:127], v[112:115], v[204:207]
    v_mfma_f32_16x16x32_bf16 v[224:227], v[124:127], v[116:119], v[224:227]
    buffer_load_dwordx4 v[120:123], v6, s[40:43], s37 offen offset:3072 sc0 sc1
    buffer_load_dwordx4 v[124:127], v6, s[40:43], s38 offen offset:3072 sc0 sc1
    v_mfma_f32_16x16x32_bf16 v[168:171], v[128:131], v[104:107], v[168:171]
    v_mfma_f32_16x16x32_bf16 v[188:191], v[128:131], v[108:111], v[188:191]
    v_mfma_f32_16x16x32_bf16 v[208:211], v[128:131], v[112:115], v[208:211]
    v_mfma_f32_16x16x32_bf16 v[228:231], v[128:131], v[116:119], v[228:231]
    buffer_load_dwordx4 v[128:131], v6, s[40:43], s39 offen offset:3072 sc0 sc1
    v_mfma_f32_16x16x32_bf16 v[172:175], v[132:135], v[104:107], v[172:175]
    v_mfma_f32_16x16x32_bf16 v[192:195], v[132:135], v[108:111], v[192:195]
    v_mfma_f32_16x16x32_bf16 v[212:215], v[132:135], v[112:115], v[212:215]
    v_mfma_f32_16x16x32_bf16 v[232:235], v[132:135], v[116:119], v[232:235]
    s_add_u32 s57, s52, 53248
    buffer_load_dwordx4 v[132:135], v4, s[40:43], s57 offen offset:3072 sc0 sc1
    v_mfma_f32_16x16x32_bf16 v[176:179], v[136:139], v[104:107], v[176:179]
    v_mfma_f32_16x16x32_bf16 v[196:199], v[136:139], v[108:111], v[196:199]
    v_mfma_f32_16x16x32_bf16 v[216:219], v[136:139], v[112:115], v[216:219]
    v_mfma_f32_16x16x32_bf16 v[236:239], v[136:139], v[116:119], v[236:239]
    s_add_u32 s57, s52, 57344
    buffer_load_dwordx4 v[136:139], v4, s[40:43], s57 offen offset:0 sc0 sc1
    s_add_u32 s57, s52, 57344
    buffer_load_dwordx4 v[104:107], v4, s[40:43], s57 offen offset:1024 sc0 sc1
    s_add_u32 s57, s52, 57344
    buffer_load_dwordx4 v[108:111], v4, s[40:43], s57 offen offset:2048 sc0 sc1
    s_waitcnt vmcnt(26)
    v_mfma_f32_16x16x32_bf16 v[160:163], v[32:35], v[140:143], v[160:163]
    v_mfma_f32_16x16x32_bf16 v[180:183], v[32:35], v[20:23], v[180:183]
    v_mfma_f32_16x16x32_bf16 v[200:203], v[32:35], v[24:27], v[200:203]
    v_mfma_f32_16x16x32_bf16 v[220:223], v[32:35], v[28:31], v[220:223]
    s_add_u32 s57, s52, 57344
    buffer_load_dwordx4 v[112:115], v4, s[40:43], s57 offen offset:3072 sc0 sc1
    v_mfma_f32_16x16x32_bf16 v[164:167], v[36:39], v[140:143], v[164:167]
    v_mfma_f32_16x16x32_bf16 v[184:187], v[36:39], v[20:23], v[184:187]
    v_mfma_f32_16x16x32_bf16 v[204:207], v[36:39], v[24:27], v[204:207]
    v_mfma_f32_16x16x32_bf16 v[224:227], v[36:39], v[28:31], v[224:227]
    v_mfma_f32_16x16x32_bf16 v[168:171], v[144:147], v[140:143], v[168:171]
    v_mfma_f32_16x16x32_bf16 v[188:191], v[144:147], v[20:23], v[188:191]
    v_mfma_f32_16x16x32_bf16 v[208:211], v[144:147], v[24:27], v[208:211]
    v_mfma_f32_16x16x32_bf16 v[228:231], v[144:147], v[28:31], v[228:231]
    v_mfma_f32_16x16x32_bf16 v[172:175], v[148:151], v[140:143], v[172:175]
    v_mfma_f32_16x16x32_bf16 v[192:195], v[148:151], v[20:23], v[192:195]
    v_mfma_f32_16x16x32_bf16 v[212:215], v[148:151], v[24:27], v[212:215]
    v_mfma_f32_16x16x32_bf16 v[232:235], v[148:151], v[28:31], v[232:235]
    v_mfma_f32_16x16x32_bf16 v[176:179], v[152:155], v[140:143], v[176:179]
    v_mfma_f32_16x16x32_bf16 v[196:199], v[152:155], v[20:23], v[196:199]
    v_mfma_f32_16x16x32_bf16 v[216:219], v[152:155], v[24:27], v[216:219]
    v_mfma_f32_16x16x32_bf16 v[236:239], v[152:155], v[28:31], v[236:239]
    s_lshl_b32 s56, s32, 6
    s_lshl_b32 s58, s34, 4
    s_add_u32 s56, s56, s58
    s_mul_i32 s56, s56, 1280
    s_mul_i32 s58, s33, 160
    s_add_u32 s61, s56, s58
    v_mul_u32_u24 v254, 1280, v2
    v_lshl_add_u32 v254, v3, 3, v254
    buffer_load_dwordx2 v[244:245], v254, s[24:27], s61 offen offset:0
    buffer_load_dwordx2 v[246:247], v254, s[24:27], s61 offen offset:32
    buffer_load_dwordx2 v[248:249], v254, s[24:27], s61 offen offset:64
    s_mov_b32 s28, s18
    s_mov_b32 s29, s19
    s_mov_b32 s30, 2621440
    s_mov_b32 s31, 0x20000
    s_waitcnt vmcnt(21)
    v_mfma_f32_16x16x32_bf16 v[160:163], v[52:55], v[156:159], v[160:163]
    v_mfma_f32_16x16x32_bf16 v[180:183], v[52:55], v[40:43], v[180:183]
    v_mfma_f32_16x16x32_bf16 v[200:203], v[52:55], v[44:47], v[200:203]
    v_mfma_f32_16x16x32_bf16 v[220:223], v[52:55], v[48:51], v[220:223]
    v_mfma_f32_16x16x32_bf16 v[164:167], v[56:59], v[156:159], v[164:167]
    v_mfma_f32_16x16x32_bf16 v[184:187], v[56:59], v[40:43], v[184:187]
    v_mfma_f32_16x16x32_bf16 v[204:207], v[56:59], v[44:47], v[204:207]
    v_mfma_f32_16x16x32_bf16 v[224:227], v[56:59], v[48:51], v[224:227]
    v_mfma_f32_16x16x32_bf16 v[168:171], v[240:243], v[156:159], v[168:171]
    v_mfma_f32_16x16x32_bf16 v[188:191], v[240:243], v[40:43], v[188:191]
    v_mfma_f32_16x16x32_bf16 v[208:211], v[240:243], v[44:47], v[208:211]
    v_mfma_f32_16x16x32_bf16 v[228:231], v[240:243], v[48:51], v[228:231]
    v_mfma_f32_16x16x32_bf16 v[172:175], v[16:19], v[156:159], v[172:175]
    v_mfma_f32_16x16x32_bf16 v[192:195], v[16:19], v[40:43], v[192:195]
    v_mfma_f32_16x16x32_bf16 v[212:215], v[16:19], v[44:47], v[212:215]
    v_mfma_f32_16x16x32_bf16 v[232:235], v[16:19], v[48:51], v[232:235]
    v_mfma_f32_16x16x32_bf16 v[176:179], v[80:83], v[156:159], v[176:179]
    v_mfma_f32_16x16x32_bf16 v[196:199], v[80:83], v[40:43], v[196:199]
    v_mfma_f32_16x16x32_bf16 v[216:219], v[80:83], v[44:47], v[216:219]
    v_mfma_f32_16x16x32_bf16 v[236:239], v[80:83], v[48:51], v[236:239]
    s_waitcnt vmcnt(12)
    v_mfma_f32_16x16x32_bf16 v[160:163], v[72:75], v[84:87], v[160:163]
    v_mfma_f32_16x16x32_bf16 v[180:183], v[72:75], v[60:63], v[180:183]
    v_mfma_f32_16x16x32_bf16 v[200:203], v[72:75], v[64:67], v[200:203]
    v_mfma_f32_16x16x32_bf16 v[220:223], v[72:75], v[68:71], v[220:223]
    v_mfma_f32_16x16x32_bf16 v[164:167], v[76:79], v[84:87], v[164:167]
    v_mfma_f32_16x16x32_bf16 v[184:187], v[76:79], v[60:63], v[184:187]
    v_mfma_f32_16x16x32_bf16 v[204:207], v[76:79], v[64:67], v[204:207]
    v_mfma_f32_16x16x32_bf16 v[224:227], v[76:79], v[68:71], v[224:227]
    v_mfma_f32_16x16x32_bf16 v[168:171], v[88:91], v[84:87], v[168:171]
    v_mfma_f32_16x16x32_bf16 v[188:191], v[88:91], v[60:63], v[188:191]
    v_mfma_f32_16x16x32_bf16 v[208:211], v[88:91], v[64:67], v[208:211]
    v_mfma_f32_16x16x32_bf16 v[228:231], v[88:91], v[68:71], v[228:231]
    v_mfma_f32_16x16x32_bf16 v[172:175], v[92:95], v[84:87], v[172:175]
    v_mfma_f32_16x16x32_bf16 v[192:195], v[92:95], v[60:63], v[192:195]
    v_mfma_f32_16x16x32_bf16 v[212:215], v[92:95], v[64:67], v[212:215]
    v_mfma_f32_16x16x32_bf16 v[232:235], v[92:95], v[68:71], v[232:235]
    v_mfma_f32_16x16x32_bf16 v[176:179], v[96:99], v[84:87], v[176:179]
    v_mfma_f32_16x16x32_bf16 v[196:199], v[96:99], v[60:63], v[196:199]
    v_mfma_f32_16x16x32_bf16 v[216:219], v[96:99], v[64:67], v[216:219]
    v_mfma_f32_16x16x32_bf16 v[236:239], v[96:99], v[68:71], v[236:239]
    s_waitcnt vmcnt(3)
    v_mfma_f32_16x16x32_bf16 v[160:163], v[132:135], v[100:103], v[160:163]
    v_mfma_f32_16x16x32_bf16 v[180:183], v[132:135], v[120:123], v[180:183]
    v_mfma_f32_16x16x32_bf16 v[200:203], v[132:135], v[124:127], v[200:203]
    v_mfma_f32_16x16x32_bf16 v[220:223], v[132:135], v[128:131], v[220:223]
    v_mfma_f32_16x16x32_bf16 v[164:167], v[136:139], v[100:103], v[164:167]
    v_mfma_f32_16x16x32_bf16 v[184:187], v[136:139], v[120:123], v[184:187]
    v_mfma_f32_16x16x32_bf16 v[204:207], v[136:139], v[124:127], v[204:207]
    v_mfma_f32_16x16x32_bf16 v[224:227], v[136:139], v[128:131], v[224:227]
    v_mfma_f32_16x16x32_bf16 v[168:171], v[104:107], v[100:103], v[168:171]
    v_mfma_f32_16x16x32_bf16 v[188:191], v[104:107], v[120:123], v[188:191]
    v_mfma_f32_16x16x32_bf16 v[208:211], v[104:107], v[124:127], v[208:211]
    v_mfma_f32_16x16x32_bf16 v[228:231], v[104:107], v[128:131], v[228:231]
    v_mfma_f32_16x16x32_bf16 v[172:175], v[108:111], v[100:103], v[172:175]
    v_mfma_f32_16x16x32_bf16 v[192:195], v[108:111], v[120:123], v[192:195]
    v_mfma_f32_16x16x32_bf16 v[212:215], v[108:111], v[124:127], v[212:215]
    v_mfma_f32_16x16x32_bf16 v[232:235], v[108:111], v[128:131], v[232:235]
    v_mfma_f32_16x16x32_bf16 v[176:179], v[112:115], v[100:103], v[176:179]
    v_mfma_f32_16x16x32_bf16 v[196:199], v[112:115], v[120:123], v[196:199]
    v_mfma_f32_16x16x32_bf16 v[216:219], v[112:115], v[124:127], v[216:219]
    v_mfma_f32_16x16x32_bf16 v[236:239], v[112:115], v[128:131], v[236:239]
P2_D_S3:
    s_add_u32 s3, s3, 1
    s_cmp_gt_u32 s3, 0x2000000
    s_cbranch_scc1 K_END
    ds_read_b32 v8, v10 offset:16
    s_waitcnt lgkmcnt(0)
    v_readfirstlane_b32 s56, v8
    s_nop 1
    s_cmp_lt_u32 s56, 1
    s_cbranch_scc1 P2_D_S3
    s_mul_i32 s63, s34, 19456
    s_cmp_eq_u32 s34, 0
    s_cbranch_scc1 P2_DRW0
    s_sub_u32 s56, 3, s34
    s_and_b32 s56, s56, 3
    s_mul_i32 s56, s56, 5120
    s_add_u32 s56, s56, s63
    v_add_u32 v12, s56, v4
    ds_write_b128 v12, v[160:163] offset:0
    ds_write_b128 v12, v[164:167] offset:1024
    ds_write_b128 v12, v[168:171] offset:2048
    ds_write_b128 v12, v[172:175] offset:3072
    ds_write_b128 v12, v[176:179] offset:4096
    s_branch P2_DRX0
P2_DRW0:
    s_nop 7
    v_add_u32 v12, s63, v4
    ds_write_b128 v12, v[172:175] offset:15360
    ds_write_b128 v12, v[176:179] offset:16384
    v_mov_b32 v16, v160
    v_mov_b32 v17, v161
    v_mov_b32 v18, v162
    v_mov_b32 v19, v163
    v_mov_b32 v20, v164
    v_mov_b32 v21, v165
    v_mov_b32 v22, v166
    v_mov_b32 v23, v167
    v_mov_b32 v24, v168
    v_mov_b32 v25, v169
    v_mov_b32 v26, v170
    v_mov_b32 v27, v171
P2_DRX0:
    s_cmp_eq_u32 s34, 1
    s_cbranch_scc1 P2_DRW1
    s_sub_u32 s56, 4, s34
    s_and_b32 s56, s56, 3
    s_mul_i32 s56, s56, 5120
    s_add_u32 s56, s56, s63
    v_add_u32 v12, s56, v4
    ds_write_b128 v12, v[180:183] offset:0
    ds_write_b128 v12, v[184:187] offset:1024
    ds_write_b128 v12, v[188:191] offset:2048
    ds_write_b128 v12, v[192:195] offset:3072
    ds_write_b128 v12, v[196:199] offset:4096
    s_branch P2_DRX1
P2_DRW1:
    s_nop 7
    v_add_u32 v12, s63, v4
    ds_write_b128 v12, v[192:195] offset:15360
    ds_write_b128 v12, v[196:199] offset:16384
    v_mov_b32 v16, v180
    v_mov_b32 v17, v181
    v_mov_b32 v18, v182
    v_mov_b32 v19, v183
    v_mov_b32 v20, v184
    v_mov_b32 v21, v185
    v_mov_b32 v22, v186
    v_mov_b32 v23, v187
    v_mov_b32 v24, v188
    v_mov_b32 v25, v189
    v_mov_b32 v26, v190
    v_mov_b32 v27, v191
P2_DRX1:
    s_cmp_eq_u32 s34, 2
    s_cbranch_scc1 P2_DRW2
    s_sub_u32 s56, 5, s34
    s_and_b32 s56, s56, 3
    s_mul_i32 s56, s56, 5120
    s_add_u32 s56, s56, s63
    v_add_u32 v12, s56, v4
    ds_write_b128 v12, v[200:203] offset:0
    ds_write_b128 v12, v[204:207] offset:1024
    ds_write_b128 v12, v[208:211] offset:2048
    ds_write_b128 v12, v[212:215] offset:3072
    ds_write_b128 v12, v[216:219] offset:4096
    s_branch P2_DRX2
P2_DRW2:
    s_nop 7
    v_add_u32 v12, s63, v4
    ds_write_b128 v12, v[212:215] offset:15360
    ds_write_b128 v12, v[216:219] offset:16384
    v_mov_b32 v16, v200
    v_mov_b32 v17, v201
    v_mov_b32 v18, v202
    v_mov_b32 v19, v203
    v_mov_b32 v20, v204
    v_mov_b32 v21, v205
    v_mov_b32 v22, v206
    v_mov_b32 v23, v207
    v_mov_b32 v24, v208
    v_mov_b32 v25, v209
    v_mov_b32 v26, v210
    v_mov_b32 v27, v211
P2_DRX2:
    s_cmp_eq_u32 s34, 3
    s_cbranch_scc1 P2_DRW3
    s_sub_u32 s56, 6, s34
    s_and_b32 s56, s56, 3
    s_mul_i32 s56, s56, 5120
    s_add_u32 s56, s56, s63
    v_add_u32 v12, s56, v4
    ds_write_b128 v12, v[220:223] offset:0
    ds_write_b128 v12, v[224:227] offset:1024
    ds_write_b128 v12, v[228:231] offset:2048
    ds_write_b128 v12, v[232:235] offset:3072
    ds_write_b128 v12, v[236:239] offset:4096
    s_branch P2_DRX3
P2_DRW3:
    s_nop 7
    v_add_u32 v12, s63, v4
    ds_write_b128 v12, v[232:235] offset:15360
    ds_write_b128 v12, v[236:239] offset:16384
    v_mov_b32 v16, v220
    v_mov_b32 v17, v221
    v_mov_b32 v18, v222
    v_mov_b32 v19, v223
    v_mov_b32 v20, v224
    v_mov_b32 v21, v225
    v_mov_b32 v22, v226
    v_mov_b32 v23, v227
    v_mov_b32 v24, v228
    v_mov_b32 v25, v229
    v_mov_b32 v26, v230
    v_mov_b32 v27, v231
P2_DRX3:
    s_sub_u32 s56, s34, 1
    s_and_b32 s56, s56, 3
    s_mul_i32 s57, s56, 19456
    s_add_u32 s57, s57, 0
    v_add_u32 v5, s57, v4
    s_mul_i32 s57, s56, 20480
    s_add_u32 s57, s57, 77824
    v_add_u32 v8, s57, v4
    s_sub_u32 s56, s34, 2
    s_and_b32 s56, s56, 3
    s_mul_i32 s57, s56, 19456
    s_add_u32 s57, s57, 5120
    v_add_u32 v6, s57, v4
    s_mul_i32 s57, s56, 20480
    s_add_u32 s57, s57, 82944
    v_add_u32 v9, s57, v4
    s_sub_u32 s56, s34, 3
    s_and_b32 s56, s56, 3
    s_mul_i32 s57, s56, 19456
    s_add_u32 s57, s57, 10240
    v_add_u32 v7, s57, v4
    s_mul_i32 s57, s56, 20480
    s_add_u32 s57, s57, 88064
    v_add_u32 v10, s57, v4
    s_mul_i32 s57, s34, 20480
    s_add_u32 s57, s57, 93184
    s_mov_b32 s62, 0xbfb8aa3b
    s_waitcnt vmcnt(0)
    v_lshlrev_b32 v28, 16, v244
    v_and_b32 v29, 0xffff0000, v244
    v_lshlrev_b32 v30, 16, v245
    v_and_b32 v31, 0xffff0000, v245
    v_lshlrev_b32 v32, 16, v246
    v_and_b32 v33, 0xffff0000, v246
    v_lshlrev_b32 v34, 16, v247
    v_and_b32 v35, 0xffff0000, v247
    v_lshlrev_b32 v36, 16, v248
    v_and_b32 v37, 0xffff0000, v248
    v_lshlrev_b32 v38, 16, v249
    v_and_b32 v39, 0xffff0000, v249
    s_waitcnt lgkmcnt(0)
    v_add_u32 v12, s57, v4
    s_barrier
    ds_read_b128 v[40:43], v5 offset:0
    ds_read_b128 v[44:47], v5 offset:1024
    ds_read_b128 v[48:51], v5 offset:2048
    ds_read_b128 v[52:55], v6 offset:0
    ds_read_b128 v[56:59], v6 offset:1024
    ds_read_b128 v[60:63], v6 offset:2048
    ds_read_b128 v[64:67], v7 offset:0
    ds_read_b128 v[68:71], v7 offset:1024
    ds_read_b128 v[72:75], v7 offset:2048
    ds_read_b128 v[76:79], v8 offset:0
    ds_read_b128 v[80:83], v8 offset:1024
    ds_read_b128 v[84:87], v8 offset:2048
    ds_read_b128 v[88:91], v9 offset:0
    ds_read_b128 v[92:95], v9 offset:1024
    ds_read_b128 v[96:99], v9 offset:2048
    ds_read_b128 v[100:103], v10 offset:0
    ds_read_b128 v[104:107], v10 offset:1024
    ds_read_b128 v[108:111], v10 offset:2048
    ds_read_b128 v[112:115], v12 offset:0
    ds_read_b128 v[116:119], v12 offset:1024
    ds_read_b128 v[120:123], v12 offset:2048
    s_waitcnt lgkmcnt(12)
    v_add_f32 v40, v40, v52
    v_add_f32 v64, v64, v16
    v_add_f32 v41, v41, v53
    v_add_f32 v65, v65, v17
    v_add_f32 v42, v42, v54
    v_add_f32 v66, v66, v18
    v_add_f32 v43, v43, v55
    v_add_f32 v67, v67, v19
    v_add_f32 v44, v44, v56
    v_add_f32 v68, v68, v20
    v_add_f32 v45, v45, v57
    v_add_f32 v69, v69, v21
    v_add_f32 v46, v46, v58
    v_add_f32 v70, v70, v22
    v_add_f32 v47, v47, v59
    v_add_f32 v71, v71, v23
    v_add_f32 v48, v48, v60
    v_add_f32 v72, v72, v24
    v_add_f32 v49, v49, v61
    v_add_f32 v73, v73, v25
    v_add_f32 v50, v50, v62
    v_add_f32 v74, v74, v26
    v_add_f32 v51, v51, v63
    v_add_f32 v75, v75, v27
    v_add_f32 v40, v40, v64
    v_add_f32 v41, v41, v65
    v_add_f32 v42, v42, v66
    v_add_f32 v43, v43, v67
    v_add_f32 v44, v44, v68
    v_add_f32 v45, v45, v69
    v_add_f32 v46, v46, v70
    v_add_f32 v47, v47, v71
    v_add_f32 v48, v48, v72
    v_add_f32 v49, v49, v73
    v_add_f32 v50, v50, v74
    v_add_f32 v51, v51, v75
    v_mul_f32 v52, s62, v40
    v_mul_f32 v53, s62, v41
    v_mul_f32 v54, s62, v42
    v_mul_f32 v55, s62, v43
    v_mul_f32 v56, s62, v44
    v_mul_f32 v57, s62, v45
    v_mul_f32 v58, s62, v46
    v_mul_f32 v59, s62, v47
    v_mul_f32 v60, s62, v48
    v_mul_f32 v61, s62, v49
    v_mul_f32 v62, s62, v50
    v_mul_f32 v63, s62, v51
    v_exp_f32 v52, v52
    v_exp_f32 v53, v53
    v_exp_f32 v54, v54
    v_exp_f32 v55, v55
    v_exp_f32 v56, v56
    v_exp_f32 v57, v57
    v_exp_f32 v58, v58
    v_exp_f32 v59, v59
    v_exp_f32 v60, v60
    v_exp_f32 v61, v61
    v_exp_f32 v62, v62
    v_exp_f32 v63, v63
    s_waitcnt lgkmcnt(0)
    v_add_f32 v76, v76, v88
    v_add_f32 v100, v100, v112
    v_add_f32 v77, v77, v89
    v_add_f32 v101, v101, v113
    v_add_f32 v78, v78, v90
    v_add_f32 v102, v102, v114
    v_add_f32 v79, v79, v91
    v_add_f32 v103, v103, v115
    v_add_f32 v80, v80, v92
    v_add_f32 v104, v104, v116
    v_add_f32 v81, v81, v93
    v_add_f32 v105, v105, v117
    v_add_f32 v82, v82, v94
    v_add_f32 v106, v106, v118
    v_add_f32 v83, v83, v95
    v_add_f32 v107, v107, v119
    v_add_f32 v84, v84, v96
    v_add_f32 v108, v108, v120
    v_add_f32 v85, v85, v97
    v_add_f32 v109, v109, v121
    v_add_f32 v86, v86, v98
    v_add_f32 v110, v110, v122
    v_add_f32 v87, v87, v99
    v_add_f32 v111, v111, v123
    v_add_f32 v52, 1.0, v52
    v_add_f32 v53, 1.0, v53
    v_add_f32 v54, 1.0, v54
    v_add_f32 v55, 1.0, v55
    v_add_f32 v56, 1.0, v56
    v_add_f32 v57, 1.0, v57
    v_add_f32 v58, 1.0, v58
    v_add_f32 v59, 1.0, v59
    v_add_f32 v60, 1.0, v60
    v_add_f32 v61, 1.0, v61
    v_add_f32 v62, 1.0, v62
    v_add_f32 v63, 1.0, v63
    v_rcp_f32 v52, v52
    v_add_f32 v76, v76, v100
    v_rcp_f32 v53, v53
    v_add_f32 v77, v77, v101
    v_rcp_f32 v54, v54
    v_add_f32 v78, v78, v102
    v_rcp_f32 v55, v55
    v_add_f32 v79, v79, v103
    v_rcp_f32 v56, v56
    v_add_f32 v80, v80, v104
    v_rcp_f32 v57, v57
    v_add_f32 v81, v81, v105
    v_rcp_f32 v58, v58
    v_add_f32 v82, v82, v106
    v_rcp_f32 v59, v59
    v_add_f32 v83, v83, v107
    v_rcp_f32 v60, v60
    v_add_f32 v84, v84, v108
    v_rcp_f32 v61, v61
    v_add_f32 v85, v85, v109
    v_rcp_f32 v62, v62
    v_add_f32 v86, v86, v110
    v_rcp_f32 v63, v63
    v_add_f32 v87, v87, v111
    v_mul_f32 v40, v40, v76
    v_mul_f32 v41, v41, v77
    v_mul_f32 v42, v42, v78
    v_mul_f32 v43, v43, v79
    v_mul_f32 v44, v44, v80
    v_mul_f32 v45, v45, v81
    v_mul_f32 v46, v46, v82
    v_mul_f32 v47, v47, v83
    v_mul_f32 v48, v48, v84
    v_mul_f32 v49, v49, v85
    v_mul_f32 v50, v50, v86
    v_mul_f32 v51, v51, v87
    v_fma_f32 v28, v40, v52, v28
    v_fma_f32 v29, v41, v53, v29
    v_fma_f32 v30, v42, v54, v30
    v_fma_f32 v31, v43, v55, v31
    v_cvt_pk_bf16_f32 v244, v28, v29
    v_cvt_pk_bf16_f32 v245, v30, v31
    buffer_store_dwordx2 v[244:245], v254, s[28:31], s61 offen offset:0
    v_fma_f32 v32, v44, v56, v32
    v_fma_f32 v33, v45, v57, v33
    v_fma_f32 v34, v46, v58, v34
    v_fma_f32 v35, v47, v59, v35
    v_cvt_pk_bf16_f32 v246, v32, v33
    v_cvt_pk_bf16_f32 v247, v34, v35
    buffer_store_dwordx2 v[246:247], v254, s[28:31], s61 offen offset:32
    v_fma_f32 v36, v48, v60, v36
    v_fma_f32 v37, v49, v61, v37
    v_fma_f32 v38, v50, v62, v38
    v_fma_f32 v39, v51, v63, v39
    v_cvt_pk_bf16_f32 v248, v36, v37
    v_cvt_pk_bf16_f32 v249, v38, v39
    buffer_store_dwordx2 v[248:249], v254, s[28:31], s61 offen offset:64
    s_branch K_END
P2_S:
    s_setprio 3
    s_lshl_b32 s56, s33, 2
    s_add_u32 s56, s56, s34
    s_mul_i32 s56, s56, 25600
    s_add_u32 s52, s56, 10878976
    s_add_u32 s56, s52, 0
    buffer_load_dwordx4 v[124:127], v4, s[40:43], s56 offen sc0 sc1
    s_add_u32 s56, s52, 1024
    buffer_load_dwordx4 v[128:131], v4, s[40:43], s56 offen sc0 sc1
    s_add_u32 s56, s52, 2048
    buffer_load_dwordx4 v[132:135], v4, s[40:43], s56 offen sc0 sc1
    s_add_u32 s56, s52, 3072
    buffer_load_dwordx4 v[136:139], v4, s[40:43], s56 offen sc0 sc1
    s_add_u32 s56, s52, 4096
    buffer_load_dwordx4 v[140:143], v4, s[40:43], s56 offen sc0 sc1
    s_add_u32 s56, s52, 5120
    buffer_load_dwordx4 v[144:147], v4, s[40:43], s56 offen sc0 sc1
    s_add_u32 s56, s52, 6144
    buffer_load_dwordx4 v[148:151], v4, s[40:43], s56 offen sc0 sc1
    s_add_u32 s56, s52, 7168
    buffer_load_dwordx4 v[152:155], v4, s[40:43], s56 offen sc0 sc1
    s_add_u32 s56, s52, 8192
    buffer_load_dwordx4 v[156:159], v4, s[40:43], s56 offen sc0 sc1
    s_add_u32 s56, s52, 9216
    buffer_load_dwordx4 v[240:243], v4, s[40:43], s56 offen sc0 sc1
    s_waitcnt vmcnt(10)
    s_cmp_lg_u32 s70, 0
    s_cbranch_scc1 P2_KVFS
    s_mov_b64 exec, 1
    buffer_store_dwordx2 v[12:13], v11, s[40:43], s71 offen sc0 sc1
    s_mov_b64 exec, -1
    s_barrier
    s_branch P2_FDS
P2_KVFS:
    s_barrier
P2_FDS:
    s_lshl_b32 s56, s32, 2
    s_add_u32 s56, s56, 0
    s_mul_i32 s57, s56, 20480
    s_mul_i32 s58, s34, 5120
    s_add_u32 s57, s57, s58
    s_add_u32 s36, s57, 6291456
    s_lshl_b32 s56, s32, 2
    s_add_u32 s56, s56, 1
    s_mul_i32 s57, s56, 20480
    s_mul_i32 s58, s34, 5120
    s_add_u32 s57, s57, s58
    s_add_u32 s37, s57, 6291456
    s_lshl_b32 s56, s32, 2
    s_add_u32 s56, s56, 2
    s_mul_i32 s57, s56, 20480
    s_mul_i32 s58, s34, 5120
    s_add_u32 s57, s57, s58
    s_add_u32 s38, s57, 6291456
    s_lshl_b32 s56, s32, 2
    s_add_u32 s56, s56, 3
    s_mul_i32 s57, s56, 20480
    s_mul_i32 s58, s34, 5120
    s_add_u32 s57, s57, s58
    s_add_u32 s39, s57, 6291456
    s_mul_i32 s56, s34, 13440
    s_add_u32 s53, s56, 11698176
    s_mul_i32 s63, s34, 19456
    s_mul_i32 s51, s34, 1024
    s_add_u32 s51, s51, 77824
    v_lshlrev_b32 v11, 5, v3
    v_add_u32 v11, s63, v11
    v_mul_u32_u24 v12, 80, v2
    v_add_u32 v5, v12, v11
    v_lshrrev_b32 v13, 2, v2
    v_add_u32 v13, 16, v13
    v_and_b32 v16, 3, v2
    v_cmp_eq_u32 vcc, 1, v16
    s_nop 1
    v_cndmask_b32 v13, v13, 20, vcc
    v_mul_u32_u24 v13, 80, v13
    v_add_u32 v6, v13, v11
    v_cmp_gt_u32 s[64:65], 2, v16
    v_cmp_gt_u32 s[66:67], 3, v3
    v_cmp_gt_u32 s[68:69], 2, v3
    v_lshlrev_b32 v16, 8, v3
    v_lshl_add_u32 v16, v2, 3, v16
    s_add_u32 s56, s63, 7168
    v_add_u32 v7, s56, v16
    s_and_b64 s[70:71], s[64:65], s[68:69]
    s_and_b64 s[64:65], s[64:65], s[66:67]
    v_mov_b32 v28, 0
    v_mov_b32 v29, 0
    v_mov_b32 v30, 0
    v_mov_b32 v31, 0
    v_mov_b32 v32, 0
    v_mov_b32 v33, 0
    v_mov_b32 v34, 0
    v_mov_b32 v35, 0
    v_mov_b32 v36, 0
    v_mov_b32 v37, 0
    v_mov_b32 v38, 0
    v_mov_b32 v39, 0
    v_mov_b32 v40, 0
    v_mov_b32 v41, 0
    v_mov_b32 v42, 0
    v_mov_b32 v43, 0
    v_mov_b32 v44, 0
    v_mov_b32 v45, 0
    v_mov_b32 v46, 0
    v_mov_b32 v47, 0
    v_mov_b32 v48, 0
    v_mov_b32 v49, 0
    v_mov_b32 v50, 0
    v_mov_b32 v51, 0
    v_mov_b32 v52, 0
    v_mov_b32 v53, 0
    v_mov_b32 v54, 0
    v_mov_b32 v55, 0
    v_mov_b32 v56, 0
    v_mov_b32 v57, 0
    v_mov_b32 v58, 0
    v_mov_b32 v59, 0
    v_mov_b32 v160, 0
    v_mov_b32 v161, 0
    v_mov_b32 v162, 0
    v_mov_b32 v163, 0
    v_mov_b32 v164, 0
    v_mov_b32 v165, 0
    v_mov_b32 v166, 0
    v_mov_b32 v167, 0
    v_mov_b32 v168, 0
    v_mov_b32 v169, 0
    v_mov_b32 v170, 0
    v_mov_b32 v171, 0
    v_mov_b32 v172, 0
    v_mov_b32 v173, 0
    v_mov_b32 v174, 0
    v_mov_b32 v175, 0
    v_mov_b32 v176, 0
    v_mov_b32 v177, 0
    v_mov_b32 v178, 0
    v_mov_b32 v179, 0
    v_mov_b32 v180, 0
    v_mov_b32 v181, 0
    v_mov_b32 v182, 0
    v_mov_b32 v183, 0
    v_mov_b32 v184, 0
    v_mov_b32 v185, 0
    v_mov_b32 v186, 0
    v_mov_b32 v187, 0
    v_mov_b32 v188, 0
    v_mov_b32 v189, 0
    v_mov_b32 v190, 0
    v_mov_b32 v191, 0
    v_mov_b32 v192, 0
    v_mov_b32 v193, 0
    v_mov_b32 v194, 0
    v_mov_b32 v195, 0
    v_mov_b32 v196, 0
    v_mov_b32 v197, 0
    v_mov_b32 v198, 0
    v_mov_b32 v199, 0
    v_mov_b32 v200, 0
    v_mov_b32 v201, 0
    v_mov_b32 v202, 0
    v_mov_b32 v203, 0
    v_mov_b32 v204, 0
    v_mov_b32 v205, 0
    v_mov_b32 v206, 0
    v_mov_b32 v207, 0
    v_mov_b32 v208, 0
    v_mov_b32 v209, 0
    v_mov_b32 v210, 0
    v_mov_b32 v211, 0
    v_mov_b32 v212, 0
    v_mov_b32 v213, 0
    v_mov_b32 v214, 0
    v_mov_b32 v215, 0
    v_mov_b32 v216, 0
    v_mov_b32 v217, 0
    v_mov_b32 v218, 0
    v_mov_b32 v219, 0
    v_mov_b32 v220, 0
    v_mov_b32 v221, 0
    v_mov_b32 v222, 0
    v_mov_b32 v223, 0
    v_mov_b32 v224, 0
    v_mov_b32 v225, 0
    v_mov_b32 v226, 0
    v_mov_b32 v227, 0
    v_mov_b32 v228, 0
    v_mov_b32 v229, 0
    v_mov_b32 v230, 0
    v_mov_b32 v231, 0
    v_mov_b32 v232, 0
    v_mov_b32 v233, 0
    v_mov_b32 v234, 0
    v_mov_b32 v235, 0
    v_mov_b32 v236, 0
    v_mov_b32 v237, 0
    v_mov_b32 v238, 0
    v_mov_b32 v239, 0
    s_mov_b64 exec, 4095
    s_branch P2_POLLH_l
P2_POLLH:
    s_add_u32 s3, s3, 1
    s_cmp_gt_u32 s3, 0x200000
    s_cbranch_scc1 K_END
    s_sleep 6
P2_POLLH_l:
    buffer_load_dwordx2 v[16:17], v9, s[40:43], s61 offen sc0 sc1
P2_POLLH_w:
    s_waitcnt vmcnt(0)
    v_cmp_ne_u64 vcc, s[48:49], v[16:17]
    s_nop 1
    s_cmp_lg_u64 vcc, 0
    s_cbranch_scc1 P2_POLLH
    s_mov_b64 exec, -1
    s_add_u32 m0, s63, 7168
    s_add_u32 s56, s36, 0
    buffer_load_dwordx4 v4, s[40:43], s56 offen sc0 sc1 lds
    s_add_u32 m0, s63, 10240
    s_add_u32 s56, s37, 0
    buffer_load_dwordx4 v4, s[40:43], s56 offen sc0 sc1 lds
    s_add_u32 m0, s63, 13312
    s_add_u32 s56, s38, 0
    buffer_load_dwordx4 v4, s[40:43], s56 offen sc0 sc1 lds
    s_add_u32 m0, s63, 16384
    s_add_u32 s56, s39, 0
    buffer_load_dwordx4 v4, s[40:43], s56 offen sc0 sc1 lds
    s_add_u32 m0, s63, 8192
    s_add_u32 s56, s36, 1024
    buffer_load_dwordx4 v4, s[40:43], s56 offen sc0 sc1 lds
    s_add_u32 m0, s63, 11264
    s_add_u32 s56, s37, 1024
    buffer_load_dwordx4 v4, s[40:43], s56 offen sc0 sc1 lds
    s_add_u32 m0, s63, 14336
    s_add_u32 s56, s38, 1024
    buffer_load_dwordx4 v4, s[40:43], s56 offen sc0 sc1 lds
    s_add_u32 m0, s63, 17408
    s_add_u32 s56, s39, 1024
    buffer_load_dwordx4 v4, s[40:43], s56 offen sc0 sc1 lds
    s_add_u32 m0, s63, 9216
    s_add_u32 s56, s36, 2048
    buffer_load_dwordx4 v4, s[40:43], s56 offen sc0 sc1 lds
    s_add_u32 m0, s63, 12288
    s_add_u32 s56, s37, 2048
    buffer_load_dwordx4 v4, s[40:43], s56 offen sc0 sc1 lds
    s_add_u32 m0, s63, 15360
    s_add_u32 s56, s38, 2048
    buffer_load_dwordx4 v4, s[40:43], s56 offen sc0 sc1 lds
    s_add_u32 m0, s63, 18432
    s_add_u32 s56, s39, 2048
    buffer_load_dwordx4 v4, s[40:43], s56 offen sc0 sc1 lds
    s_mov_b64 exec, 65535
    s_branch P2_POLLKV_l
P2_POLLKV:
    s_add_u32 s3, s3, 1
    s_cmp_gt_u32 s3, 0x200000
    s_cbranch_scc1 K_END
    s_sleep 6
P2_POLLKV_l:
    buffer_load_dwordx2 v[16:17], v9, s[40:43], s62 offen sc0 sc1
P2_POLLKV_w:
    s_waitcnt vmcnt(0)
    v_cmp_ne_u64 vcc, s[48:49], v[16:17]
    s_nop 1
    s_cmp_lg_u64 vcc, 0
    s_cbranch_scc1 P2_POLLKV
    s_mov_b64 exec, -1
    s_add_u32 m0, s63, 0
    s_add_u32 s56, s53, 0
    buffer_load_dwordx4 v4, s[40:43], s56 offen sc0 sc1 lds
    s_add_u32 m0, s63, 1024
    s_add_u32 s56, s53, 1024
    buffer_load_dwordx4 v4, s[40:43], s56 offen sc0 sc1 lds
    s_add_u32 m0, s63, 2048
    s_add_u32 s56, s53, 2048
    buffer_load_dwordx4 v4, s[40:43], s56 offen sc0 sc1 lds
    s_add_u32 m0, s63, 3072
    s_add_u32 s56, s53, 3072
    buffer_load_dwordx4 v4, s[40:43], s56 offen sc0 sc1 lds
    s_add_u32 m0, s63, 4096
    s_add_u32 s56, s53, 4096
    buffer_load_dwordx4 v4, s[40:43], s56 offen sc0 sc1 lds
    s_add_u32 m0, s63, 5120
    s_add_u32 s56, s53, 5120
    buffer_load_dwordx4 v4, s[40:43], s56 offen sc0 sc1 lds
    s_add_u32 m0, s63, 6144
    s_add_u32 s56, s53, 6144
    buffer_load_dwordx4 v4, s[40:43], s56 offen sc0 sc1 lds
    s_mov_b32 s60, 0x358637bd
    v_mov_b32 v17, 1
    s_waitcnt vmcnt(5)
    s_mov_b64 exec, s[66:67]
    ds_read_b128 v[28:31], v5 offset:0
    ds_read_b64 v[44:45], v7 offset:0
    ds_read_b64 v[48:49], v7 offset:3072
    ds_read_b64 v[52:53], v7 offset:6144
    ds_read_b64 v[56:57], v7 offset:9216
    s_mov_b64 exec, s[68:69]
    ds_read_b128 v[32:35], v5 offset:16
    ds_read_b64 v[46:47], v7 offset:128
    ds_read_b64 v[50:51], v7 offset:3200
    ds_read_b64 v[54:55], v7 offset:6272
    ds_read_b64 v[58:59], v7 offset:9344
    s_mov_b64 exec, s[64:65]
    ds_read_b128 v[36:39], v6 offset:0
    s_mov_b64 exec, s[70:71]
    ds_read_b128 v[40:43], v6 offset:16
    s_mov_b64 exec, -1
    s_waitcnt lgkmcnt(0)
    v_cvt_pk_bf16_f32 v20, v28, v29
    v_cvt_pk_bf16_f32 v21, v30, v31
    v_cvt_pk_bf16_f32 v22, v32, v33
    v_cvt_pk_bf16_f32 v23, v34, v35
    v_cvt_pk_bf16_f32 v24, v36, v37
    v_cvt_pk_bf16_f32 v25, v38, v39
    v_cvt_pk_bf16_f32 v26, v40, v41
    v_cvt_pk_bf16_f32 v27, v42, v43
    v_mfma_f32_16x16x32_bf16 v[60:63], v[20:23], v[44:47], 0
    s_nop 0
    v_mfma_f32_16x16x32_bf16 v[64:67], v[24:27], v[44:47], 0
    v_mfma_f32_16x16x32_bf16 v[68:71], v[20:23], v[48:51], 0
    v_mfma_f32_16x16x32_bf16 v[72:75], v[24:27], v[48:51], 0
    v_mfma_f32_16x16x32_bf16 v[76:79], v[20:23], v[52:55], 0
    v_mfma_f32_16x16x32_bf16 v[80:83], v[24:27], v[52:55], 0
    v_mfma_f32_16x16x32_bf16 v[84:87], v[20:23], v[56:59], 0
    v_mfma_f32_16x16x32_bf16 v[88:91], v[24:27], v[56:59], 0
    s_waitcnt vmcnt(3)
    s_mov_b64 exec, s[66:67]
    ds_read_b128 v[28:31], v5 offset:1680
    ds_read_b64 v[44:45], v7 offset:640
    ds_read_b64 v[48:49], v7 offset:3712
    ds_read_b64 v[52:53], v7 offset:6784
    ds_read_b64 v[56:57], v7 offset:9856
    s_mov_b64 exec, s[68:69]
    ds_read_b128 v[32:35], v5 offset:1696
    ds_read_b64 v[46:47], v7 offset:768
    ds_read_b64 v[50:51], v7 offset:3840
    ds_read_b64 v[54:55], v7 offset:6912
    ds_read_b64 v[58:59], v7 offset:9984
    s_mov_b64 exec, s[64:65]
    ds_read_b128 v[36:39], v6 offset:1680
    s_mov_b64 exec, s[70:71]
    ds_read_b128 v[40:43], v6 offset:1696
    s_mov_b64 exec, -1
    v_add_f32 v11, s60, v65
    v_add_f32 v12, s60, v73
    v_add_f32 v13, s60, v81
    v_add_f32 v14, s60, v89
    v_rcp_f32 v11, v11
    v_rcp_f32 v12, v12
    v_rcp_f32 v13, v13
    v_rcp_f32 v14, v14
    v_mul_f32 v60, v60, v11
    v_mul_f32 v61, v61, v11
    v_mul_f32 v62, v62, v11
    v_mul_f32 v63, v63, v11
    v_mul_f32 v92, v64, v11
    v_cvt_pk_bf16_f32 v108, v60, v61
    v_cvt_pk_bf16_f32 v109, v62, v63
    v_mul_f32 v68, v68, v12
    v_mul_f32 v69, v69, v12
    v_mul_f32 v70, v70, v12
    v_mul_f32 v71, v71, v12
    v_mul_f32 v96, v72, v12
    v_cvt_pk_bf16_f32 v112, v68, v69
    v_cvt_pk_bf16_f32 v113, v70, v71
    v_mul_f32 v76, v76, v13
    v_mul_f32 v77, v77, v13
    v_mul_f32 v78, v78, v13
    v_mul_f32 v79, v79, v13
    v_mul_f32 v100, v80, v13
    v_cvt_pk_bf16_f32 v116, v76, v77
    v_cvt_pk_bf16_f32 v117, v78, v79
    v_mul_f32 v84, v84, v14
    v_mul_f32 v85, v85, v14
    v_mul_f32 v86, v86, v14
    v_mul_f32 v87, v87, v14
    v_mul_f32 v104, v88, v14
    v_cvt_pk_bf16_f32 v120, v84, v85
    v_cvt_pk_bf16_f32 v121, v86, v87
    s_waitcnt lgkmcnt(0)
    v_cvt_pk_bf16_f32 v20, v28, v29
    v_cvt_pk_bf16_f32 v21, v30, v31
    v_cvt_pk_bf16_f32 v22, v32, v33
    v_cvt_pk_bf16_f32 v23, v34, v35
    v_cvt_pk_bf16_f32 v24, v36, v37
    v_cvt_pk_bf16_f32 v25, v38, v39
    v_cvt_pk_bf16_f32 v26, v40, v41
    v_cvt_pk_bf16_f32 v27, v42, v43
    v_mfma_f32_16x16x32_bf16 v[60:63], v[20:23], v[44:47], 0
    s_nop 0
    v_mfma_f32_16x16x32_bf16 v[64:67], v[24:27], v[44:47], 0
    v_mfma_f32_16x16x32_bf16 v[68:71], v[20:23], v[48:51], 0
    v_mfma_f32_16x16x32_bf16 v[72:75], v[24:27], v[48:51], 0
    v_mfma_f32_16x16x32_bf16 v[76:79], v[20:23], v[52:55], 0
    v_mfma_f32_16x16x32_bf16 v[80:83], v[24:27], v[52:55], 0
    v_mfma_f32_16x16x32_bf16 v[84:87], v[20:23], v[56:59], 0
    v_mfma_f32_16x16x32_bf16 v[88:91], v[24:27], v[56:59], 0
    s_waitcnt vmcnt(2)
    s_mov_b64 exec, s[66:67]
    ds_read_b128 v[28:31], v5 offset:3360
    ds_read_b64 v[44:45], v7 offset:1280
    ds_read_b64 v[48:49], v7 offset:4352
    ds_read_b64 v[52:53], v7 offset:7424
    ds_read_b64 v[56:57], v7 offset:10496
    s_mov_b64 exec, s[68:69]
    ds_read_b128 v[32:35], v5 offset:3376
    ds_read_b64 v[46:47], v7 offset:1408
    ds_read_b64 v[50:51], v7 offset:4480
    ds_read_b64 v[54:55], v7 offset:7552
    ds_read_b64 v[58:59], v7 offset:10624
    s_mov_b64 exec, s[64:65]
    ds_read_b128 v[36:39], v6 offset:3360
    s_mov_b64 exec, s[70:71]
    ds_read_b128 v[40:43], v6 offset:3376
    s_mov_b64 exec, -1
    v_add_f32 v11, s60, v65
    v_add_f32 v12, s60, v73
    v_add_f32 v13, s60, v81
    v_add_f32 v14, s60, v89
    v_rcp_f32 v11, v11
    v_rcp_f32 v12, v12
    v_rcp_f32 v13, v13
    v_rcp_f32 v14, v14
    v_mul_f32 v60, v60, v11
    v_mul_f32 v61, v61, v11
    v_mul_f32 v62, v62, v11
    v_mul_f32 v63, v63, v11
    v_mul_f32 v93, v64, v11
    v_cvt_pk_bf16_f32 v110, v60, v61
    v_cvt_pk_bf16_f32 v111, v62, v63
    v_mul_f32 v68, v68, v12
    v_mul_f32 v69, v69, v12
    v_mul_f32 v70, v70, v12
    v_mul_f32 v71, v71, v12
    v_mul_f32 v97, v72, v12
    v_cvt_pk_bf16_f32 v114, v68, v69
    v_cvt_pk_bf16_f32 v115, v70, v71
    v_mul_f32 v76, v76, v13
    v_mul_f32 v77, v77, v13
    v_mul_f32 v78, v78, v13
    v_mul_f32 v79, v79, v13
    v_mul_f32 v101, v80, v13
    v_cvt_pk_bf16_f32 v118, v76, v77
    v_cvt_pk_bf16_f32 v119, v78, v79
    v_mul_f32 v84, v84, v14
    v_mul_f32 v85, v85, v14
    v_mul_f32 v86, v86, v14
    v_mul_f32 v87, v87, v14
    v_mul_f32 v105, v88, v14
    v_cvt_pk_bf16_f32 v122, v84, v85
    v_cvt_pk_bf16_f32 v123, v86, v87
P2_S_WL:
    s_add_u32 s3, s3, 1
    s_cmp_gt_u32 s3, 0x2000000
    s_cbranch_scc1 K_END
    ds_read_b32 v8, v10 offset:0
    s_waitcnt lgkmcnt(0)
    v_readfirstlane_b32 s56, v8
    s_nop 1
    s_cmp_lt_u32 s56, 1
    s_cbranch_scc1 P2_S_WL
    s_add_u32 s63, s63, s51
    v_mfma_f32_16x16x32_bf16 v[160:163], v[124:127], v[108:111], v[160:163]
    v_mfma_f32_16x16x32_bf16 v[180:183], v[124:127], v[112:115], v[180:183]
    v_mfma_f32_16x16x32_bf16 v[200:203], v[124:127], v[116:119], v[200:203]
    v_mfma_f32_16x16x32_bf16 v[220:223], v[124:127], v[120:123], v[220:223]
    s_add_u32 s56, s52, 10240
    buffer_load_dwordx4 v[124:127], v4, s[40:43], s56 offen sc0 sc1
    s_add_u32 m0, s63, 7168
    s_add_u32 s56, s36, 2560
    buffer_load_dwordx4 v4, s[40:43], s56 offen sc0 sc1 lds
    v_mfma_f32_16x16x32_bf16 v[164:167], v[128:131], v[108:111], v[164:167]
    v_mfma_f32_16x16x32_bf16 v[184:187], v[128:131], v[112:115], v[184:187]
    v_mfma_f32_16x16x32_bf16 v[204:207], v[128:131], v[116:119], v[204:207]
    v_mfma_f32_16x16x32_bf16 v[224:227], v[128:131], v[120:123], v[224:227]
    s_add_u32 s56, s52, 11264
    buffer_load_dwordx4 v[128:131], v4, s[40:43], s56 offen sc0 sc1
    s_add_u32 m0, s63, 10240
    s_add_u32 s56, s37, 2560
    buffer_load_dwordx4 v4, s[40:43], s56 offen sc0 sc1 lds
    v_mfma_f32_16x16x32_bf16 v[168:171], v[132:135], v[108:111], v[168:171]
    v_mfma_f32_16x16x32_bf16 v[188:191], v[132:135], v[112:115], v[188:191]
    v_mfma_f32_16x16x32_bf16 v[208:211], v[132:135], v[116:119], v[208:211]
    v_mfma_f32_16x16x32_bf16 v[228:231], v[132:135], v[120:123], v[228:231]
    s_add_u32 s56, s52, 12288
    buffer_load_dwordx4 v[132:135], v4, s[40:43], s56 offen sc0 sc1
    s_add_u32 m0, s63, 13312
    s_add_u32 s56, s38, 2560
    buffer_load_dwordx4 v4, s[40:43], s56 offen sc0 sc1 lds
    v_mfma_f32_16x16x32_bf16 v[172:175], v[136:139], v[108:111], v[172:175]
    v_mfma_f32_16x16x32_bf16 v[192:195], v[136:139], v[112:115], v[192:195]
    v_mfma_f32_16x16x32_bf16 v[212:215], v[136:139], v[116:119], v[212:215]
    v_mfma_f32_16x16x32_bf16 v[232:235], v[136:139], v[120:123], v[232:235]
    s_add_u32 s56, s52, 13312
    buffer_load_dwordx4 v[136:139], v4, s[40:43], s56 offen sc0 sc1
    s_add_u32 m0, s63, 16384
    s_add_u32 s56, s39, 2560
    buffer_load_dwordx4 v4, s[40:43], s56 offen sc0 sc1 lds
    v_mfma_f32_16x16x32_bf16 v[176:179], v[140:143], v[108:111], v[176:179]
    v_mfma_f32_16x16x32_bf16 v[196:199], v[140:143], v[112:115], v[196:199]
    v_mfma_f32_16x16x32_bf16 v[216:219], v[140:143], v[116:119], v[216:219]
    v_mfma_f32_16x16x32_bf16 v[236:239], v[140:143], v[120:123], v[236:239]
    s_add_u32 s56, s52, 14336
    buffer_load_dwordx4 v[140:143], v4, s[40:43], s56 offen sc0 sc1
    s_add_u32 m0, s63, 0
    s_add_u32 s56, s53, 6720
    buffer_load_dwordx4 v4, s[40:43], s56 offen sc0 sc1 lds
    s_waitcnt lgkmcnt(0)
    v_cvt_pk_bf16_f32 v20, v28, v29
    v_cvt_pk_bf16_f32 v21, v30, v31
    v_cvt_pk_bf16_f32 v22, v32, v33
    v_cvt_pk_bf16_f32 v23, v34, v35
    v_cvt_pk_bf16_f32 v24, v36, v37
    v_cvt_pk_bf16_f32 v25, v38, v39
    v_cvt_pk_bf16_f32 v26, v40, v41
    v_cvt_pk_bf16_f32 v27, v42, v43
    v_mfma_f32_16x16x32_bf16 v[60:63], v[20:23], v[44:47], 0
    s_nop 0
    v_mfma_f32_16x16x32_bf16 v[64:67], v[24:27], v[44:47], 0
    s_add_u32 m0, s63, 1024
    s_add_u32 s56, s53, 7744
    buffer_load_dwordx4 v4, s[40:43], s56 offen sc0 sc1 lds
    v_mfma_f32_16x16x32_bf16 v[68:71], v[20:23], v[48:51], 0
    v_mfma_f32_16x16x32_bf16 v[72:75], v[24:27], v[48:51], 0
    s_add_u32 m0, s63, 8192
    s_add_u32 s56, s36, 3584
    buffer_load_dwordx4 v4, s[40:43], s56 offen sc0 sc1 lds
    v_mfma_f32_16x16x32_bf16 v[76:79], v[20:23], v[52:55], 0
    v_mfma_f32_16x16x32_bf16 v[80:83], v[24:27], v[52:55], 0
    s_add_u32 m0, s63, 11264
    s_add_u32 s56, s37, 3584
    buffer_load_dwordx4 v4, s[40:43], s56 offen sc0 sc1 lds
    v_mfma_f32_16x16x32_bf16 v[84:87], v[20:23], v[56:59], 0
    v_mfma_f32_16x16x32_bf16 v[88:91], v[24:27], v[56:59], 0
    s_add_u32 m0, s63, 14336
    s_add_u32 s56, s38, 3584
    buffer_load_dwordx4 v4, s[40:43], s56 offen sc0 sc1 lds
    s_waitcnt vmcnt(14)
    s_mov_b64 exec, s[66:67]
    ds_read_b128 v[28:31], v5 offset:5040
    ds_read_b64 v[44:45], v7 offset:1920
    ds_read_b64 v[48:49], v7 offset:4992
    ds_read_b64 v[52:53], v7 offset:8064
    ds_read_b64 v[56:57], v7 offset:11136
    s_mov_b64 exec, s[68:69]
    ds_read_b128 v[32:35], v5 offset:5056
    ds_read_b64 v[46:47], v7 offset:2048
    ds_read_b64 v[50:51], v7 offset:5120
    ds_read_b64 v[54:55], v7 offset:8192
    ds_read_b64 v[58:59], v7 offset:11264
    s_mov_b64 exec, s[64:65]
    ds_read_b128 v[36:39], v6 offset:5040
    s_mov_b64 exec, s[70:71]
    ds_read_b128 v[40:43], v6 offset:5056
    s_mov_b64 exec, -1
    v_add_f32 v11, s60, v65
    v_add_f32 v12, s60, v73
    v_add_f32 v13, s60, v81
    v_add_f32 v14, s60, v89
    v_rcp_f32 v11, v11
    v_rcp_f32 v12, v12
    v_rcp_f32 v13, v13
    v_rcp_f32 v14, v14
    v_mul_f32 v60, v60, v11
    v_mul_f32 v61, v61, v11
    v_mul_f32 v62, v62, v11
    v_mul_f32 v63, v63, v11
    v_mul_f32 v94, v64, v11
    v_cvt_pk_bf16_f32 v108, v60, v61
    v_cvt_pk_bf16_f32 v109, v62, v63
    s_add_u32 m0, s63, 17408
    s_add_u32 s56, s39, 3584
    buffer_load_dwordx4 v4, s[40:43], s56 offen sc0 sc1 lds
    v_mul_f32 v68, v68, v12
    v_mul_f32 v69, v69, v12
    v_mul_f32 v70, v70, v12
    v_mul_f32 v71, v71, v12
    v_mul_f32 v98, v72, v12
    v_cvt_pk_bf16_f32 v112, v68, v69
    v_cvt_pk_bf16_f32 v113, v70, v71
    s_add_u32 m0, s63, 2048
    s_add_u32 s56, s53, 8768
    buffer_load_dwordx4 v4, s[40:43], s56 offen sc0 sc1 lds
    v_mul_f32 v76, v76, v13
    v_mul_f32 v77, v77, v13
    v_mul_f32 v78, v78, v13
    v_mul_f32 v79, v79, v13
    v_mul_f32 v102, v80, v13
    v_cvt_pk_bf16_f32 v116, v76, v77
    v_cvt_pk_bf16_f32 v117, v78, v79
    s_add_u32 m0, s63, 3072
    s_add_u32 s56, s53, 9792
    buffer_load_dwordx4 v4, s[40:43], s56 offen sc0 sc1 lds
    v_mul_f32 v84, v84, v14
    v_mul_f32 v85, v85, v14
    v_mul_f32 v86, v86, v14
    v_mul_f32 v87, v87, v14
    v_mul_f32 v106, v88, v14
    v_cvt_pk_bf16_f32 v120, v84, v85
    v_cvt_pk_bf16_f32 v121, v86, v87
    s_add_u32 m0, s63, 4096
    s_add_u32 s56, s53, 10816
    buffer_load_dwordx4 v4, s[40:43], s56 offen sc0 sc1 lds
    s_waitcnt lgkmcnt(0)
    ds_write_b32 v10, v17 offset:16
    v_cvt_pk_bf16_f32 v20, v28, v29
    v_cvt_pk_bf16_f32 v21, v30, v31
    v_cvt_pk_bf16_f32 v22, v32, v33
    v_cvt_pk_bf16_f32 v23, v34, v35
    v_cvt_pk_bf16_f32 v24, v36, v37
    v_cvt_pk_bf16_f32 v25, v38, v39
    v_cvt_pk_bf16_f32 v26, v40, v41
    v_cvt_pk_bf16_f32 v27, v42, v43
    v_mfma_f32_16x16x32_bf16 v[60:63], v[20:23], v[44:47], 0
    s_nop 0
    v_mfma_f32_16x16x32_bf16 v[64:67], v[24:27], v[44:47], 0
    s_add_u32 m0, s63, 9216
    s_add_u32 s56, s36, 4608
    buffer_load_dwordx4 v4, s[40:43], s56 offen sc0 sc1 lds
    v_mfma_f32_16x16x32_bf16 v[68:71], v[20:23], v[48:51], 0
    v_mfma_f32_16x16x32_bf16 v[72:75], v[24:27], v[48:51], 0
    s_add_u32 m0, s63, 12288
    s_add_u32 s56, s37, 4608
    buffer_load_dwordx4 v4, s[40:43], s56 offen sc0 sc1 lds
    v_mfma_f32_16x16x32_bf16 v[76:79], v[20:23], v[52:55], 0
    v_mfma_f32_16x16x32_bf16 v[80:83], v[24:27], v[52:55], 0
    s_add_u32 m0, s63, 15360
    s_add_u32 s56, s38, 4608
    buffer_load_dwordx4 v4, s[40:43], s56 offen sc0 sc1 lds
    v_mfma_f32_16x16x32_bf16 v[84:87], v[20:23], v[56:59], 0
    v_mfma_f32_16x16x32_bf16 v[88:91], v[24:27], v[56:59], 0
    s_add_u32 m0, s63, 18432
    s_add_u32 s56, s39, 4608
    buffer_load_dwordx4 v4, s[40:43], s56 offen sc0 sc1 lds
    s_waitcnt vmcnt(11)
    v_add_u32 v5, s51, v5
    v_add_u32 v6, s51, v6
    v_add_u32 v7, s51, v7
    s_mov_b64 exec, s[66:67]
    ds_read_b128 v[28:31], v5 offset:0
    ds_read_b64 v[44:45], v7 offset:0
    ds_read_b64 v[48:49], v7 offset:3072
    ds_read_b64 v[52:53], v7 offset:6144
    ds_read_b64 v[56:57], v7 offset:9216
    s_mov_b64 exec, s[68:69]
    ds_read_b128 v[32:35], v5 offset:16
    ds_read_b64 v[46:47], v7 offset:128
    ds_read_b64 v[50:51], v7 offset:3200
    ds_read_b64 v[54:55], v7 offset:6272
    ds_read_b64 v[58:59], v7 offset:9344
    s_mov_b64 exec, s[64:65]
    ds_read_b128 v[36:39], v6 offset:0
    s_mov_b64 exec, s[70:71]
    ds_read_b128 v[40:43], v6 offset:16
    s_mov_b64 exec, -1
    v_add_f32 v11, s60, v65
    v_add_f32 v12, s60, v73
    v_add_f32 v13, s60, v81
    v_add_f32 v14, s60, v89
    v_rcp_f32 v11, v11
    v_rcp_f32 v12, v12
    v_rcp_f32 v13, v13
    v_rcp_f32 v14, v14
    v_mul_f32 v60, v60, v11
    v_mul_f32 v61, v61, v11
    v_mul_f32 v62, v62, v11
    v_mul_f32 v63, v63, v11
    v_mul_f32 v95, v64, v11
    v_cvt_pk_bf16_f32 v110, v60, v61
    v_cvt_pk_bf16_f32 v111, v62, v63
    s_add_u32 m0, s63, 5120
    s_add_u32 s56, s53, 11840
    buffer_load_dwordx4 v4, s[40:43], s56 offen sc0 sc1 lds
    v_mul_f32 v68, v68, v12
    v_mul_f32 v69, v69, v12
    v_mul_f32 v70, v70, v12
    v_mul_f32 v71, v71, v12
    v_mul_f32 v99, v72, v12
    v_cvt_pk_bf16_f32 v114, v68, v69
    v_cvt_pk_bf16_f32 v115, v70, v71
    s_add_u32 m0, s63, 6144
    s_add_u32 s56, s53, 12864
    buffer_load_dwordx4 v4, s[40:43], s56 offen sc0 sc1 lds
    v_mul_f32 v76, v76, v13
    v_mul_f32 v77, v77, v13
    v_mul_f32 v78, v78, v13
    v_mul_f32 v79, v79, v13
    v_mul_f32 v103, v80, v13
    v_cvt_pk_bf16_f32 v118, v76, v77
    v_cvt_pk_bf16_f32 v119, v78, v79
    v_mul_f32 v84, v84, v14
    v_mul_f32 v85, v85, v14
    v_mul_f32 v86, v86, v14
    v_mul_f32 v87, v87, v14
    v_mul_f32 v107, v88, v14
    v_cvt_pk_bf16_f32 v122, v84, v85
    v_cvt_pk_bf16_f32 v123, v86, v87
    v_mfma_f32_16x16x32_bf16 v[160:163], v[144:147], v[108:111], v[160:163]
    v_mfma_f32_16x16x32_bf16 v[180:183], v[144:147], v[112:115], v[180:183]
    v_mfma_f32_16x16x32_bf16 v[200:203], v[144:147], v[116:119], v[200:203]
    v_mfma_f32_16x16x32_bf16 v[220:223], v[144:147], v[120:123], v[220:223]
    s_add_u32 s56, s52, 15360
    buffer_load_dwordx4 v[144:147], v4, s[40:43], s56 offen sc0 sc1
    v_mfma_f32_16x16x32_bf16 v[164:167], v[148:151], v[108:111], v[164:167]
    v_mfma_f32_16x16x32_bf16 v[184:187], v[148:151], v[112:115], v[184:187]
    v_mfma_f32_16x16x32_bf16 v[204:207], v[148:151], v[116:119], v[204:207]
    v_mfma_f32_16x16x32_bf16 v[224:227], v[148:151], v[120:123], v[224:227]
    s_add_u32 s56, s52, 16384
    buffer_load_dwordx4 v[148:151], v4, s[40:43], s56 offen sc0 sc1
    v_mfma_f32_16x16x32_bf16 v[168:171], v[152:155], v[108:111], v[168:171]
    v_mfma_f32_16x16x32_bf16 v[188:191], v[152:155], v[112:115], v[188:191]
    v_mfma_f32_16x16x32_bf16 v[208:211], v[152:155], v[116:119], v[208:211]
    v_mfma_f32_16x16x32_bf16 v[228:231], v[152:155], v[120:123], v[228:231]
    s_add_u32 s56, s52, 17408
    buffer_load_dwordx4 v[152:155], v4, s[40:43], s56 offen sc0 sc1
    v_mfma_f32_16x16x32_bf16 v[172:175], v[156:159], v[108:111], v[172:175]
    v_mfma_f32_16x16x32_bf16 v[192:195], v[156:159], v[112:115], v[192:195]
    v_mfma_f32_16x16x32_bf16 v[212:215], v[156:159], v[116:119], v[212:215]
    v_mfma_f32_16x16x32_bf16 v[232:235], v[156:159], v[120:123], v[232:235]
    s_add_u32 s56, s52, 18432
    buffer_load_dwordx4 v[156:159], v4, s[40:43], s56 offen sc0 sc1
    v_mfma_f32_16x16x32_bf16 v[176:179], v[240:243], v[108:111], v[176:179]
    v_mfma_f32_16x16x32_bf16 v[196:199], v[240:243], v[112:115], v[196:199]
    v_mfma_f32_16x16x32_bf16 v[216:219], v[240:243], v[116:119], v[216:219]
    v_mfma_f32_16x16x32_bf16 v[236:239], v[240:243], v[120:123], v[236:239]
    s_add_u32 s56, s52, 19456
    buffer_load_dwordx4 v[240:243], v4, s[40:43], s56 offen sc0 sc1
    v_cvt_pk_bf16_f32 v108, v92, v93
    v_cvt_pk_bf16_f32 v109, v94, v95
    v_cvt_pk_bf16_f32 v112, v96, v97
    v_cvt_pk_bf16_f32 v113, v98, v99
    v_cvt_pk_bf16_f32 v116, v100, v101
    v_cvt_pk_bf16_f32 v117, v102, v103
    v_cvt_pk_bf16_f32 v120, v104, v105
    v_cvt_pk_bf16_f32 v121, v106, v107
    s_waitcnt lgkmcnt(0)
    v_cvt_pk_bf16_f32 v20, v28, v29
    v_cvt_pk_bf16_f32 v21, v30, v31
    v_cvt_pk_bf16_f32 v22, v32, v33
    v_cvt_pk_bf16_f32 v23, v34, v35
    v_cvt_pk_bf16_f32 v24, v36, v37
    v_cvt_pk_bf16_f32 v25, v38, v39
    v_cvt_pk_bf16_f32 v26, v40, v41
    v_cvt_pk_bf16_f32 v27, v42, v43
    v_mfma_f32_16x16x32_bf16 v[60:63], v[20:23], v[44:47], 0
    s_nop 0
    v_mfma_f32_16x16x32_bf16 v[64:67], v[24:27], v[44:47], 0
    v_mfma_f32_16x16x32_bf16 v[68:71], v[20:23], v[48:51], 0
    v_mfma_f32_16x16x32_bf16 v[72:75], v[24:27], v[48:51], 0
    v_mfma_f32_16x16x32_bf16 v[76:79], v[20:23], v[52:55], 0
    v_mfma_f32_16x16x32_bf16 v[80:83], v[24:27], v[52:55], 0
    v_mfma_f32_16x16x32_bf16 v[84:87], v[20:23], v[56:59], 0
    v_mfma_f32_16x16x32_bf16 v[88:91], v[24:27], v[56:59], 0
    s_waitcnt vmcnt(12)
    s_mov_b64 exec, s[66:67]
    ds_read_b128 v[28:31], v5 offset:1680
    ds_read_b64 v[44:45], v7 offset:640
    ds_read_b64 v[48:49], v7 offset:3712
    ds_read_b64 v[52:53], v7 offset:6784
    ds_read_b64 v[56:57], v7 offset:9856
    s_mov_b64 exec, s[68:69]
    ds_read_b128 v[32:35], v5 offset:1696
    ds_read_b64 v[46:47], v7 offset:768
    ds_read_b64 v[50:51], v7 offset:3840
    ds_read_b64 v[54:55], v7 offset:6912
    ds_read_b64 v[58:59], v7 offset:9984
    s_mov_b64 exec, s[64:65]
    ds_read_b128 v[36:39], v6 offset:1680
    s_mov_b64 exec, s[70:71]
    ds_read_b128 v[40:43], v6 offset:1696
    s_mov_b64 exec, -1
    v_add_f32 v11, s60, v65
    v_add_f32 v12, s60, v73
    v_add_f32 v13, s60, v81
    v_add_f32 v14, s60, v89
    v_rcp_f32 v11, v11
    v_rcp_f32 v12, v12
    v_rcp_f32 v13, v13
    v_rcp_f32 v14, v14
    v_mul_f32 v60, v60, v11
    v_mul_f32 v61, v61, v11
    v_mul_f32 v62, v62, v11
    v_mul_f32 v63, v63, v11
    v_mul_f32 v92, v64, v11
    v_cvt_pk_bf16_f32 v110, v60, v61
    v_cvt_pk_bf16_f32 v111, v62, v63
    v_mul_f32 v68, v68, v12
    v_mul_f32 v69, v69, v12
    v_mul_f32 v70, v70, v12
    v_mul_f32 v71, v71, v12
    v_mul_f32 v96, v72, v12
    v_cvt_pk_bf16_f32 v114, v68, v69
    v_cvt_pk_bf16_f32 v115, v70, v71
    v_mul_f32 v76, v76, v13
    v_mul_f32 v77, v77, v13
    v_mul_f32 v78, v78, v13
    v_mul_f32 v79, v79, v13
    v_mul_f32 v100, v80, v13
    v_cvt_pk_bf16_f32 v118, v76, v77
    v_cvt_pk_bf16_f32 v119, v78, v79
    v_mul_f32 v84, v84, v14
    v_mul_f32 v85, v85, v14
    v_mul_f32 v86, v86, v14
    v_mul_f32 v87, v87, v14
    v_mul_f32 v104, v88, v14
    v_cvt_pk_bf16_f32 v122, v84, v85
    v_cvt_pk_bf16_f32 v123, v86, v87
    s_waitcnt vmcnt(20)
    v_mfma_f32_16x16x32_bf16 v[160:163], v[124:127], v[108:111], v[160:163]
    v_mfma_f32_16x16x32_bf16 v[180:183], v[124:127], v[112:115], v[180:183]
    v_mfma_f32_16x16x32_bf16 v[200:203], v[124:127], v[116:119], v[200:203]
    v_mfma_f32_16x16x32_bf16 v[220:223], v[124:127], v[120:123], v[220:223]
    s_add_u32 s56, s52, 20480
    buffer_load_dwordx4 v[124:127], v4, s[40:43], s56 offen sc0 sc1
    v_mfma_f32_16x16x32_bf16 v[164:167], v[128:131], v[108:111], v[164:167]
    v_mfma_f32_16x16x32_bf16 v[184:187], v[128:131], v[112:115], v[184:187]
    v_mfma_f32_16x16x32_bf16 v[204:207], v[128:131], v[116:119], v[204:207]
    v_mfma_f32_16x16x32_bf16 v[224:227], v[128:131], v[120:123], v[224:227]
    s_add_u32 s56, s52, 21504
    buffer_load_dwordx4 v[128:131], v4, s[40:43], s56 offen sc0 sc1
    v_mfma_f32_16x16x32_bf16 v[168:171], v[132:135], v[108:111], v[168:171]
    v_mfma_f32_16x16x32_bf16 v[188:191], v[132:135], v[112:115], v[188:191]
    v_mfma_f32_16x16x32_bf16 v[208:211], v[132:135], v[116:119], v[208:211]
    v_mfma_f32_16x16x32_bf16 v[228:231], v[132:135], v[120:123], v[228:231]
    s_add_u32 s56, s52, 22528
    buffer_load_dwordx4 v[132:135], v4, s[40:43], s56 offen sc0 sc1
    v_mfma_f32_16x16x32_bf16 v[172:175], v[136:139], v[108:111], v[172:175]
    v_mfma_f32_16x16x32_bf16 v[192:195], v[136:139], v[112:115], v[192:195]
    v_mfma_f32_16x16x32_bf16 v[212:215], v[136:139], v[116:119], v[212:215]
    v_mfma_f32_16x16x32_bf16 v[232:235], v[136:139], v[120:123], v[232:235]
    s_add_u32 s56, s52, 23552
    buffer_load_dwordx4 v[136:139], v4, s[40:43], s56 offen sc0 sc1
    v_mfma_f32_16x16x32_bf16 v[176:179], v[140:143], v[108:111], v[176:179]
    v_mfma_f32_16x16x32_bf16 v[196:199], v[140:143], v[112:115], v[196:199]
    v_mfma_f32_16x16x32_bf16 v[216:219], v[140:143], v[116:119], v[216:219]
    v_mfma_f32_16x16x32_bf16 v[236:239], v[140:143], v[120:123], v[236:239]
    s_add_u32 s56, s52, 24576
    buffer_load_dwordx4 v[140:143], v4, s[40:43], s56 offen sc0 sc1
    s_waitcnt lgkmcnt(0)
    v_cvt_pk_bf16_f32 v20, v28, v29
    v_cvt_pk_bf16_f32 v21, v30, v31
    v_cvt_pk_bf16_f32 v22, v32, v33
    v_cvt_pk_bf16_f32 v23, v34, v35
    v_cvt_pk_bf16_f32 v24, v36, v37
    v_cvt_pk_bf16_f32 v25, v38, v39
    v_cvt_pk_bf16_f32 v26, v40, v41
    v_cvt_pk_bf16_f32 v27, v42, v43
    v_mfma_f32_16x16x32_bf16 v[60:63], v[20:23], v[44:47], 0
    s_nop 0
    v_mfma_f32_16x16x32_bf16 v[64:67], v[24:27], v[44:47], 0
    v_mfma_f32_16x16x32_bf16 v[68:71], v[20:23], v[48:51], 0
    v_mfma_f32_16x16x32_bf16 v[72:75], v[24:27], v[48:51], 0
    v_mfma_f32_16x16x32_bf16 v[76:79], v[20:23], v[52:55], 0
    v_mfma_f32_16x16x32_bf16 v[80:83], v[24:27], v[52:55], 0
    v_mfma_f32_16x16x32_bf16 v[84:87], v[20:23], v[56:59], 0
    v_mfma_f32_16x16x32_bf16 v[88:91], v[24:27], v[56:59], 0
    s_waitcnt vmcnt(16)
    s_mov_b64 exec, s[66:67]
    ds_read_b128 v[28:31], v5 offset:3360
    ds_read_b64 v[44:45], v7 offset:1280
    ds_read_b64 v[48:49], v7 offset:4352
    ds_read_b64 v[52:53], v7 offset:7424
    ds_read_b64 v[56:57], v7 offset:10496
    s_mov_b64 exec, s[68:69]
    ds_read_b128 v[32:35], v5 offset:3376
    ds_read_b64 v[46:47], v7 offset:1408
    ds_read_b64 v[50:51], v7 offset:4480
    ds_read_b64 v[54:55], v7 offset:7552
    ds_read_b64 v[58:59], v7 offset:10624
    s_mov_b64 exec, s[64:65]
    ds_read_b128 v[36:39], v6 offset:3360
    s_mov_b64 exec, s[70:71]
    ds_read_b128 v[40:43], v6 offset:3376
    s_mov_b64 exec, -1
    v_add_f32 v11, s60, v65
    v_add_f32 v12, s60, v73
    v_add_f32 v13, s60, v81
    v_add_f32 v14, s60, v89
    v_rcp_f32 v11, v11
    v_rcp_f32 v12, v12
    v_rcp_f32 v13, v13
    v_rcp_f32 v14, v14
    v_mul_f32 v60, v60, v11
    v_mul_f32 v61, v61, v11
    v_mul_f32 v62, v62, v11
    v_mul_f32 v63, v63, v11
    v_mul_f32 v93, v64, v11
    v_cvt_pk_bf16_f32 v108, v60, v61
    v_cvt_pk_bf16_f32 v109, v62, v63
    v_mul_f32 v68, v68, v12
    v_mul_f32 v69, v69, v12
    v_mul_f32 v70, v70, v12
    v_mul_f32 v71, v71, v12
    v_mul_f32 v97, v72, v12
    v_cvt_pk_bf16_f32 v112, v68, v69
    v_cvt_pk_bf16_f32 v113, v70, v71
    v_mul_f32 v76, v76, v13
    v_mul_f32 v77, v77, v13
    v_mul_f32 v78, v78, v13
    v_mul_f32 v79, v79, v13
    v_mul_f32 v101, v80, v13
    v_cvt_pk_bf16_f32 v116, v76, v77
    v_cvt_pk_bf16_f32 v117, v78, v79
    v_mul_f32 v84, v84, v14
    v_mul_f32 v85, v85, v14
    v_mul_f32 v86, v86, v14
    v_mul_f32 v87, v87, v14
    v_mul_f32 v105, v88, v14
    v_cvt_pk_bf16_f32 v120, v84, v85
    v_cvt_pk_bf16_f32 v121, v86, v87
    s_waitcnt lgkmcnt(0)
    v_cvt_pk_bf16_f32 v20, v28, v29
    v_cvt_pk_bf16_f32 v21, v30, v31
    v_cvt_pk_bf16_f32 v22, v32, v33
    v_cvt_pk_bf16_f32 v23, v34, v35
    v_cvt_pk_bf16_f32 v24, v36, v37
    v_cvt_pk_bf16_f32 v25, v38, v39
    v_cvt_pk_bf16_f32 v26, v40, v41
    v_cvt_pk_bf16_f32 v27, v42, v43
    v_mfma_f32_16x16x32_bf16 v[60:63], v[20:23], v[44:47], 0
    s_nop 0
    v_mfma_f32_16x16x32_bf16 v[64:67], v[24:27], v[44:47], 0
    v_mfma_f32_16x16x32_bf16 v[68:71], v[20:23], v[48:51], 0
    v_mfma_f32_16x16x32_bf16 v[72:75], v[24:27], v[48:51], 0
    v_mfma_f32_16x16x32_bf16 v[76:79], v[20:23], v[52:55], 0
    v_mfma_f32_16x16x32_bf16 v[80:83], v[24:27], v[52:55], 0
    v_mfma_f32_16x16x32_bf16 v[84:87], v[20:23], v[56:59], 0
    v_mfma_f32_16x16x32_bf16 v[88:91], v[24:27], v[56:59], 0
    s_waitcnt vmcnt(10)
    s_mov_b64 exec, s[66:67]
    ds_read_b128 v[28:31], v5 offset:5040
    ds_read_b64 v[44:45], v7 offset:1920
    ds_read_b64 v[48:49], v7 offset:4992
    ds_read_b64 v[52:53], v7 offset:8064
    ds_read_b64 v[56:57], v7 offset:11136
    s_mov_b64 exec, s[68:69]
    ds_read_b128 v[32:35], v5 offset:5056
    ds_read_b64 v[46:47], v7 offset:2048
    ds_read_b64 v[50:51], v7 offset:5120
    ds_read_b64 v[54:55], v7 offset:8192
    ds_read_b64 v[58:59], v7 offset:11264
    s_mov_b64 exec, s[64:65]
    ds_read_b128 v[36:39], v6 offset:5040
    s_mov_b64 exec, s[70:71]
    ds_read_b128 v[40:43], v6 offset:5056
    s_mov_b64 exec, -1
    v_add_f32 v11, s60, v65
    v_add_f32 v12, s60, v73
    v_add_f32 v13, s60, v81
    v_add_f32 v14, s60, v89
    v_rcp_f32 v11, v11
    v_rcp_f32 v12, v12
    v_rcp_f32 v13, v13
    v_rcp_f32 v14, v14
    v_mul_f32 v60, v60, v11
    v_mul_f32 v61, v61, v11
    v_mul_f32 v62, v62, v11
    v_mul_f32 v63, v63, v11
    v_mul_f32 v94, v64, v11
    v_cvt_pk_bf16_f32 v110, v60, v61
    v_cvt_pk_bf16_f32 v111, v62, v63
    v_mul_f32 v68, v68, v12
    v_mul_f32 v69, v69, v12
    v_mul_f32 v70, v70, v12
    v_mul_f32 v71, v71, v12
    v_mul_f32 v98, v72, v12
    v_cvt_pk_bf16_f32 v114, v68, v69
    v_cvt_pk_bf16_f32 v115, v70, v71
    v_mul_f32 v76, v76, v13
    v_mul_f32 v77, v77, v13
    v_mul_f32 v78, v78, v13
    v_mul_f32 v79, v79, v13
    v_mul_f32 v102, v80, v13
    v_cvt_pk_bf16_f32 v118, v76, v77
    v_cvt_pk_bf16_f32 v119, v78, v79
    v_mul_f32 v84, v84, v14
    v_mul_f32 v85, v85, v14
    v_mul_f32 v86, v86, v14
    v_mul_f32 v87, v87, v14
    v_mul_f32 v106, v88, v14
    v_cvt_pk_bf16_f32 v122, v84, v85
    v_cvt_pk_bf16_f32 v123, v86, v87
    s_waitcnt vmcnt(5)
    v_mfma_f32_16x16x32_bf16 v[160:163], v[144:147], v[108:111], v[160:163]
    v_mfma_f32_16x16x32_bf16 v[180:183], v[144:147], v[112:115], v[180:183]
    v_mfma_f32_16x16x32_bf16 v[200:203], v[144:147], v[116:119], v[200:203]
    v_mfma_f32_16x16x32_bf16 v[220:223], v[144:147], v[120:123], v[220:223]
    v_mfma_f32_16x16x32_bf16 v[164:167], v[148:151], v[108:111], v[164:167]
    v_mfma_f32_16x16x32_bf16 v[184:187], v[148:151], v[112:115], v[184:187]
    v_mfma_f32_16x16x32_bf16 v[204:207], v[148:151], v[116:119], v[204:207]
    v_mfma_f32_16x16x32_bf16 v[224:227], v[148:151], v[120:123], v[224:227]
    v_mfma_f32_16x16x32_bf16 v[168:171], v[152:155], v[108:111], v[168:171]
    v_mfma_f32_16x16x32_bf16 v[188:191], v[152:155], v[112:115], v[188:191]
    v_mfma_f32_16x16x32_bf16 v[208:211], v[152:155], v[116:119], v[208:211]
    v_mfma_f32_16x16x32_bf16 v[228:231], v[152:155], v[120:123], v[228:231]
    v_mfma_f32_16x16x32_bf16 v[172:175], v[156:159], v[108:111], v[172:175]
    v_mfma_f32_16x16x32_bf16 v[192:195], v[156:159], v[112:115], v[192:195]
    v_mfma_f32_16x16x32_bf16 v[212:215], v[156:159], v[116:119], v[212:215]
    v_mfma_f32_16x16x32_bf16 v[232:235], v[156:159], v[120:123], v[232:235]
    v_mfma_f32_16x16x32_bf16 v[176:179], v[240:243], v[108:111], v[176:179]
    v_mfma_f32_16x16x32_bf16 v[196:199], v[240:243], v[112:115], v[196:199]
    v_mfma_f32_16x16x32_bf16 v[216:219], v[240:243], v[116:119], v[216:219]
    v_mfma_f32_16x16x32_bf16 v[236:239], v[240:243], v[120:123], v[236:239]
    s_lshl_b32 s56, s32, 6
    s_lshl_b32 s58, s34, 4
    s_add_u32 s56, s56, s58
    s_mul_i32 s56, s56, 1280
    s_mul_i32 s58, s33, 160
    s_add_u32 s61, s56, s58
    v_mul_u32_u24 v254, 1280, v2
    v_lshl_add_u32 v254, v3, 3, v254
    buffer_load_dwordx2 v[244:245], v254, s[24:27], s61 offen offset:96
    buffer_load_dwordx2 v[246:247], v254, s[24:27], s61 offen offset:128
    s_mov_b32 s28, s18
    s_mov_b32 s29, s19
    s_mov_b32 s30, 2621440
    s_mov_b32 s31, 0x20000
    s_waitcnt lgkmcnt(0)
    v_cvt_pk_bf16_f32 v20, v28, v29
    v_cvt_pk_bf16_f32 v21, v30, v31
    v_cvt_pk_bf16_f32 v22, v32, v33
    v_cvt_pk_bf16_f32 v23, v34, v35
    v_cvt_pk_bf16_f32 v24, v36, v37
    v_cvt_pk_bf16_f32 v25, v38, v39
    v_cvt_pk_bf16_f32 v26, v40, v41
    v_cvt_pk_bf16_f32 v27, v42, v43
    v_mfma_f32_16x16x32_bf16 v[60:63], v[20:23], v[44:47], 0
    s_nop 0
    v_mfma_f32_16x16x32_bf16 v[64:67], v[24:27], v[44:47], 0
    v_mfma_f32_16x16x32_bf16 v[68:71], v[20:23], v[48:51], 0
    v_mfma_f32_16x16x32_bf16 v[72:75], v[24:27], v[48:51], 0
    v_mfma_f32_16x16x32_bf16 v[76:79], v[20:23], v[52:55], 0
    v_mfma_f32_16x16x32_bf16 v[80:83], v[24:27], v[52:55], 0
    v_mfma_f32_16x16x32_bf16 v[84:87], v[20:23], v[56:59], 0
    v_mfma_f32_16x16x32_bf16 v[88:91], v[24:27], v[56:59], 0
    s_nop 1
    v_add_f32 v11, s60, v65
    s_nop 0
    v_add_f32 v12, s60, v73
    s_nop 0
    v_add_f32 v13, s60, v81
    s_nop 0
    v_add_f32 v14, s60, v89
    v_rcp_f32 v11, v11
    v_rcp_f32 v12, v12
    v_rcp_f32 v13, v13
    v_rcp_f32 v14, v14
    v_mul_f32 v60, v60, v11
    v_mul_f32 v61, v61, v11
    v_mul_f32 v62, v62, v11
    v_mul_f32 v63, v63, v11
    v_mul_f32 v95, v64, v11
    v_cvt_pk_bf16_f32 v108, v60, v61
    v_cvt_pk_bf16_f32 v109, v62, v63
    v_mul_f32 v68, v68, v12
    v_mul_f32 v69, v69, v12
    v_mul_f32 v70, v70, v12
    v_mul_f32 v71, v71, v12
    v_mul_f32 v99, v72, v12
    v_cvt_pk_bf16_f32 v112, v68, v69
    v_cvt_pk_bf16_f32 v113, v70, v71
    v_mul_f32 v76, v76, v13
    v_mul_f32 v77, v77, v13
    v_mul_f32 v78, v78, v13
    v_mul_f32 v79, v79, v13
    v_mul_f32 v103, v80, v13
    v_cvt_pk_bf16_f32 v116, v76, v77
    v_cvt_pk_bf16_f32 v117, v78, v79
    v_mul_f32 v84, v84, v14
    v_mul_f32 v85, v85, v14
    v_mul_f32 v86, v86, v14
    v_mul_f32 v87, v87, v14
    v_mul_f32 v107, v88, v14
    v_cvt_pk_bf16_f32 v120, v84, v85
    v_cvt_pk_bf16_f32 v121, v86, v87
    v_cvt_pk_bf16_f32 v110, v92, v93
    v_cvt_pk_bf16_f32 v111, v94, v95
    v_cvt_pk_bf16_f32 v114, v96, v97
    v_cvt_pk_bf16_f32 v115, v98, v99
    v_cvt_pk_bf16_f32 v118, v100, v101
    v_cvt_pk_bf16_f32 v119, v102, v103
    v_cvt_pk_bf16_f32 v122, v104, v105
    v_cvt_pk_bf16_f32 v123, v106, v107
    s_waitcnt vmcnt(2)
    v_mfma_f32_16x16x32_bf16 v[160:163], v[124:127], v[108:111], v[160:163]
    v_mfma_f32_16x16x32_bf16 v[180:183], v[124:127], v[112:115], v[180:183]
    v_mfma_f32_16x16x32_bf16 v[200:203], v[124:127], v[116:119], v[200:203]
    v_mfma_f32_16x16x32_bf16 v[220:223], v[124:127], v[120:123], v[220:223]
    v_mfma_f32_16x16x32_bf16 v[164:167], v[128:131], v[108:111], v[164:167]
    v_mfma_f32_16x16x32_bf16 v[184:187], v[128:131], v[112:115], v[184:187]
    v_mfma_f32_16x16x32_bf16 v[204:207], v[128:131], v[116:119], v[204:207]
    v_mfma_f32_16x16x32_bf16 v[224:227], v[128:131], v[120:123], v[224:227]
    v_mfma_f32_16x16x32_bf16 v[168:171], v[132:135], v[108:111], v[168:171]
    v_mfma_f32_16x16x32_bf16 v[188:191], v[132:135], v[112:115], v[188:191]
    v_mfma_f32_16x16x32_bf16 v[208:211], v[132:135], v[116:119], v[208:211]
    v_mfma_f32_16x16x32_bf16 v[228:231], v[132:135], v[120:123], v[228:231]
    v_mfma_f32_16x16x32_bf16 v[172:175], v[136:139], v[108:111], v[172:175]
    v_mfma_f32_16x16x32_bf16 v[192:195], v[136:139], v[112:115], v[192:195]
    v_mfma_f32_16x16x32_bf16 v[212:215], v[136:139], v[116:119], v[212:215]
    v_mfma_f32_16x16x32_bf16 v[232:235], v[136:139], v[120:123], v[232:235]
    v_mfma_f32_16x16x32_bf16 v[176:179], v[140:143], v[108:111], v[176:179]
    v_mfma_f32_16x16x32_bf16 v[196:199], v[140:143], v[112:115], v[196:199]
    v_mfma_f32_16x16x32_bf16 v[216:219], v[140:143], v[116:119], v[216:219]
    v_mfma_f32_16x16x32_bf16 v[236:239], v[140:143], v[120:123], v[236:239]
    s_cmp_eq_u32 s34, 0
    s_cbranch_scc1 P2_SRW0
    s_sub_u32 s56, 3, s34
    s_and_b32 s56, s56, 3
    s_mul_i32 s56, s56, 5120
    s_add_u32 s56, s56, s63
    v_add_u32 v12, s56, v4
    ds_write_b128 v12, v[160:163] offset:0
    ds_write_b128 v12, v[164:167] offset:1024
    ds_write_b128 v12, v[168:171] offset:2048
    ds_write_b128 v12, v[172:175] offset:3072
    ds_write_b128 v12, v[176:179] offset:4096
    s_branch P2_SRX0
P2_SRW0:
    s_nop 7
    v_add_u32 v12, s63, v4
    ds_write_b128 v12, v[160:163] offset:15360
    ds_write_b128 v12, v[164:167] offset:16384
    ds_write_b128 v12, v[168:171] offset:17408
    v_mov_b32 v16, v172
    v_mov_b32 v17, v173
    v_mov_b32 v18, v174
    v_mov_b32 v19, v175
    v_mov_b32 v20, v176
    v_mov_b32 v21, v177
    v_mov_b32 v22, v178
    v_mov_b32 v23, v179
P2_SRX0:
    s_cmp_eq_u32 s34, 1
    s_cbranch_scc1 P2_SRW1
    s_sub_u32 s56, 4, s34
    s_and_b32 s56, s56, 3
    s_mul_i32 s56, s56, 5120
    s_add_u32 s56, s56, s63
    v_add_u32 v12, s56, v4
    ds_write_b128 v12, v[180:183] offset:0
    ds_write_b128 v12, v[184:187] offset:1024
    ds_write_b128 v12, v[188:191] offset:2048
    ds_write_b128 v12, v[192:195] offset:3072
    ds_write_b128 v12, v[196:199] offset:4096
    s_branch P2_SRX1
P2_SRW1:
    s_nop 7
    v_add_u32 v12, s63, v4
    ds_write_b128 v12, v[180:183] offset:15360
    ds_write_b128 v12, v[184:187] offset:16384
    ds_write_b128 v12, v[188:191] offset:17408
    v_mov_b32 v16, v192
    v_mov_b32 v17, v193
    v_mov_b32 v18, v194
    v_mov_b32 v19, v195
    v_mov_b32 v20, v196
    v_mov_b32 v21, v197
    v_mov_b32 v22, v198
    v_mov_b32 v23, v199
P2_SRX1:
    s_cmp_eq_u32 s34, 2
    s_cbranch_scc1 P2_SRW2
    s_sub_u32 s56, 5, s34
    s_and_b32 s56, s56, 3
    s_mul_i32 s56, s56, 5120
    s_add_u32 s56, s56, s63
    v_add_u32 v12, s56, v4
    ds_write_b128 v12, v[200:203] offset:0
    ds_write_b128 v12, v[204:207] offset:1024
    ds_write_b128 v12, v[208:211] offset:2048
    ds_write_b128 v12, v[212:215] offset:3072
    ds_write_b128 v12, v[216:219] offset:4096
    s_branch P2_SRX2
P2_SRW2:
    s_nop 7
    v_add_u32 v12, s63, v4
    ds_write_b128 v12, v[200:203] offset:15360
    ds_write_b128 v12, v[204:207] offset:16384
    ds_write_b128 v12, v[208:211] offset:17408
    v_mov_b32 v16, v212
    v_mov_b32 v17, v213
    v_mov_b32 v18, v214
    v_mov_b32 v19, v215
    v_mov_b32 v20, v216
    v_mov_b32 v21, v217
    v_mov_b32 v22, v218
    v_mov_b32 v23, v219
P2_SRX2:
    s_cmp_eq_u32 s34, 3
    s_cbranch_scc1 P2_SRW3
    s_sub_u32 s56, 6, s34
    s_and_b32 s56, s56, 3
    s_mul_i32 s56, s56, 5120
    s_add_u32 s56, s56, s63
    v_add_u32 v12, s56, v4
    ds_write_b128 v12, v[220:223] offset:0
    ds_write_b128 v12, v[224:227] offset:1024
    ds_write_b128 v12, v[228:231] offset:2048
    ds_write_b128 v12, v[232:235] offset:3072
    ds_write_b128 v12, v[236:239] offset:4096
    s_branch P2_SRX3
P2_SRW3:
    s_nop 7
    v_add_u32 v12, s63, v4
    ds_write_b128 v12, v[220:223] offset:15360
    ds_write_b128 v12, v[224:227] offset:16384
    ds_write_b128 v12, v[228:231] offset:17408
    v_mov_b32 v16, v232
    v_mov_b32 v17, v233
    v_mov_b32 v18, v234
    v_mov_b32 v19, v235
    v_mov_b32 v20, v236
    v_mov_b32 v21, v237
    v_mov_b32 v22, v238
    v_mov_b32 v23, v239
P2_SRX3:
    s_sub_u32 s56, s34, 1
    s_and_b32 s56, s56, 3
    s_mul_i32 s57, s56, 20480
    s_add_u32 s57, s57, 80896
    v_add_u32 v5, s57, v4
    s_mul_i32 s57, s56, 19456
    s_add_u32 s57, s57, 3072
    v_add_u32 v8, s57, v4
    s_sub_u32 s56, s34, 2
    s_and_b32 s56, s56, 3
    s_mul_i32 s57, s56, 20480
    s_add_u32 s57, s57, 86016
    v_add_u32 v6, s57, v4
    s_mul_i32 s57, s56, 19456
    s_add_u32 s57, s57, 8192
    v_add_u32 v9, s57, v4
    s_sub_u32 s56, s34, 3
    s_and_b32 s56, s56, 3
    s_mul_i32 s57, s56, 20480
    s_add_u32 s57, s57, 91136
    v_add_u32 v7, s57, v4
    s_mul_i32 s57, s56, 19456
    s_add_u32 s57, s57, 13312
    v_add_u32 v10, s57, v4
    s_mul_i32 s57, s34, 19456
    s_add_u32 s57, s57, 15360
    s_mov_b32 s62, 0xbfb8aa3b
    s_waitcnt vmcnt(0)
    v_lshlrev_b32 v28, 16, v244
    v_and_b32 v29, 0xffff0000, v244
    v_lshlrev_b32 v30, 16, v245
    v_and_b32 v31, 0xffff0000, v245
    v_lshlrev_b32 v32, 16, v246
    v_and_b32 v33, 0xffff0000, v246
    v_lshlrev_b32 v34, 16, v247
    v_and_b32 v35, 0xffff0000, v247
    s_waitcnt lgkmcnt(0)
    v_add_u32 v12, s57, v4
    s_barrier
    ds_read_b128 v[40:43], v8 offset:0
    ds_read_b128 v[44:47], v8 offset:1024
    ds_read_b128 v[48:51], v9 offset:0
    ds_read_b128 v[52:55], v9 offset:1024
    ds_read_b128 v[56:59], v10 offset:0
    ds_read_b128 v[60:63], v10 offset:1024
    ds_read_b128 v[64:67], v12 offset:0
    ds_read_b128 v[68:71], v12 offset:1024
    ds_read_b128 v[72:75], v5 offset:0
    ds_read_b128 v[76:79], v5 offset:1024
    ds_read_b128 v[80:83], v6 offset:0
    ds_read_b128 v[84:87], v6 offset:1024
    ds_read_b128 v[88:91], v7 offset:0
    ds_read_b128 v[92:95], v7 offset:1024
    s_waitcnt lgkmcnt(6)
    v_add_f32 v40, v40, v48
    v_add_f32 v56, v56, v64
    v_add_f32 v41, v41, v49
    v_add_f32 v57, v57, v65
    v_add_f32 v42, v42, v50
    v_add_f32 v58, v58, v66
    v_add_f32 v43, v43, v51
    v_add_f32 v59, v59, v67
    v_add_f32 v44, v44, v52
    v_add_f32 v60, v60, v68
    v_add_f32 v45, v45, v53
    v_add_f32 v61, v61, v69
    v_add_f32 v46, v46, v54
    v_add_f32 v62, v62, v70
    v_add_f32 v47, v47, v55
    v_add_f32 v63, v63, v71
    v_add_f32 v40, v40, v56
    v_add_f32 v41, v41, v57
    v_add_f32 v42, v42, v58
    v_add_f32 v43, v43, v59
    v_add_f32 v44, v44, v60
    v_add_f32 v45, v45, v61
    v_add_f32 v46, v46, v62
    v_add_f32 v47, v47, v63
    v_mul_f32 v48, s62, v40
    v_mul_f32 v49, s62, v41
    v_mul_f32 v50, s62, v42
    v_mul_f32 v51, s62, v43
    v_mul_f32 v52, s62, v44
    v_mul_f32 v53, s62, v45
    v_mul_f32 v54, s62, v46
    v_mul_f32 v55, s62, v47
    v_exp_f32 v48, v48
    v_exp_f32 v49, v49
    v_exp_f32 v50, v50
    v_exp_f32 v51, v51
    v_exp_f32 v52, v52
    v_exp_f32 v53, v53
    v_exp_f32 v54, v54
    v_exp_f32 v55, v55
    s_waitcnt lgkmcnt(0)
    v_add_f32 v72, v72, v80
    v_add_f32 v88, v88, v16
    v_add_f32 v73, v73, v81
    v_add_f32 v89, v89, v17
    v_add_f32 v74, v74, v82
    v_add_f32 v90, v90, v18
    v_add_f32 v75, v75, v83
    v_add_f32 v91, v91, v19
    v_add_f32 v76, v76, v84
    v_add_f32 v92, v92, v20
    v_add_f32 v77, v77, v85
    v_add_f32 v93, v93, v21
    v_add_f32 v78, v78, v86
    v_add_f32 v94, v94, v22
    v_add_f32 v79, v79, v87
    v_add_f32 v95, v95, v23
    v_add_f32 v48, 1.0, v48
    v_add_f32 v49, 1.0, v49
    v_add_f32 v50, 1.0, v50
    v_add_f32 v51, 1.0, v51
    v_add_f32 v52, 1.0, v52
    v_add_f32 v53, 1.0, v53
    v_add_f32 v54, 1.0, v54
    v_add_f32 v55, 1.0, v55
    v_rcp_f32 v48, v48
    v_add_f32 v72, v72, v88
    v_rcp_f32 v49, v49
    v_add_f32 v73, v73, v89
    v_rcp_f32 v50, v50
    v_add_f32 v74, v74, v90
    v_rcp_f32 v51, v51
    v_add_f32 v75, v75, v91
    v_rcp_f32 v52, v52
    v_add_f32 v76, v76, v92
    v_rcp_f32 v53, v53
    v_add_f32 v77, v77, v93
    v_rcp_f32 v54, v54
    v_add_f32 v78, v78, v94
    v_rcp_f32 v55, v55
    v_add_f32 v79, v79, v95
    v_mul_f32 v40, v40, v72
    v_mul_f32 v41, v41, v73
    v_mul_f32 v42, v42, v74
    v_mul_f32 v43, v43, v75
    v_mul_f32 v44, v44, v76
    v_mul_f32 v45, v45, v77
    v_mul_f32 v46, v46, v78
    v_mul_f32 v47, v47, v79
    v_fma_f32 v28, v40, v48, v28
    v_fma_f32 v29, v41, v49, v29
    v_fma_f32 v30, v42, v50, v30
    v_fma_f32 v31, v43, v51, v31
    v_cvt_pk_bf16_f32 v244, v28, v29
    v_cvt_pk_bf16_f32 v245, v30, v31
    buffer_store_dwordx2 v[244:245], v254, s[28:31], s61 offen offset:96
    v_fma_f32 v32, v44, v52, v32
    v_fma_f32 v33, v45, v53, v33
    v_fma_f32 v34, v46, v54, v34
    v_fma_f32 v35, v47, v55, v35
    v_cvt_pk_bf16_f32 v246, v32, v33
    v_cvt_pk_bf16_f32 v247, v34, v35
    buffer_store_dwordx2 v[246:247], v254, s[28:31], s61 offen offset:128
K_END:
    s_endpgm
K_CODE_END:
.section .rodata,"a"
.p2align 6
.amdhsa_kernel recurrent_scan__linear_attn_block__glu_gated_geglu__prompt_kernel
  .amdhsa_next_free_vgpr 256
  .amdhsa_next_free_sgpr 102
  .amdhsa_accum_offset 256
  .amdhsa_group_segment_fixed_size 0
  .amdhsa_kernarg_size 80
  .amdhsa_user_sgpr_count 2
  .amdhsa_user_sgpr_kernarg_segment_ptr 1
  .amdhsa_system_sgpr_workgroup_id_x 1
.end_amdhsa_kernel
```
